```python
import torch

def _softmax(x, axis=-1):
    return torch.softmax(x, dim=axis)

def _gelu(x):
    return torch.nn.functional.gelu(x, approximate='tanh')

def _silu(x):
    return torch.nn.functional.silu(x)

def _sigmoid(x):
    return torch.sigmoid(x)

def _layernorm(x, axis=-1, eps=1e-05):
    m = x.mean(dim=axis, keepdim=True)
    v = x.var(dim=axis, keepdim=True, unbiased=False)
    return (x - m) / torch.sqrt(v + eps)

def _scatter_add(tgt, idx, src, axis=0):
    return tgt.clone().index_add_(axis, idx, src)

def _segment_sum(src, seg, n):
    out = torch.zeros((n,) + src.shape[1:], dtype=src.dtype)
    return out.index_add_(0, seg, src)

def _pad(x, pw):
    flat = tuple((v for pair in reversed(pw) for v in pair))
    return torch.nn.functional.pad(x, flat)
kernel_name = 'parallel_sum__grouped_kv_mqa__mixer_gmlp__prompt'

def setup_inputs():

    _w = lambda a: (lambda t: t.to(torch.bfloat16) if t.is_floating_point() else t)(torch.as_tensor(a))

    def _A_setup():
        B, S, D, H = (1, 2048, 576, 32)
        Dh = D // H
        return {'x': _w((lambda *s: torch.randn(*s, dtype=torch.bfloat16) * 0.05)(B, S, D)), 'wq': _w((lambda *s: torch.randn(*s, dtype=torch.bfloat16) * 0.2)(D, H * Dh)), 'wk': _w((lambda *s: torch.randn(*s, dtype=torch.bfloat16) * 0.2)(D, Dh)), 'wv': _w((lambda *s: torch.randn(*s, dtype=torch.bfloat16) * 0.1)(D, Dh)), 'wo': _w((lambda *s: torch.randn(*s, dtype=torch.bfloat16) * 0.1)(H * Dh, D))}
    _A_in = _A_setup()

    def _B_setup():
        B, S, D, F = (1, 2048, 576, 4608)
        Fh = F // 2
        return {'x': _w((lambda *s: torch.randn(*s, dtype=torch.bfloat16) * 0.05)(B, S, D)), 'w_in': _w((lambda *s: torch.randn(*s, dtype=torch.bfloat16) * 0.4)(D, 2 * Fh)), 'w_sp': _w(0.01 * (lambda *s: torch.randn(*s, dtype=torch.bfloat16) * 0.4)(S, S)), 'b_sp': _w(1.0 + 0.01 * (lambda *s: torch.randn(*s, dtype=torch.bfloat16) * 0.1)(S)), 'w_out': _w((lambda *s: torch.randn(*s, dtype=torch.bfloat16) * 0.1)(Fh, D))}
    _B_in = _B_setup()
    return {'A_x': _A_in['x'], 'A_wq': _A_in['wq'], 'A_wk': _A_in['wk'], 'A_wv': _A_in['wv'], 'A_wo': _A_in['wo'], 'B_x': _B_in['x'], 'B_w_in': _B_in['w_in'], 'B_w_sp': _B_in['w_sp'], 'B_b_sp': _B_in['b_sp'], 'B_w_out': _B_in['w_out']}

def reference(A_x, A_wq, A_wk, A_wv, A_wo, B_x, B_w_in, B_w_sp, B_b_sp, B_w_out):

    def _A_ref(x, wq, wk, wv, wo):
        B, S, D = x.shape
        H = 32
        Dh = D // H
        q = (lambda x, *d: x.permute(*d))((x @ wq).reshape(B, S, H, Dh), 0, 2, 1, 3)
        k = x @ wk
        v = x @ wv
        scores = torch.einsum('bhqd,bkd->bhqk', q, k) * Dh ** (-0.5)
        p = _softmax(scores, axis=-1)
        o = torch.einsum('bhqk,bkd->bhqd', p, v)
        return (lambda x, *d: x.permute(*d))(o, 0, 2, 1, 3).reshape(B, S, H * Dh) @ wo

    def _B_ref(x, w_in, w_sp, b_sp, w_out):
        B, S, D = x.shape
        F = w_in.shape[-1]
        Fh = F // 2
        z = _gelu(torch.einsum('bsd,df->bsf', x, w_in))
        z1 = z[..., :Fh].clone()
        z2 = _layernorm(z[..., Fh:], axis=-1)
        g = torch.einsum('ts,bsf->btf', w_sp, z2) + b_sp[None, :, None]
        return torch.einsum('bsf,fd->bsd', z1 * g, w_out)
    x = A_x
    xn = _layernorm(x, axis=-1)
    return x + _A_ref(xn, A_wq, A_wk, A_wv, A_wo) + _B_ref(xn, B_w_in, B_w_sp, B_b_sp, B_w_out)
```

```asm
; @launch kernel=k1_kernel grid=(256,1,1) block=(512,1,1) lds=147456
; @launch kernel=kn_kernel grid=(256,1,1) block=(512,1,1) lds=1024
; @launch kernel=kf_kernel grid=(256,1,1) block=(768,1,1) lds=157696
; @launch kernel=k4_kernel grid=(192,1,1) block=(256,1,1) lds=143360
.amdgcn_target "amdgcn-amd-amdhsa--gfx950"
.text
.globl k1_kernel
.p2align 8
.type k1_kernel,@function
k1_kernel:
    s_cmp_ge_u32 s2, 256
    s_cbranch_scc1 k1_end
    s_load_dwordx4 s[4:7], s[0:1], 0
    s_load_dwordx4 s[8:11], s[0:1], 16
    s_load_dwordx4 s[12:15], s[0:1], 48
    s_load_dwordx2 s[64:65], s[0:1], 96
    v_lshrrev_b32 v16, 6, v0
    v_and_b32 v1, 63, v0
    s_nop 0
    v_readfirstlane_b32 s28, v16
    v_and_b32 v2, 15, v1
    v_lshrrev_b32 v3, 4, v1
    v_and_b32 v4, 31, v1
    v_lshrrev_b32 v5, 5, v1
    s_lshr_b32 s29, s28, 2
    s_and_b32 s30, s28, 3
    s_and_b32 s39, s2, 7
    s_lshr_b32 s40, s2, 3
    s_and_b32 s41, s39, 3
    s_lshl_b32 s41, s41, 2
    s_and_b32 s42, s40, 3
    s_add_u32 s31, s41, s42
    s_lshr_b32 s41, s39, 2
    s_lshl_b32 s41, s41, 3
    s_lshr_b32 s42, s40, 2
    s_add_u32 s32, s41, s42
    s_mul_i32 s33, s32, 10
    s_min_u32 s39, s32, 4
    s_add_u32 s33, s33, s39
    s_cmp_lt_u32 s32, 4
    s_cselect_b32 s34, 11, 10
    s_lshl_b32 s36, s31, 7
    s_lshl_b32 s39, s30, 5
    s_add_u32 s36, s36, s39
    s_mov_b32 s44, 0xbdd2d3e8
    s_mov_b32 s45, 0xffff0000
    v_lshrrev_b32 v16, 3, v1
    v_and_b32 v17, 7, v1
    v_lshrrev_b32 v18, 1, v16
    v_xor_b32 v17, v17, v18
    v_mul_u32_u24 v16, 1152, v16
    v_lshl_add_u32 v20, v17, 4, v16
    v_xor_b32 v17, 4, v17
    v_lshl_add_u32 v21, v17, 4, v16
    s_lshl_b32 s39, s31, 7
    s_lshl_b32 s40, s28, 4
    s_add_u32 s39, s39, s40
    s_mul_i32 s39, s39, 1152
    s_lshl_b32 s43, s28, 11
    s_waitcnt lgkmcnt(0)
    s_mov_b32 s16, s4
    s_mov_b32 s17, s5
    s_mov_b32 s18, 2359296
    s_mov_b32 s19, 0x00020000
    s_mov_b32 s24, s64
    s_mov_b32 s25, s65
    s_mov_b32 s26, 0x10000000
    s_mov_b32 s27, 0x00020000
    s_mov_b32 s23, 0x00020000
    v_mov_b32 v11, 0xc0135761
    v_lshrrev_b32 v6, 2, v1
    v_and_b32 v16, 3, v1
    v_lshlrev_b32 v7, 4, v16
    v_bfe_u32 v16, v1, 2, 2
    v_lshl_add_u32 v16, v5, 3, v16
    v_lshlrev_b32 v16, 6, v16
    v_and_b32 v17, 3, v1
    v_lshl_add_u32 v16, v17, 3, v16
    v_and_b32 v17, 1, v3
    v_lshl_add_u32 v9, v17, 5, v16
    s_lshl_b32 s39, s31, 7
    s_lshl_b32 s40, s28, 4
    s_add_u32 s39, s39, s40
    s_mul_i32 s39, s39, 1152
    s_add_u32 m0, s43, 0
    s_add_u32 s40, s39, 0
    buffer_load_dwordx4 v20, s[16:19], s40 offen lds
    s_add_u32 m0, s43, 1024
    s_add_u32 s40, s39, 9216
    buffer_load_dwordx4 v21, s[16:19], s40 offen lds
    s_add_u32 m0, s43, 16384
    s_add_u32 s40, s39, 128
    buffer_load_dwordx4 v20, s[16:19], s40 offen lds
    s_add_u32 m0, s43, 17408
    s_add_u32 s40, s39, 9344
    buffer_load_dwordx4 v21, s[16:19], s40 offen lds
    s_add_u32 m0, s43, 32768
    s_add_u32 s40, s39, 256
    buffer_load_dwordx4 v20, s[16:19], s40 offen lds
    s_add_u32 m0, s43, 33792
    s_add_u32 s40, s39, 9472
    buffer_load_dwordx4 v21, s[16:19], s40 offen lds
    s_add_u32 m0, s43, 49152
    s_add_u32 s40, s39, 384
    buffer_load_dwordx4 v20, s[16:19], s40 offen lds
    s_add_u32 m0, s43, 50176
    s_add_u32 s40, s39, 9600
    buffer_load_dwordx4 v21, s[16:19], s40 offen lds
    s_add_u32 m0, s43, 65536
    s_add_u32 s40, s39, 512
    buffer_load_dwordx4 v20, s[16:19], s40 offen lds
    s_add_u32 m0, s43, 66560
    s_add_u32 s40, s39, 9728
    buffer_load_dwordx4 v21, s[16:19], s40 offen lds
    s_add_u32 m0, s43, 81920
    s_add_u32 s40, s39, 640
    buffer_load_dwordx4 v20, s[16:19], s40 offen lds
    s_add_u32 m0, s43, 82944
    s_add_u32 s40, s39, 9856
    buffer_load_dwordx4 v21, s[16:19], s40 offen lds
    s_add_u32 m0, s43, 98304
    s_add_u32 s40, s39, 768
    buffer_load_dwordx4 v20, s[16:19], s40 offen lds
    s_add_u32 m0, s43, 99328
    s_add_u32 s40, s39, 9984
    buffer_load_dwordx4 v21, s[16:19], s40 offen lds
    s_add_u32 m0, s43, 114688
    s_add_u32 s40, s39, 896
    buffer_load_dwordx4 v20, s[16:19], s40 offen lds
    s_add_u32 m0, s43, 115712
    s_add_u32 s40, s39, 10112
    buffer_load_dwordx4 v21, s[16:19], s40 offen lds
    s_add_u32 m0, s43, 131072
    s_add_u32 s40, s39, 1024
    buffer_load_dwordx4 v20, s[16:19], s40 offen lds
    s_add_u32 m0, s43, 132096
    s_add_u32 s40, s39, 10240
    buffer_load_dwordx4 v21, s[16:19], s40 offen lds
    s_add_u32 s41, s33, s29
    s_mov_b32 s20, s12
    s_mov_b32 s21, s13
    s_mov_b32 s22, 5308416
    s_movk_i32 s37, 9216
    s_sub_u32 s38, s41, 20
    s_lshl_b32 s38, s38, 6
    s_lshl_b32 s39, s41, 6
    s_cmp_lt_u32 s41, 20
    s_cselect_b32 s20, s10, s20
    s_cselect_b32 s21, s11, s21
    s_cselect_b32 s22, 20736, s22
    s_cselect_b32 s37, 36, s37
    s_cselect_b32 s38, 0, s38
    s_cmp_lt_u32 s41, 19
    s_cselect_b32 s20, s8, s20
    s_cselect_b32 s21, s9, s21
    s_cmp_lt_u32 s41, 18
    s_cselect_b32 s20, s6, s20
    s_cselect_b32 s21, s7, s21
    s_cselect_b32 s22, 663552, s22
    s_cselect_b32 s37, 1152, s37
    s_cselect_b32 s38, s39, s38
    v_mad_u32_u24 v8, v6, s37, v7
    s_lshl_b32 s58, s37, 4
    s_mul_i32 s40, s30, 9
    s_mul_i32 s59, s40, s58
    s_add_u32 s59, s59, s38
    s_and_b32 s57, s29, 3
    s_mul_i32 s57, s57, 36864
    s_lshl_b32 s40, s40, 10
    s_add_u32 s57, s57, s40
    s_cmp_ge_u32 s29, s34
    s_cselect_b32 s22, 0, s22
    s_mov_b32 s56, s57
    buffer_load_dwordx4 v[184:187], v8, s[20:23], s59 offen
    s_add_u32 s59, s59, s58
    buffer_load_dwordx4 v[188:191], v8, s[20:23], s59 offen
    s_add_u32 s59, s59, s58
    buffer_load_dwordx4 v[192:195], v8, s[20:23], s59 offen
    s_add_u32 s59, s59, s58
    buffer_load_dwordx4 v[196:199], v8, s[20:23], s59 offen
    s_add_u32 s59, s59, s58
    buffer_load_dwordx4 v[200:203], v8, s[20:23], s59 offen
    s_add_u32 s59, s59, s58
    buffer_load_dwordx4 v[204:207], v8, s[20:23], s59 offen
    s_add_u32 s59, s59, s58
    buffer_load_dwordx4 v[208:211], v8, s[20:23], s59 offen
    s_add_u32 s59, s59, s58
    buffer_load_dwordx4 v[212:215], v8, s[20:23], s59 offen
    s_add_u32 s59, s59, s58
    buffer_load_dwordx4 v[216:219], v8, s[20:23], s59 offen
    s_add_u32 s59, s59, s58
    s_cmp_ge_u32 s28, 4
    s_cbranch_scc1 k1_pf2
    v_mul_u32_u24 v17, 10923, v0
    v_lshrrev_b32 v17, 16, v17
    v_mul_u32_u24 v18, 6, v17
    v_sub_u32 v18, v0, v18
    s_mul_i32 s40, s31, 36
    v_add_u32 v17, s40, v17
    v_min_u32 v17, 575, v17
    v_mul_lo_u32 v17, v17, s37
    v_lshl_add_u32 v17, v18, 7, v17
    buffer_load_dword v19, v17, s[20:23], s38 offen
    s_branch k1_pf3
k1_pf2:
    s_mov_b32 s52, s14
    s_mov_b32 s53, s15
    s_mov_b32 s54, 8388608
    s_mov_b32 s55, 0x00020000
    s_lshl_b32 s39, s2, 8
    v_and_b32 v18, 255, v0
    v_add_u32 v18, s39, v18
    v_lshlrev_b32 v18, 7, v18
    buffer_load_dword v19, v18, s[52:55], 0 offen
k1_pf3:
    s_lshl_b32 s39, s28, 4
    v_add_u32 v16, s39, v2
    v_bfe_u32 v17, v2, 1, 3
    v_lshlrev_b32 v16, 7, v16
    v_xor_b32 v18, v3, v17
    v_lshl_add_u32 v232, v18, 4, v16
    v_xor_b32 v233, 64, v232
    v_add_u32 v234, 65536, v232
    v_add_u32 v235, 65536, v233
    v_add_u32 v236, 131072, v232
    v_add_u32 v237, 131072, v233
    v_mov_b32 v244, 0x3f803f80
    v_mov_b32 v245, 0x3f803f80
    v_mov_b32 v246, 0x3f803f80
    v_mov_b32 v247, 0x3f803f80
    v_and_b32 v16, 3, v1
    v_cmp_eq_u32 s[46:47], 1, v16
    v_cmp_eq_u32 s[48:49], 2, v16
    v_cmp_eq_u32 s[50:51], 3, v16
    v_lshrrev_b32 v17, 2, v2
    v_lshlrev_b32 v17, 4, v17
    v_add_u32 v17, v17, v2
    v_lshlrev_b32 v23, 2, v17
    s_waitcnt vmcnt(26)
    ds_read_b128 v[24:27], v232 offset:0
    ds_read_b128 v[28:31], v233 offset:0
    s_waitcnt vmcnt(24)
    ds_read_b128 v[32:35], v232 offset:16384
    ds_read_b128 v[36:39], v233 offset:16384
    s_waitcnt vmcnt(22)
    ds_read_b128 v[40:43], v232 offset:32768
    ds_read_b128 v[44:47], v233 offset:32768
    s_waitcnt vmcnt(20)
    ds_read_b128 v[48:51], v232 offset:49152
    ds_read_b128 v[52:55], v233 offset:49152
    s_waitcnt vmcnt(18)
    ds_read_b128 v[56:59], v234 offset:0
    ds_read_b128 v[60:63], v235 offset:0
    s_waitcnt vmcnt(16)
    ds_read_b128 v[64:67], v234 offset:16384
    ds_read_b128 v[68:71], v235 offset:16384
    s_waitcnt vmcnt(14)
    ds_read_b128 v[72:75], v234 offset:32768
    ds_read_b128 v[76:79], v235 offset:32768
    s_waitcnt vmcnt(12)
    ds_read_b128 v[80:83], v234 offset:49152
    ds_read_b128 v[84:87], v235 offset:49152
    s_waitcnt vmcnt(10)
    ds_read_b128 v[88:91], v236 offset:0
    ds_read_b128 v[92:95], v237 offset:0
    s_waitcnt lgkmcnt(15)
    v_mfma_f32_16x16x32_bf16 v[168:171], v[244:247], v[24:27], 0
    v_mfma_f32_16x16x32_bf16 v[172:175], v[24:27], v[24:27], 0
    s_waitcnt lgkmcnt(15)
    v_mfma_f32_16x16x32_bf16 v[168:171], v[244:247], v[28:31], v[168:171]
    v_mfma_f32_16x16x32_bf16 v[172:175], v[28:31], v[28:31], v[172:175]
    s_waitcnt lgkmcnt(15)
    v_mfma_f32_16x16x32_bf16 v[168:171], v[244:247], v[32:35], v[168:171]
    v_mfma_f32_16x16x32_bf16 v[172:175], v[32:35], v[32:35], v[172:175]
    s_waitcnt lgkmcnt(14)
    v_mfma_f32_16x16x32_bf16 v[168:171], v[244:247], v[36:39], v[168:171]
    v_mfma_f32_16x16x32_bf16 v[172:175], v[36:39], v[36:39], v[172:175]
    s_waitcnt lgkmcnt(13)
    v_mfma_f32_16x16x32_bf16 v[168:171], v[244:247], v[40:43], v[168:171]
    v_mfma_f32_16x16x32_bf16 v[172:175], v[40:43], v[40:43], v[172:175]
    s_waitcnt lgkmcnt(12)
    v_mfma_f32_16x16x32_bf16 v[168:171], v[244:247], v[44:47], v[168:171]
    v_mfma_f32_16x16x32_bf16 v[172:175], v[44:47], v[44:47], v[172:175]
    s_waitcnt lgkmcnt(11)
    v_mfma_f32_16x16x32_bf16 v[168:171], v[244:247], v[48:51], v[168:171]
    v_mfma_f32_16x16x32_bf16 v[172:175], v[48:51], v[48:51], v[172:175]
    s_waitcnt lgkmcnt(10)
    v_mfma_f32_16x16x32_bf16 v[168:171], v[244:247], v[52:55], v[168:171]
    v_mfma_f32_16x16x32_bf16 v[172:175], v[52:55], v[52:55], v[172:175]
    s_waitcnt lgkmcnt(9)
    v_mfma_f32_16x16x32_bf16 v[168:171], v[244:247], v[56:59], v[168:171]
    v_mfma_f32_16x16x32_bf16 v[172:175], v[56:59], v[56:59], v[172:175]
    s_waitcnt lgkmcnt(8)
    v_mfma_f32_16x16x32_bf16 v[168:171], v[244:247], v[60:63], v[168:171]
    v_mfma_f32_16x16x32_bf16 v[172:175], v[60:63], v[60:63], v[172:175]
    s_waitcnt lgkmcnt(7)
    v_mfma_f32_16x16x32_bf16 v[168:171], v[244:247], v[64:67], v[168:171]
    v_mfma_f32_16x16x32_bf16 v[172:175], v[64:67], v[64:67], v[172:175]
    s_waitcnt lgkmcnt(6)
    v_mfma_f32_16x16x32_bf16 v[168:171], v[244:247], v[68:71], v[168:171]
    v_mfma_f32_16x16x32_bf16 v[172:175], v[68:71], v[68:71], v[172:175]
    s_waitcnt lgkmcnt(5)
    v_mfma_f32_16x16x32_bf16 v[168:171], v[244:247], v[72:75], v[168:171]
    v_mfma_f32_16x16x32_bf16 v[172:175], v[72:75], v[72:75], v[172:175]
    s_waitcnt lgkmcnt(4)
    v_mfma_f32_16x16x32_bf16 v[168:171], v[244:247], v[76:79], v[168:171]
    v_mfma_f32_16x16x32_bf16 v[172:175], v[76:79], v[76:79], v[172:175]
    s_waitcnt lgkmcnt(3)
    v_mfma_f32_16x16x32_bf16 v[168:171], v[244:247], v[80:83], v[168:171]
    v_mfma_f32_16x16x32_bf16 v[172:175], v[80:83], v[80:83], v[172:175]
    s_waitcnt lgkmcnt(2)
    v_mfma_f32_16x16x32_bf16 v[168:171], v[244:247], v[84:87], v[168:171]
    v_mfma_f32_16x16x32_bf16 v[172:175], v[84:87], v[84:87], v[172:175]
    s_waitcnt lgkmcnt(1)
    v_mfma_f32_16x16x32_bf16 v[168:171], v[244:247], v[88:91], v[168:171]
    v_mfma_f32_16x16x32_bf16 v[172:175], v[88:91], v[88:91], v[172:175]
    s_waitcnt lgkmcnt(0)
    v_mfma_f32_16x16x32_bf16 v[168:171], v[244:247], v[92:95], v[168:171]
    v_mfma_f32_16x16x32_bf16 v[172:175], v[92:95], v[92:95], v[172:175]
    s_nop 7
    s_nop 3
    v_cndmask_b32 v16, v172, v173, s[46:47]
    v_cndmask_b32 v16, v16, v174, s[48:49]
    v_cndmask_b32 v16, v16, v175, s[50:51]
    ds_bpermute_b32 v20, v23, v16
    s_waitcnt lgkmcnt(0)
    v_mul_f32 v17, 0x3ae38e39, v168
    v_mul_f32 v16, 0x3ae38e39, v20
    v_fma_f32 v16, -v17, v17, v16
    v_max_f32 v16, 0, v16
    v_cvt_pk_bf16_f32 v22, v17, v17
    v_lshlrev_b32 v17, 16, v22
    v_cvt_pk_bf16_f32 v22, v16, v16
    v_lshlrev_b32 v16, 16, v22
    v_add_f32 v16, 0x3727c5ac, v16
    v_cvt_pk_bf16_f32 v22, v16, v16
    v_lshlrev_b32 v16, 16, v22
    v_sqrt_f32 v16, v16
    s_nop 0
    v_cvt_pk_bf16_f32 v22, v16, v16
    v_lshlrev_b32 v16, 16, v22
    v_rcp_f32 v18, v16
    s_nop 0
    v_mul_f32 v21, v17, v18
    v_sub_f32 v21, 0, v21
    v_lshlrev_b32 v16, 16, v24
    v_and_b32 v17, s45, v24
    v_fma_f32 v16, v16, v18, v21
    v_fma_f32 v17, v17, v18, v21
    v_cvt_pk_bf16_f32 v24, v16, v17
    v_lshlrev_b32 v22, 16, v25
    v_and_b32 v23, s45, v25
    v_fma_f32 v22, v22, v18, v21
    v_fma_f32 v23, v23, v18, v21
    v_cvt_pk_bf16_f32 v25, v22, v23
    v_lshlrev_b32 v16, 16, v26
    v_and_b32 v17, s45, v26
    v_fma_f32 v16, v16, v18, v21
    v_fma_f32 v17, v17, v18, v21
    v_cvt_pk_bf16_f32 v26, v16, v17
    v_lshlrev_b32 v22, 16, v27
    v_and_b32 v23, s45, v27
    v_fma_f32 v22, v22, v18, v21
    v_fma_f32 v23, v23, v18, v21
    v_cvt_pk_bf16_f32 v27, v22, v23
    ds_write_b128 v232, v[24:27] offset:0
    v_lshlrev_b32 v16, 16, v28
    v_and_b32 v17, s45, v28
    v_fma_f32 v16, v16, v18, v21
    v_fma_f32 v17, v17, v18, v21
    v_cvt_pk_bf16_f32 v28, v16, v17
    v_lshlrev_b32 v22, 16, v29
    v_and_b32 v23, s45, v29
    v_fma_f32 v22, v22, v18, v21
    v_fma_f32 v23, v23, v18, v21
    v_cvt_pk_bf16_f32 v29, v22, v23
    v_lshlrev_b32 v16, 16, v30
    v_and_b32 v17, s45, v30
    v_fma_f32 v16, v16, v18, v21
    v_fma_f32 v17, v17, v18, v21
    v_cvt_pk_bf16_f32 v30, v16, v17
    v_lshlrev_b32 v22, 16, v31
    v_and_b32 v23, s45, v31
    v_fma_f32 v22, v22, v18, v21
    v_fma_f32 v23, v23, v18, v21
    v_cvt_pk_bf16_f32 v31, v22, v23
    ds_write_b128 v233, v[28:31] offset:0
    v_lshlrev_b32 v16, 16, v32
    v_and_b32 v17, s45, v32
    v_fma_f32 v16, v16, v18, v21
    v_fma_f32 v17, v17, v18, v21
    v_cvt_pk_bf16_f32 v32, v16, v17
    v_lshlrev_b32 v22, 16, v33
    v_and_b32 v23, s45, v33
    v_fma_f32 v22, v22, v18, v21
    v_fma_f32 v23, v23, v18, v21
    v_cvt_pk_bf16_f32 v33, v22, v23
    v_lshlrev_b32 v16, 16, v34
    v_and_b32 v17, s45, v34
    v_fma_f32 v16, v16, v18, v21
    v_fma_f32 v17, v17, v18, v21
    v_cvt_pk_bf16_f32 v34, v16, v17
    v_lshlrev_b32 v22, 16, v35
    v_and_b32 v23, s45, v35
    v_fma_f32 v22, v22, v18, v21
    v_fma_f32 v23, v23, v18, v21
    v_cvt_pk_bf16_f32 v35, v22, v23
    ds_write_b128 v232, v[32:35] offset:16384
    v_lshlrev_b32 v16, 16, v36
    v_and_b32 v17, s45, v36
    v_fma_f32 v16, v16, v18, v21
    v_fma_f32 v17, v17, v18, v21
    v_cvt_pk_bf16_f32 v36, v16, v17
    v_lshlrev_b32 v22, 16, v37
    v_and_b32 v23, s45, v37
    v_fma_f32 v22, v22, v18, v21
    v_fma_f32 v23, v23, v18, v21
    v_cvt_pk_bf16_f32 v37, v22, v23
    v_lshlrev_b32 v16, 16, v38
    v_and_b32 v17, s45, v38
    v_fma_f32 v16, v16, v18, v21
    v_fma_f32 v17, v17, v18, v21
    v_cvt_pk_bf16_f32 v38, v16, v17
    v_lshlrev_b32 v22, 16, v39
    v_and_b32 v23, s45, v39
    v_fma_f32 v22, v22, v18, v21
    v_fma_f32 v23, v23, v18, v21
    v_cvt_pk_bf16_f32 v39, v22, v23
    ds_write_b128 v233, v[36:39] offset:16384
    v_lshlrev_b32 v16, 16, v40
    v_and_b32 v17, s45, v40
    v_fma_f32 v16, v16, v18, v21
    v_fma_f32 v17, v17, v18, v21
    v_cvt_pk_bf16_f32 v40, v16, v17
    v_lshlrev_b32 v22, 16, v41
    v_and_b32 v23, s45, v41
    v_fma_f32 v22, v22, v18, v21
    v_fma_f32 v23, v23, v18, v21
    v_cvt_pk_bf16_f32 v41, v22, v23
    v_lshlrev_b32 v16, 16, v42
    v_and_b32 v17, s45, v42
    v_fma_f32 v16, v16, v18, v21
    v_fma_f32 v17, v17, v18, v21
    v_cvt_pk_bf16_f32 v42, v16, v17
    v_lshlrev_b32 v22, 16, v43
    v_and_b32 v23, s45, v43
    v_fma_f32 v22, v22, v18, v21
    v_fma_f32 v23, v23, v18, v21
    v_cvt_pk_bf16_f32 v43, v22, v23
    ds_write_b128 v232, v[40:43] offset:32768
    v_lshlrev_b32 v16, 16, v44
    v_and_b32 v17, s45, v44
    v_fma_f32 v16, v16, v18, v21
    v_fma_f32 v17, v17, v18, v21
    v_cvt_pk_bf16_f32 v44, v16, v17
    v_lshlrev_b32 v22, 16, v45
    v_and_b32 v23, s45, v45
    v_fma_f32 v22, v22, v18, v21
    v_fma_f32 v23, v23, v18, v21
    v_cvt_pk_bf16_f32 v45, v22, v23
    v_lshlrev_b32 v16, 16, v46
    v_and_b32 v17, s45, v46
    v_fma_f32 v16, v16, v18, v21
    v_fma_f32 v17, v17, v18, v21
    v_cvt_pk_bf16_f32 v46, v16, v17
    v_lshlrev_b32 v22, 16, v47
    v_and_b32 v23, s45, v47
    v_fma_f32 v22, v22, v18, v21
    v_fma_f32 v23, v23, v18, v21
    v_cvt_pk_bf16_f32 v47, v22, v23
    ds_write_b128 v233, v[44:47] offset:32768
    v_lshlrev_b32 v16, 16, v48
    v_and_b32 v17, s45, v48
    v_fma_f32 v16, v16, v18, v21
    v_fma_f32 v17, v17, v18, v21
    v_cvt_pk_bf16_f32 v48, v16, v17
    v_lshlrev_b32 v22, 16, v49
    v_and_b32 v23, s45, v49
    v_fma_f32 v22, v22, v18, v21
    v_fma_f32 v23, v23, v18, v21
    v_cvt_pk_bf16_f32 v49, v22, v23
    v_lshlrev_b32 v16, 16, v50
    v_and_b32 v17, s45, v50
    v_fma_f32 v16, v16, v18, v21
    v_fma_f32 v17, v17, v18, v21
    v_cvt_pk_bf16_f32 v50, v16, v17
    v_lshlrev_b32 v22, 16, v51
    v_and_b32 v23, s45, v51
    v_fma_f32 v22, v22, v18, v21
    v_fma_f32 v23, v23, v18, v21
    v_cvt_pk_bf16_f32 v51, v22, v23
    ds_write_b128 v232, v[48:51] offset:49152
    v_lshlrev_b32 v16, 16, v52
    v_and_b32 v17, s45, v52
    v_fma_f32 v16, v16, v18, v21
    v_fma_f32 v17, v17, v18, v21
    v_cvt_pk_bf16_f32 v52, v16, v17
    v_lshlrev_b32 v22, 16, v53
    v_and_b32 v23, s45, v53
    v_fma_f32 v22, v22, v18, v21
    v_fma_f32 v23, v23, v18, v21
    v_cvt_pk_bf16_f32 v53, v22, v23
    v_lshlrev_b32 v16, 16, v54
    v_and_b32 v17, s45, v54
    v_fma_f32 v16, v16, v18, v21
    v_fma_f32 v17, v17, v18, v21
    v_cvt_pk_bf16_f32 v54, v16, v17
    v_lshlrev_b32 v22, 16, v55
    v_and_b32 v23, s45, v55
    v_fma_f32 v22, v22, v18, v21
    v_fma_f32 v23, v23, v18, v21
    v_cvt_pk_bf16_f32 v55, v22, v23
    ds_write_b128 v233, v[52:55] offset:49152
    v_lshlrev_b32 v16, 16, v56
    v_and_b32 v17, s45, v56
    v_fma_f32 v16, v16, v18, v21
    v_fma_f32 v17, v17, v18, v21
    v_cvt_pk_bf16_f32 v56, v16, v17
    v_lshlrev_b32 v22, 16, v57
    v_and_b32 v23, s45, v57
    v_fma_f32 v22, v22, v18, v21
    v_fma_f32 v23, v23, v18, v21
    v_cvt_pk_bf16_f32 v57, v22, v23
    v_lshlrev_b32 v16, 16, v58
    v_and_b32 v17, s45, v58
    v_fma_f32 v16, v16, v18, v21
    v_fma_f32 v17, v17, v18, v21
    v_cvt_pk_bf16_f32 v58, v16, v17
    v_lshlrev_b32 v22, 16, v59
    v_and_b32 v23, s45, v59
    v_fma_f32 v22, v22, v18, v21
    v_fma_f32 v23, v23, v18, v21
    v_cvt_pk_bf16_f32 v59, v22, v23
    ds_write_b128 v234, v[56:59] offset:0
    v_lshlrev_b32 v16, 16, v60
    v_and_b32 v17, s45, v60
    v_fma_f32 v16, v16, v18, v21
    v_fma_f32 v17, v17, v18, v21
    v_cvt_pk_bf16_f32 v60, v16, v17
    v_lshlrev_b32 v22, 16, v61
    v_and_b32 v23, s45, v61
    v_fma_f32 v22, v22, v18, v21
    v_fma_f32 v23, v23, v18, v21
    v_cvt_pk_bf16_f32 v61, v22, v23
    v_lshlrev_b32 v16, 16, v62
    v_and_b32 v17, s45, v62
    v_fma_f32 v16, v16, v18, v21
    v_fma_f32 v17, v17, v18, v21
    v_cvt_pk_bf16_f32 v62, v16, v17
    v_lshlrev_b32 v22, 16, v63
    v_and_b32 v23, s45, v63
    v_fma_f32 v22, v22, v18, v21
    v_fma_f32 v23, v23, v18, v21
    v_cvt_pk_bf16_f32 v63, v22, v23
    ds_write_b128 v235, v[60:63] offset:0
    v_lshlrev_b32 v16, 16, v64
    v_and_b32 v17, s45, v64
    v_fma_f32 v16, v16, v18, v21
    v_fma_f32 v17, v17, v18, v21
    v_cvt_pk_bf16_f32 v64, v16, v17
    v_lshlrev_b32 v22, 16, v65
    v_and_b32 v23, s45, v65
    v_fma_f32 v22, v22, v18, v21
    v_fma_f32 v23, v23, v18, v21
    v_cvt_pk_bf16_f32 v65, v22, v23
    v_lshlrev_b32 v16, 16, v66
    v_and_b32 v17, s45, v66
    v_fma_f32 v16, v16, v18, v21
    v_fma_f32 v17, v17, v18, v21
    v_cvt_pk_bf16_f32 v66, v16, v17
    v_lshlrev_b32 v22, 16, v67
    v_and_b32 v23, s45, v67
    v_fma_f32 v22, v22, v18, v21
    v_fma_f32 v23, v23, v18, v21
    v_cvt_pk_bf16_f32 v67, v22, v23
    ds_write_b128 v234, v[64:67] offset:16384
    v_lshlrev_b32 v16, 16, v68
    v_and_b32 v17, s45, v68
    v_fma_f32 v16, v16, v18, v21
    v_fma_f32 v17, v17, v18, v21
    v_cvt_pk_bf16_f32 v68, v16, v17
    v_lshlrev_b32 v22, 16, v69
    v_and_b32 v23, s45, v69
    v_fma_f32 v22, v22, v18, v21
    v_fma_f32 v23, v23, v18, v21
    v_cvt_pk_bf16_f32 v69, v22, v23
    v_lshlrev_b32 v16, 16, v70
    v_and_b32 v17, s45, v70
    v_fma_f32 v16, v16, v18, v21
    v_fma_f32 v17, v17, v18, v21
    v_cvt_pk_bf16_f32 v70, v16, v17
    v_lshlrev_b32 v22, 16, v71
    v_and_b32 v23, s45, v71
    v_fma_f32 v22, v22, v18, v21
    v_fma_f32 v23, v23, v18, v21
    v_cvt_pk_bf16_f32 v71, v22, v23
    ds_write_b128 v235, v[68:71] offset:16384
    v_lshlrev_b32 v16, 16, v72
    v_and_b32 v17, s45, v72
    v_fma_f32 v16, v16, v18, v21
    v_fma_f32 v17, v17, v18, v21
    v_cvt_pk_bf16_f32 v72, v16, v17
    v_lshlrev_b32 v22, 16, v73
    v_and_b32 v23, s45, v73
    v_fma_f32 v22, v22, v18, v21
    v_fma_f32 v23, v23, v18, v21
    v_cvt_pk_bf16_f32 v73, v22, v23
    v_lshlrev_b32 v16, 16, v74
    v_and_b32 v17, s45, v74
    v_fma_f32 v16, v16, v18, v21
    v_fma_f32 v17, v17, v18, v21
    v_cvt_pk_bf16_f32 v74, v16, v17
    v_lshlrev_b32 v22, 16, v75
    v_and_b32 v23, s45, v75
    v_fma_f32 v22, v22, v18, v21
    v_fma_f32 v23, v23, v18, v21
    v_cvt_pk_bf16_f32 v75, v22, v23
    ds_write_b128 v234, v[72:75] offset:32768
    v_lshlrev_b32 v16, 16, v76
    v_and_b32 v17, s45, v76
    v_fma_f32 v16, v16, v18, v21
    v_fma_f32 v17, v17, v18, v21
    v_cvt_pk_bf16_f32 v76, v16, v17
    v_lshlrev_b32 v22, 16, v77
    v_and_b32 v23, s45, v77
    v_fma_f32 v22, v22, v18, v21
    v_fma_f32 v23, v23, v18, v21
    v_cvt_pk_bf16_f32 v77, v22, v23
    v_lshlrev_b32 v16, 16, v78
    v_and_b32 v17, s45, v78
    v_fma_f32 v16, v16, v18, v21
    v_fma_f32 v17, v17, v18, v21
    v_cvt_pk_bf16_f32 v78, v16, v17
    v_lshlrev_b32 v22, 16, v79
    v_and_b32 v23, s45, v79
    v_fma_f32 v22, v22, v18, v21
    v_fma_f32 v23, v23, v18, v21
    v_cvt_pk_bf16_f32 v79, v22, v23
    ds_write_b128 v235, v[76:79] offset:32768
    v_lshlrev_b32 v16, 16, v80
    v_and_b32 v17, s45, v80
    v_fma_f32 v16, v16, v18, v21
    v_fma_f32 v17, v17, v18, v21
    v_cvt_pk_bf16_f32 v80, v16, v17
    v_lshlrev_b32 v22, 16, v81
    v_and_b32 v23, s45, v81
    v_fma_f32 v22, v22, v18, v21
    v_fma_f32 v23, v23, v18, v21
    v_cvt_pk_bf16_f32 v81, v22, v23
    v_lshlrev_b32 v16, 16, v82
    v_and_b32 v17, s45, v82
    v_fma_f32 v16, v16, v18, v21
    v_fma_f32 v17, v17, v18, v21
    v_cvt_pk_bf16_f32 v82, v16, v17
    v_lshlrev_b32 v22, 16, v83
    v_and_b32 v23, s45, v83
    v_fma_f32 v22, v22, v18, v21
    v_fma_f32 v23, v23, v18, v21
    v_cvt_pk_bf16_f32 v83, v22, v23
    ds_write_b128 v234, v[80:83] offset:49152
    v_lshlrev_b32 v16, 16, v84
    v_and_b32 v17, s45, v84
    v_fma_f32 v16, v16, v18, v21
    v_fma_f32 v17, v17, v18, v21
    v_cvt_pk_bf16_f32 v84, v16, v17
    v_lshlrev_b32 v22, 16, v85
    v_and_b32 v23, s45, v85
    v_fma_f32 v22, v22, v18, v21
    v_fma_f32 v23, v23, v18, v21
    v_cvt_pk_bf16_f32 v85, v22, v23
    v_lshlrev_b32 v16, 16, v86
    v_and_b32 v17, s45, v86
    v_fma_f32 v16, v16, v18, v21
    v_fma_f32 v17, v17, v18, v21
    v_cvt_pk_bf16_f32 v86, v16, v17
    v_lshlrev_b32 v22, 16, v87
    v_and_b32 v23, s45, v87
    v_fma_f32 v22, v22, v18, v21
    v_fma_f32 v23, v23, v18, v21
    v_cvt_pk_bf16_f32 v87, v22, v23
    ds_write_b128 v235, v[84:87] offset:49152
    v_lshlrev_b32 v16, 16, v88
    v_and_b32 v17, s45, v88
    v_fma_f32 v16, v16, v18, v21
    v_fma_f32 v17, v17, v18, v21
    v_cvt_pk_bf16_f32 v88, v16, v17
    v_lshlrev_b32 v22, 16, v89
    v_and_b32 v23, s45, v89
    v_fma_f32 v22, v22, v18, v21
    v_fma_f32 v23, v23, v18, v21
    v_cvt_pk_bf16_f32 v89, v22, v23
    v_lshlrev_b32 v16, 16, v90
    v_and_b32 v17, s45, v90
    v_fma_f32 v16, v16, v18, v21
    v_fma_f32 v17, v17, v18, v21
    v_cvt_pk_bf16_f32 v90, v16, v17
    v_lshlrev_b32 v22, 16, v91
    v_and_b32 v23, s45, v91
    v_fma_f32 v22, v22, v18, v21
    v_fma_f32 v23, v23, v18, v21
    v_cvt_pk_bf16_f32 v91, v22, v23
    ds_write_b128 v236, v[88:91] offset:0
    v_lshlrev_b32 v16, 16, v92
    v_and_b32 v17, s45, v92
    v_fma_f32 v16, v16, v18, v21
    v_fma_f32 v17, v17, v18, v21
    v_cvt_pk_bf16_f32 v92, v16, v17
    v_lshlrev_b32 v22, 16, v93
    v_and_b32 v23, s45, v93
    v_fma_f32 v22, v22, v18, v21
    v_fma_f32 v23, v23, v18, v21
    v_cvt_pk_bf16_f32 v93, v22, v23
    v_lshlrev_b32 v16, 16, v94
    v_and_b32 v17, s45, v94
    v_fma_f32 v16, v16, v18, v21
    v_fma_f32 v17, v17, v18, v21
    v_cvt_pk_bf16_f32 v94, v16, v17
    v_lshlrev_b32 v22, 16, v95
    v_and_b32 v23, s45, v95
    v_fma_f32 v22, v22, v18, v21
    v_fma_f32 v23, v23, v18, v21
    v_cvt_pk_bf16_f32 v95, v22, v23
    ds_write_b128 v237, v[92:95] offset:0
    s_lshl_b32 s39, s30, 5
    v_add_u32 v16, s39, v4
    v_bfe_u32 v17, v4, 1, 3
    v_lshlrev_b32 v16, 7, v16
    v_xor_b32 v18, v5, v17
    v_xor_b32 v17, 0, v18
    v_lshl_add_u32 v232, v17, 4, v16
    v_xor_b32 v17, 2, v18
    v_lshl_add_u32 v233, v17, 4, v16
    v_xor_b32 v17, 4, v18
    v_lshl_add_u32 v234, v17, 4, v16
    v_xor_b32 v17, 6, v18
    v_lshl_add_u32 v235, v17, 4, v16
    v_add_u32 v236, 65536, v232
    v_add_u32 v237, 65536, v233
    v_add_u32 v238, 65536, v234
    v_add_u32 v239, 65536, v235
    v_add_u32 v240, 131072, v232
    v_add_u32 v241, 131072, v233
    v_add_u32 v242, 131072, v234
    v_add_u32 v243, 131072, v235
    s_waitcnt lgkmcnt(0)
    s_barrier
    ds_read_b128 v[24:27], v232 offset:0
    ds_read_b128 v[28:31], v233 offset:0
    ds_read_b128 v[32:35], v234 offset:0
    ds_read_b128 v[36:39], v235 offset:0
    ds_read_b128 v[40:43], v232 offset:16384
    ds_read_b128 v[44:47], v233 offset:16384
    ds_read_b128 v[48:51], v234 offset:16384
    ds_read_b128 v[52:55], v235 offset:16384
    ds_read_b128 v[56:59], v232 offset:32768
    ds_read_b128 v[60:63], v233 offset:32768
    ds_read_b128 v[64:67], v234 offset:32768
    ds_read_b128 v[68:71], v235 offset:32768
    ds_read_b128 v[72:75], v232 offset:49152
    ds_read_b128 v[76:79], v233 offset:49152
    ds_read_b128 v[80:83], v234 offset:49152
    ds_read_b128 v[84:87], v235 offset:49152
    ds_read_b128 v[88:91], v236 offset:0
    ds_read_b128 v[92:95], v237 offset:0
    ds_read_b128 v[96:99], v238 offset:0
    ds_read_b128 v[100:103], v239 offset:0
    ds_read_b128 v[104:107], v236 offset:16384
    ds_read_b128 v[108:111], v237 offset:16384
    ds_read_b128 v[112:115], v238 offset:16384
    ds_read_b128 v[116:119], v239 offset:16384
    ds_read_b128 v[120:123], v236 offset:32768
    ds_read_b128 v[124:127], v237 offset:32768
    ds_read_b128 v[128:131], v238 offset:32768
    ds_read_b128 v[132:135], v239 offset:32768
    ds_read_b128 v[136:139], v236 offset:49152
    ds_read_b128 v[140:143], v237 offset:49152
    ds_read_b128 v[144:147], v238 offset:49152
    ds_read_b128 v[148:151], v239 offset:49152
    ds_read_b128 v[152:155], v240 offset:0
    ds_read_b128 v[156:159], v241 offset:0
    ds_read_b128 v[160:163], v242 offset:0
    ds_read_b128 v[164:167], v243 offset:0
    v_lshlrev_b32 v16, 4, v1
    v_add_u32 v16, s56, v16
    s_waitcnt vmcnt(1) lgkmcnt(0)
    s_barrier
    ds_write_b128 v16, v[184:187] offset:0
    ds_write_b128 v16, v[188:191] offset:1024
    ds_write_b128 v16, v[192:195] offset:2048
    ds_write_b128 v16, v[196:199] offset:3072
    ds_write_b128 v16, v[200:203] offset:4096
    ds_write_b128 v16, v[204:207] offset:5120
    ds_write_b128 v16, v[208:211] offset:6144
    ds_write_b128 v16, v[212:215] offset:7168
    ds_write_b128 v16, v[216:219] offset:8192
    s_waitcnt lgkmcnt(0)
    v_mov_b32 v216, 0
    v_mov_b32 v217, 0
    v_mov_b32 v218, 0
    v_mov_b32 v219, 0
    v_mov_b32 v220, 0
    v_mov_b32 v221, 0
    v_mov_b32 v222, 0
    v_mov_b32 v223, 0
    v_mov_b32 v224, 0
    v_mov_b32 v225, 0
    v_mov_b32 v226, 0
    v_mov_b32 v227, 0
    v_mov_b32 v228, 0
    v_mov_b32 v229, 0
    v_mov_b32 v230, 0
    v_mov_b32 v231, 0
    v_mov_b32 v232, 0
    v_mov_b32 v233, 0
    v_mov_b32 v234, 0
    v_mov_b32 v235, 0
    v_mov_b32 v236, 0
    v_mov_b32 v237, 0
    v_mov_b32 v238, 0
    v_mov_b32 v239, 0
    v_mov_b32 v240, 0
    v_mov_b32 v241, 0
    v_mov_b32 v242, 0
    v_mov_b32 v243, 0
    v_mov_b32 v244, 0
    v_mov_b32 v245, 0
    v_mov_b32 v246, 0
    v_mov_b32 v247, 0
    s_barrier
    s_mov_b32 s35, s29
    s_mov_b32 s60, -1
k1_loop:
    s_cmp_ge_u32 s35, s34
    s_cbranch_scc1 k1_idle
    s_add_u32 s41, s33, s35
    s_and_b32 s39, s35, 3
    s_mul_i32 s39, s39, 36864
    v_add_u32 v10, s39, v9
    s_add_u32 s52, s35, 2
    s_add_u32 s53, s33, s52
    s_mov_b32 s20, s12
    s_mov_b32 s21, s13
    s_mov_b32 s22, 5308416
    s_movk_i32 s37, 9216
    s_sub_u32 s38, s53, 20
    s_lshl_b32 s38, s38, 6
    s_lshl_b32 s39, s53, 6
    s_cmp_lt_u32 s53, 20
    s_cselect_b32 s20, s10, s20
    s_cselect_b32 s21, s11, s21
    s_cselect_b32 s22, 20736, s22
    s_cselect_b32 s37, 36, s37
    s_cselect_b32 s38, 0, s38
    s_cmp_lt_u32 s53, 19
    s_cselect_b32 s20, s8, s20
    s_cselect_b32 s21, s9, s21
    s_cmp_lt_u32 s53, 18
    s_cselect_b32 s20, s6, s20
    s_cselect_b32 s21, s7, s21
    s_cselect_b32 s22, 663552, s22
    s_cselect_b32 s37, 1152, s37
    s_cselect_b32 s38, s39, s38
    v_mad_u32_u24 v8, v6, s37, v7
    s_lshl_b32 s58, s37, 4
    s_mul_i32 s40, s30, 9
    s_mul_i32 s59, s40, s58
    s_add_u32 s59, s59, s38
    s_and_b32 s57, s52, 3
    s_mul_i32 s57, s57, 36864
    s_lshl_b32 s40, s40, 10
    s_add_u32 s57, s57, s40
    s_cmp_ge_u32 s52, s34
    s_cselect_b32 s22, 0, s22
    s_cmp_eq_u32 s41, 19
    s_cbranch_scc1 k1_xa
    s_cmp_ge_u32 s41, 92
    s_cbranch_scc1 k1_xa
    s_cmp_eq_u32 s60, -1
    s_cbranch_scc1 k1_wa_none
    s_cmp_lt_u32 s60, 18
    s_cbranch_scc1 k1_wa_Q
    s_cmp_eq_u32 s60, 18
    s_cbranch_scc1 k1_wa_K
    s_cmp_eq_u32 s60, 19
    s_cbranch_scc1 k1_wa_V
    ds_read_b64_tr_b16 v[184:185], v10 offset:0
    ds_read_b64_tr_b16 v[186:187], v10 offset:256
    ds_read_b64_tr_b16 v[188:189], v10 offset:1024
    ds_read_b64_tr_b16 v[190:191], v10 offset:1280
    ds_read_b64_tr_b16 v[192:193], v10 offset:2048
    ds_read_b64_tr_b16 v[194:195], v10 offset:2304
    ds_read_b64_tr_b16 v[196:197], v10 offset:3072
    ds_read_b64_tr_b16 v[198:199], v10 offset:3328
    s_waitcnt lgkmcnt(6)
    v_mfma_f32_32x32x16_bf16 v[168:183], v[184:187], v[24:27], 0
    s_movk_i32 s39, 4608
    v_lshlrev_b32 v13, 4, v5
    v_mad_u32_u24 v12, v4, s39, v13
    s_mul_i32 s61, s36, 4608
    s_sub_u32 s40, s60, 20
    s_lshl_b32 s40, s40, 6
    s_add_u32 s61, s61, s40
    s_add_u32 s61, s61, 4194304
    v_mul_f32 v16, v200, v200
    v_mul_f32 v17, v201, v201
    ds_read_b64_tr_b16 v[184:185], v10 offset:4096
    ds_read_b64_tr_b16 v[186:187], v10 offset:4352
    s_waitcnt lgkmcnt(6)
    v_mfma_f32_32x32x16_bf16 v[168:183], v[188:191], v[28:31], v[168:183]
    s_mov_b32 m0, s57
    s_add_u32 s57, s57, 1024
    buffer_load_dwordx4 v8, s[20:23], s59 offen lds
    s_add_u32 s59, s59, s58
    v_mul_f32 v18, v202, v202
    v_mul_f32 v19, v203, v203
    v_fma_f32 v16, v16, s44, v11
    v_fma_f32 v17, v17, s44, v11
    ds_read_b64_tr_b16 v[188:189], v10 offset:5120
    ds_read_b64_tr_b16 v[190:191], v10 offset:5376
    s_waitcnt lgkmcnt(6)
    v_mfma_f32_32x32x16_bf16 v[168:183], v[192:195], v[32:35], v[168:183]
    v_fma_f32 v18, v18, s44, v11
    v_fma_f32 v19, v19, s44, v11
    v_mul_f32 v16, v16, v200
    v_mul_f32 v17, v17, v201
    ds_read_b64_tr_b16 v[192:193], v10 offset:6144
    ds_read_b64_tr_b16 v[194:195], v10 offset:6400
    s_waitcnt lgkmcnt(6)
    v_mfma_f32_32x32x16_bf16 v[168:183], v[196:199], v[36:39], v[168:183]
    v_mul_f32 v18, v18, v202
    v_mul_f32 v19, v19, v203
    v_exp_f32 v16, v16
    v_exp_f32 v17, v17
    ds_read_b64_tr_b16 v[196:197], v10 offset:7168
    ds_read_b64_tr_b16 v[198:199], v10 offset:7424
    s_waitcnt lgkmcnt(6)
    v_mfma_f32_32x32x16_bf16 v[168:183], v[184:187], v[40:43], v[168:183]
    s_mov_b32 m0, s57
    s_add_u32 s57, s57, 1024
    buffer_load_dwordx4 v8, s[20:23], s59 offen lds
    s_add_u32 s59, s59, s58
    v_exp_f32 v18, v18
    v_exp_f32 v19, v19
    v_add_f32 v16, 1.0, v16
    v_add_f32 v17, 1.0, v17
    ds_read_b64_tr_b16 v[184:185], v10 offset:8192
    ds_read_b64_tr_b16 v[186:187], v10 offset:8448
    s_waitcnt lgkmcnt(6)
    v_mfma_f32_32x32x16_bf16 v[168:183], v[188:191], v[44:47], v[168:183]
    v_add_f32 v18, 1.0, v18
    v_add_f32 v19, 1.0, v19
    v_rcp_f32 v16, v16
    v_rcp_f32 v17, v17
    ds_read_b64_tr_b16 v[188:189], v10 offset:9216
    ds_read_b64_tr_b16 v[190:191], v10 offset:9472
    s_waitcnt lgkmcnt(6)
    v_mfma_f32_32x32x16_bf16 v[168:183], v[192:195], v[48:51], v[168:183]
    v_rcp_f32 v18, v18
    v_rcp_f32 v19, v19
    v_mul_f32 v200, v200, v16
    v_mul_f32 v201, v201, v17
    ds_read_b64_tr_b16 v[192:193], v10 offset:10240
    ds_read_b64_tr_b16 v[194:195], v10 offset:10496
    s_waitcnt lgkmcnt(6)
    v_mfma_f32_32x32x16_bf16 v[168:183], v[196:199], v[52:55], v[168:183]
    s_mov_b32 m0, s57
    s_add_u32 s57, s57, 1024
    buffer_load_dwordx4 v8, s[20:23], s59 offen lds
    s_add_u32 s59, s59, s58
    v_mul_f32 v202, v202, v18
    v_mul_f32 v203, v203, v19
    v_mul_f32 v16, v204, v204
    v_mul_f32 v17, v205, v205
    ds_read_b64_tr_b16 v[196:197], v10 offset:11264
    ds_read_b64_tr_b16 v[198:199], v10 offset:11520
    s_waitcnt lgkmcnt(6)
    v_mfma_f32_32x32x16_bf16 v[168:183], v[184:187], v[56:59], v[168:183]
    v_mul_f32 v18, v206, v206
    v_mul_f32 v19, v207, v207
    v_fma_f32 v16, v16, s44, v11
    v_fma_f32 v17, v17, s44, v11
    ds_read_b64_tr_b16 v[184:185], v10 offset:12288
    ds_read_b64_tr_b16 v[186:187], v10 offset:12544
    s_waitcnt lgkmcnt(6)
    v_mfma_f32_32x32x16_bf16 v[168:183], v[188:191], v[60:63], v[168:183]
    v_fma_f32 v18, v18, s44, v11
    v_fma_f32 v19, v19, s44, v11
    v_mul_f32 v16, v16, v204
    v_mul_f32 v17, v17, v205
    ds_read_b64_tr_b16 v[188:189], v10 offset:13312
    ds_read_b64_tr_b16 v[190:191], v10 offset:13568
    s_waitcnt lgkmcnt(6)
    v_mfma_f32_32x32x16_bf16 v[168:183], v[192:195], v[64:67], v[168:183]
    s_mov_b32 m0, s57
    s_add_u32 s57, s57, 1024
    buffer_load_dwordx4 v8, s[20:23], s59 offen lds
    s_add_u32 s59, s59, s58
    v_mul_f32 v18, v18, v206
    v_mul_f32 v19, v19, v207
    v_exp_f32 v16, v16
    v_exp_f32 v17, v17
    ds_read_b64_tr_b16 v[192:193], v10 offset:14336
    ds_read_b64_tr_b16 v[194:195], v10 offset:14592
    s_waitcnt lgkmcnt(6)
    v_mfma_f32_32x32x16_bf16 v[168:183], v[196:199], v[68:71], v[168:183]
    v_exp_f32 v18, v18
    v_exp_f32 v19, v19
    v_add_f32 v16, 1.0, v16
    v_add_f32 v17, 1.0, v17
    ds_read_b64_tr_b16 v[196:197], v10 offset:15360
    ds_read_b64_tr_b16 v[198:199], v10 offset:15616
    s_waitcnt lgkmcnt(6)
    v_mfma_f32_32x32x16_bf16 v[168:183], v[184:187], v[72:75], v[168:183]
    v_add_f32 v18, 1.0, v18
    v_add_f32 v19, 1.0, v19
    v_rcp_f32 v16, v16
    v_rcp_f32 v17, v17
    ds_read_b64_tr_b16 v[184:185], v10 offset:16384
    ds_read_b64_tr_b16 v[186:187], v10 offset:16640
    s_waitcnt lgkmcnt(6)
    v_mfma_f32_32x32x16_bf16 v[168:183], v[188:191], v[76:79], v[168:183]
    s_mov_b32 m0, s57
    s_add_u32 s57, s57, 1024
    buffer_load_dwordx4 v8, s[20:23], s59 offen lds
    s_add_u32 s59, s59, s58
    v_rcp_f32 v18, v18
    v_rcp_f32 v19, v19
    v_mul_f32 v204, v204, v16
    v_mul_f32 v205, v205, v17
    ds_read_b64_tr_b16 v[188:189], v10 offset:17408
    ds_read_b64_tr_b16 v[190:191], v10 offset:17664
    s_waitcnt lgkmcnt(6)
    v_mfma_f32_32x32x16_bf16 v[168:183], v[192:195], v[80:83], v[168:183]
    v_mul_f32 v206, v206, v18
    v_mul_f32 v207, v207, v19
    v_mul_f32 v16, v208, v208
    v_mul_f32 v17, v209, v209
    ds_read_b64_tr_b16 v[192:193], v10 offset:18432
    ds_read_b64_tr_b16 v[194:195], v10 offset:18688
    s_waitcnt lgkmcnt(6)
    v_mfma_f32_32x32x16_bf16 v[168:183], v[196:199], v[84:87], v[168:183]
    v_mul_f32 v18, v210, v210
    v_mul_f32 v19, v211, v211
    v_fma_f32 v16, v16, s44, v11
    v_fma_f32 v17, v17, s44, v11
    ds_read_b64_tr_b16 v[196:197], v10 offset:19456
    ds_read_b64_tr_b16 v[198:199], v10 offset:19712
    s_waitcnt lgkmcnt(6)
    v_mfma_f32_32x32x16_bf16 v[168:183], v[184:187], v[88:91], v[168:183]
    s_mov_b32 m0, s57
    s_add_u32 s57, s57, 1024
    buffer_load_dwordx4 v8, s[20:23], s59 offen lds
    s_add_u32 s59, s59, s58
    v_fma_f32 v18, v18, s44, v11
    v_fma_f32 v19, v19, s44, v11
    v_mul_f32 v16, v16, v208
    v_mul_f32 v17, v17, v209
    ds_read_b64_tr_b16 v[184:185], v10 offset:20480
    ds_read_b64_tr_b16 v[186:187], v10 offset:20736
    s_waitcnt lgkmcnt(6)
    v_mfma_f32_32x32x16_bf16 v[168:183], v[188:191], v[92:95], v[168:183]
    v_mul_f32 v18, v18, v210
    v_mul_f32 v19, v19, v211
    v_exp_f32 v16, v16
    v_exp_f32 v17, v17
    ds_read_b64_tr_b16 v[188:189], v10 offset:21504
    ds_read_b64_tr_b16 v[190:191], v10 offset:21760
    s_waitcnt lgkmcnt(6)
    v_mfma_f32_32x32x16_bf16 v[168:183], v[192:195], v[96:99], v[168:183]
    v_exp_f32 v18, v18
    v_exp_f32 v19, v19
    v_add_f32 v16, 1.0, v16
    v_add_f32 v17, 1.0, v17
    ds_read_b64_tr_b16 v[192:193], v10 offset:22528
    ds_read_b64_tr_b16 v[194:195], v10 offset:22784
    s_waitcnt lgkmcnt(6)
    v_mfma_f32_32x32x16_bf16 v[168:183], v[196:199], v[100:103], v[168:183]
    s_mov_b32 m0, s57
    s_add_u32 s57, s57, 1024
    buffer_load_dwordx4 v8, s[20:23], s59 offen lds
    s_add_u32 s59, s59, s58
    v_add_f32 v18, 1.0, v18
    v_add_f32 v19, 1.0, v19
    v_rcp_f32 v16, v16
    v_rcp_f32 v17, v17
    ds_read_b64_tr_b16 v[196:197], v10 offset:23552
    ds_read_b64_tr_b16 v[198:199], v10 offset:23808
    s_waitcnt lgkmcnt(6)
    v_mfma_f32_32x32x16_bf16 v[168:183], v[184:187], v[104:107], v[168:183]
    v_rcp_f32 v18, v18
    v_rcp_f32 v19, v19
    v_mul_f32 v208, v208, v16
    v_mul_f32 v209, v209, v17
    ds_read_b64_tr_b16 v[184:185], v10 offset:24576
    ds_read_b64_tr_b16 v[186:187], v10 offset:24832
    s_waitcnt lgkmcnt(6)
    v_mfma_f32_32x32x16_bf16 v[168:183], v[188:191], v[108:111], v[168:183]
    v_mul_f32 v210, v210, v18
    v_mul_f32 v211, v211, v19
    v_mul_f32 v16, v212, v212
    v_mul_f32 v17, v213, v213
    ds_read_b64_tr_b16 v[188:189], v10 offset:25600
    ds_read_b64_tr_b16 v[190:191], v10 offset:25856
    s_waitcnt lgkmcnt(6)
    v_mfma_f32_32x32x16_bf16 v[168:183], v[192:195], v[112:115], v[168:183]
    s_mov_b32 m0, s57
    s_add_u32 s57, s57, 1024
    buffer_load_dwordx4 v8, s[20:23], s59 offen lds
    s_add_u32 s59, s59, s58
    v_mul_f32 v18, v214, v214
    v_mul_f32 v19, v215, v215
    v_fma_f32 v16, v16, s44, v11
    v_fma_f32 v17, v17, s44, v11
    ds_read_b64_tr_b16 v[192:193], v10 offset:26624
    ds_read_b64_tr_b16 v[194:195], v10 offset:26880
    s_waitcnt lgkmcnt(6)
    v_mfma_f32_32x32x16_bf16 v[168:183], v[196:199], v[116:119], v[168:183]
    v_fma_f32 v18, v18, s44, v11
    v_fma_f32 v19, v19, s44, v11
    v_mul_f32 v16, v16, v212
    v_mul_f32 v17, v17, v213
    ds_read_b64_tr_b16 v[196:197], v10 offset:27648
    ds_read_b64_tr_b16 v[198:199], v10 offset:27904
    s_waitcnt lgkmcnt(6)
    v_mfma_f32_32x32x16_bf16 v[168:183], v[184:187], v[120:123], v[168:183]
    v_mul_f32 v18, v18, v214
    v_mul_f32 v19, v19, v215
    v_exp_f32 v16, v16
    v_exp_f32 v17, v17
    ds_read_b64_tr_b16 v[184:185], v10 offset:28672
    ds_read_b64_tr_b16 v[186:187], v10 offset:28928
    s_waitcnt lgkmcnt(6)
    v_mfma_f32_32x32x16_bf16 v[168:183], v[188:191], v[124:127], v[168:183]
    s_mov_b32 m0, s57
    s_add_u32 s57, s57, 1024
    buffer_load_dwordx4 v8, s[20:23], s59 offen lds
    s_add_u32 s59, s59, s58
    v_exp_f32 v18, v18
    v_exp_f32 v19, v19
    v_add_f32 v16, 1.0, v16
    v_add_f32 v17, 1.0, v17
    ds_read_b64_tr_b16 v[188:189], v10 offset:29696
    ds_read_b64_tr_b16 v[190:191], v10 offset:29952
    s_waitcnt lgkmcnt(6)
    v_mfma_f32_32x32x16_bf16 v[168:183], v[192:195], v[128:131], v[168:183]
    v_add_f32 v18, 1.0, v18
    v_add_f32 v19, 1.0, v19
    v_rcp_f32 v16, v16
    v_rcp_f32 v17, v17
    ds_read_b64_tr_b16 v[192:193], v10 offset:30720
    ds_read_b64_tr_b16 v[194:195], v10 offset:30976
    s_waitcnt lgkmcnt(6)
    v_mfma_f32_32x32x16_bf16 v[168:183], v[196:199], v[132:135], v[168:183]
    v_rcp_f32 v18, v18
    v_rcp_f32 v19, v19
    v_mul_f32 v212, v212, v16
    v_mul_f32 v213, v213, v17
    ds_read_b64_tr_b16 v[196:197], v10 offset:31744
    ds_read_b64_tr_b16 v[198:199], v10 offset:32000
    s_waitcnt lgkmcnt(6)
    v_mfma_f32_32x32x16_bf16 v[168:183], v[184:187], v[136:139], v[168:183]
    v_mul_f32 v214, v214, v18
    v_mul_f32 v215, v215, v19
    v_cvt_pk_bf16_f32 v200, v200, v201
    v_cvt_pk_bf16_f32 v201, v202, v203
    ds_read_b64_tr_b16 v[184:185], v10 offset:32768
    ds_read_b64_tr_b16 v[186:187], v10 offset:33024
    s_waitcnt lgkmcnt(6)
    v_mfma_f32_32x32x16_bf16 v[168:183], v[188:191], v[140:143], v[168:183]
    v_cvt_pk_bf16_f32 v202, v204, v205
    v_cvt_pk_bf16_f32 v203, v206, v207
    v_cvt_pk_bf16_f32 v204, v208, v209
    v_cvt_pk_bf16_f32 v205, v210, v211
    ds_read_b64_tr_b16 v[188:189], v10 offset:33792
    ds_read_b64_tr_b16 v[190:191], v10 offset:34048
    s_waitcnt lgkmcnt(6)
    v_mfma_f32_32x32x16_bf16 v[168:183], v[192:195], v[144:147], v[168:183]
    v_cvt_pk_bf16_f32 v206, v212, v213
    v_cvt_pk_bf16_f32 v207, v214, v215
    s_nop 1
    v_permlane32_swap_b32 v200, v202
    v_permlane32_swap_b32 v201, v203
    ds_read_b64_tr_b16 v[192:193], v10 offset:34816
    ds_read_b64_tr_b16 v[194:195], v10 offset:35072
    s_waitcnt lgkmcnt(6)
    v_mfma_f32_32x32x16_bf16 v[168:183], v[196:199], v[148:151], v[168:183]
    v_permlane32_swap_b32 v204, v206
    v_permlane32_swap_b32 v205, v207
    buffer_store_dwordx4 v[200:203], v12, s[24:27], s61 offen offset:0
    ds_read_b64_tr_b16 v[196:197], v10 offset:35840
    ds_read_b64_tr_b16 v[198:199], v10 offset:36096
    s_waitcnt lgkmcnt(6)
    v_mfma_f32_32x32x16_bf16 v[168:183], v[184:187], v[152:155], v[168:183]
    buffer_store_dwordx4 v[204:207], v12, s[24:27], s61 offen offset:32
    s_waitcnt lgkmcnt(4)
    v_mfma_f32_32x32x16_bf16 v[168:183], v[188:191], v[156:159], v[168:183]
    s_waitcnt lgkmcnt(2)
    v_mfma_f32_32x32x16_bf16 v[168:183], v[192:195], v[160:163], v[168:183]
    s_waitcnt lgkmcnt(0)
    v_mfma_f32_32x32x16_bf16 v[168:183], v[196:199], v[164:167], v[168:183]
    s_waitcnt vmcnt(2)
    s_branch k1_stepend
k1_wa_none:
    ds_read_b64_tr_b16 v[184:185], v10 offset:0
    ds_read_b64_tr_b16 v[186:187], v10 offset:256
    ds_read_b64_tr_b16 v[188:189], v10 offset:1024
    ds_read_b64_tr_b16 v[190:191], v10 offset:1280
    ds_read_b64_tr_b16 v[192:193], v10 offset:2048
    ds_read_b64_tr_b16 v[194:195], v10 offset:2304
    ds_read_b64_tr_b16 v[196:197], v10 offset:3072
    ds_read_b64_tr_b16 v[198:199], v10 offset:3328
    s_waitcnt lgkmcnt(6)
    v_mfma_f32_32x32x16_bf16 v[168:183], v[184:187], v[24:27], 0
    ds_read_b64_tr_b16 v[184:185], v10 offset:4096
    ds_read_b64_tr_b16 v[186:187], v10 offset:4352
    s_waitcnt lgkmcnt(6)
    v_mfma_f32_32x32x16_bf16 v[168:183], v[188:191], v[28:31], v[168:183]
    s_mov_b32 m0, s57
    s_add_u32 s57, s57, 1024
    buffer_load_dwordx4 v8, s[20:23], s59 offen lds
    s_add_u32 s59, s59, s58
    ds_read_b64_tr_b16 v[188:189], v10 offset:5120
    ds_read_b64_tr_b16 v[190:191], v10 offset:5376
    s_waitcnt lgkmcnt(6)
    v_mfma_f32_32x32x16_bf16 v[168:183], v[192:195], v[32:35], v[168:183]
    ds_read_b64_tr_b16 v[192:193], v10 offset:6144
    ds_read_b64_tr_b16 v[194:195], v10 offset:6400
    s_waitcnt lgkmcnt(6)
    v_mfma_f32_32x32x16_bf16 v[168:183], v[196:199], v[36:39], v[168:183]
    ds_read_b64_tr_b16 v[196:197], v10 offset:7168
    ds_read_b64_tr_b16 v[198:199], v10 offset:7424
    s_waitcnt lgkmcnt(6)
    v_mfma_f32_32x32x16_bf16 v[168:183], v[184:187], v[40:43], v[168:183]
    s_mov_b32 m0, s57
    s_add_u32 s57, s57, 1024
    buffer_load_dwordx4 v8, s[20:23], s59 offen lds
    s_add_u32 s59, s59, s58
    ds_read_b64_tr_b16 v[184:185], v10 offset:8192
    ds_read_b64_tr_b16 v[186:187], v10 offset:8448
    s_waitcnt lgkmcnt(6)
    v_mfma_f32_32x32x16_bf16 v[168:183], v[188:191], v[44:47], v[168:183]
    ds_read_b64_tr_b16 v[188:189], v10 offset:9216
    ds_read_b64_tr_b16 v[190:191], v10 offset:9472
    s_waitcnt lgkmcnt(6)
    v_mfma_f32_32x32x16_bf16 v[168:183], v[192:195], v[48:51], v[168:183]
    ds_read_b64_tr_b16 v[192:193], v10 offset:10240
    ds_read_b64_tr_b16 v[194:195], v10 offset:10496
    s_waitcnt lgkmcnt(6)
    v_mfma_f32_32x32x16_bf16 v[168:183], v[196:199], v[52:55], v[168:183]
    s_mov_b32 m0, s57
    s_add_u32 s57, s57, 1024
    buffer_load_dwordx4 v8, s[20:23], s59 offen lds
    s_add_u32 s59, s59, s58
    ds_read_b64_tr_b16 v[196:197], v10 offset:11264
    ds_read_b64_tr_b16 v[198:199], v10 offset:11520
    s_waitcnt lgkmcnt(6)
    v_mfma_f32_32x32x16_bf16 v[168:183], v[184:187], v[56:59], v[168:183]
    ds_read_b64_tr_b16 v[184:185], v10 offset:12288
    ds_read_b64_tr_b16 v[186:187], v10 offset:12544
    s_waitcnt lgkmcnt(6)
    v_mfma_f32_32x32x16_bf16 v[168:183], v[188:191], v[60:63], v[168:183]
    ds_read_b64_tr_b16 v[188:189], v10 offset:13312
    ds_read_b64_tr_b16 v[190:191], v10 offset:13568
    s_waitcnt lgkmcnt(6)
    v_mfma_f32_32x32x16_bf16 v[168:183], v[192:195], v[64:67], v[168:183]
    s_mov_b32 m0, s57
    s_add_u32 s57, s57, 1024
    buffer_load_dwordx4 v8, s[20:23], s59 offen lds
    s_add_u32 s59, s59, s58
    ds_read_b64_tr_b16 v[192:193], v10 offset:14336
    ds_read_b64_tr_b16 v[194:195], v10 offset:14592
    s_waitcnt lgkmcnt(6)
    v_mfma_f32_32x32x16_bf16 v[168:183], v[196:199], v[68:71], v[168:183]
    ds_read_b64_tr_b16 v[196:197], v10 offset:15360
    ds_read_b64_tr_b16 v[198:199], v10 offset:15616
    s_waitcnt lgkmcnt(6)
    v_mfma_f32_32x32x16_bf16 v[168:183], v[184:187], v[72:75], v[168:183]
    ds_read_b64_tr_b16 v[184:185], v10 offset:16384
    ds_read_b64_tr_b16 v[186:187], v10 offset:16640
    s_waitcnt lgkmcnt(6)
    v_mfma_f32_32x32x16_bf16 v[168:183], v[188:191], v[76:79], v[168:183]
    s_mov_b32 m0, s57
    s_add_u32 s57, s57, 1024
    buffer_load_dwordx4 v8, s[20:23], s59 offen lds
    s_add_u32 s59, s59, s58
    ds_read_b64_tr_b16 v[188:189], v10 offset:17408
    ds_read_b64_tr_b16 v[190:191], v10 offset:17664
    s_waitcnt lgkmcnt(6)
    v_mfma_f32_32x32x16_bf16 v[168:183], v[192:195], v[80:83], v[168:183]
    ds_read_b64_tr_b16 v[192:193], v10 offset:18432
    ds_read_b64_tr_b16 v[194:195], v10 offset:18688
    s_waitcnt lgkmcnt(6)
    v_mfma_f32_32x32x16_bf16 v[168:183], v[196:199], v[84:87], v[168:183]
    ds_read_b64_tr_b16 v[196:197], v10 offset:19456
    ds_read_b64_tr_b16 v[198:199], v10 offset:19712
    s_waitcnt lgkmcnt(6)
    v_mfma_f32_32x32x16_bf16 v[168:183], v[184:187], v[88:91], v[168:183]
    s_mov_b32 m0, s57
    s_add_u32 s57, s57, 1024
    buffer_load_dwordx4 v8, s[20:23], s59 offen lds
    s_add_u32 s59, s59, s58
    ds_read_b64_tr_b16 v[184:185], v10 offset:20480
    ds_read_b64_tr_b16 v[186:187], v10 offset:20736
    s_waitcnt lgkmcnt(6)
    v_mfma_f32_32x32x16_bf16 v[168:183], v[188:191], v[92:95], v[168:183]
    ds_read_b64_tr_b16 v[188:189], v10 offset:21504
    ds_read_b64_tr_b16 v[190:191], v10 offset:21760
    s_waitcnt lgkmcnt(6)
    v_mfma_f32_32x32x16_bf16 v[168:183], v[192:195], v[96:99], v[168:183]
    ds_read_b64_tr_b16 v[192:193], v10 offset:22528
    ds_read_b64_tr_b16 v[194:195], v10 offset:22784
    s_waitcnt lgkmcnt(6)
    v_mfma_f32_32x32x16_bf16 v[168:183], v[196:199], v[100:103], v[168:183]
    s_mov_b32 m0, s57
    s_add_u32 s57, s57, 1024
    buffer_load_dwordx4 v8, s[20:23], s59 offen lds
    s_add_u32 s59, s59, s58
    ds_read_b64_tr_b16 v[196:197], v10 offset:23552
    ds_read_b64_tr_b16 v[198:199], v10 offset:23808
    s_waitcnt lgkmcnt(6)
    v_mfma_f32_32x32x16_bf16 v[168:183], v[184:187], v[104:107], v[168:183]
    ds_read_b64_tr_b16 v[184:185], v10 offset:24576
    ds_read_b64_tr_b16 v[186:187], v10 offset:24832
    s_waitcnt lgkmcnt(6)
    v_mfma_f32_32x32x16_bf16 v[168:183], v[188:191], v[108:111], v[168:183]
    ds_read_b64_tr_b16 v[188:189], v10 offset:25600
    ds_read_b64_tr_b16 v[190:191], v10 offset:25856
    s_waitcnt lgkmcnt(6)
    v_mfma_f32_32x32x16_bf16 v[168:183], v[192:195], v[112:115], v[168:183]
    s_mov_b32 m0, s57
    s_add_u32 s57, s57, 1024
    buffer_load_dwordx4 v8, s[20:23], s59 offen lds
    s_add_u32 s59, s59, s58
    ds_read_b64_tr_b16 v[192:193], v10 offset:26624
    ds_read_b64_tr_b16 v[194:195], v10 offset:26880
    s_waitcnt lgkmcnt(6)
    v_mfma_f32_32x32x16_bf16 v[168:183], v[196:199], v[116:119], v[168:183]
    ds_read_b64_tr_b16 v[196:197], v10 offset:27648
    ds_read_b64_tr_b16 v[198:199], v10 offset:27904
    s_waitcnt lgkmcnt(6)
    v_mfma_f32_32x32x16_bf16 v[168:183], v[184:187], v[120:123], v[168:183]
    ds_read_b64_tr_b16 v[184:185], v10 offset:28672
    ds_read_b64_tr_b16 v[186:187], v10 offset:28928
    s_waitcnt lgkmcnt(6)
    v_mfma_f32_32x32x16_bf16 v[168:183], v[188:191], v[124:127], v[168:183]
    s_mov_b32 m0, s57
    s_add_u32 s57, s57, 1024
    buffer_load_dwordx4 v8, s[20:23], s59 offen lds
    s_add_u32 s59, s59, s58
    ds_read_b64_tr_b16 v[188:189], v10 offset:29696
    ds_read_b64_tr_b16 v[190:191], v10 offset:29952
    s_waitcnt lgkmcnt(6)
    v_mfma_f32_32x32x16_bf16 v[168:183], v[192:195], v[128:131], v[168:183]
    ds_read_b64_tr_b16 v[192:193], v10 offset:30720
    ds_read_b64_tr_b16 v[194:195], v10 offset:30976
    s_waitcnt lgkmcnt(6)
    v_mfma_f32_32x32x16_bf16 v[168:183], v[196:199], v[132:135], v[168:183]
    ds_read_b64_tr_b16 v[196:197], v10 offset:31744
    ds_read_b64_tr_b16 v[198:199], v10 offset:32000
    s_waitcnt lgkmcnt(6)
    v_mfma_f32_32x32x16_bf16 v[168:183], v[184:187], v[136:139], v[168:183]
    ds_read_b64_tr_b16 v[184:185], v10 offset:32768
    ds_read_b64_tr_b16 v[186:187], v10 offset:33024
    s_waitcnt lgkmcnt(6)
    v_mfma_f32_32x32x16_bf16 v[168:183], v[188:191], v[140:143], v[168:183]
    ds_read_b64_tr_b16 v[188:189], v10 offset:33792
    ds_read_b64_tr_b16 v[190:191], v10 offset:34048
    s_waitcnt lgkmcnt(6)
    v_mfma_f32_32x32x16_bf16 v[168:183], v[192:195], v[144:147], v[168:183]
    ds_read_b64_tr_b16 v[192:193], v10 offset:34816
    ds_read_b64_tr_b16 v[194:195], v10 offset:35072
    s_waitcnt lgkmcnt(6)
    v_mfma_f32_32x32x16_bf16 v[168:183], v[196:199], v[148:151], v[168:183]
    ds_read_b64_tr_b16 v[196:197], v10 offset:35840
    ds_read_b64_tr_b16 v[198:199], v10 offset:36096
    s_waitcnt lgkmcnt(6)
    v_mfma_f32_32x32x16_bf16 v[168:183], v[184:187], v[152:155], v[168:183]
    s_waitcnt lgkmcnt(4)
    v_mfma_f32_32x32x16_bf16 v[168:183], v[188:191], v[156:159], v[168:183]
    s_waitcnt lgkmcnt(2)
    v_mfma_f32_32x32x16_bf16 v[168:183], v[192:195], v[160:163], v[168:183]
    s_waitcnt lgkmcnt(0)
    v_mfma_f32_32x32x16_bf16 v[168:183], v[196:199], v[164:167], v[168:183]
    s_waitcnt vmcnt(0)
    s_branch k1_stepend
k1_wa_Q:
    ds_read_b64_tr_b16 v[184:185], v10 offset:0
    ds_read_b64_tr_b16 v[186:187], v10 offset:256
    ds_read_b64_tr_b16 v[188:189], v10 offset:1024
    ds_read_b64_tr_b16 v[190:191], v10 offset:1280
    ds_read_b64_tr_b16 v[192:193], v10 offset:2048
    ds_read_b64_tr_b16 v[194:195], v10 offset:2304
    ds_read_b64_tr_b16 v[196:197], v10 offset:3072
    ds_read_b64_tr_b16 v[198:199], v10 offset:3328
    s_waitcnt lgkmcnt(6)
    v_mfma_f32_32x32x16_bf16 v[168:183], v[184:187], v[24:27], 0
    s_movk_i32 s39, 1152
    v_lshlrev_b32 v13, 4, v5
    v_mad_u32_u24 v12, v4, s39, v13
    ds_read_b64_tr_b16 v[184:185], v10 offset:4096
    ds_read_b64_tr_b16 v[186:187], v10 offset:4352
    s_waitcnt lgkmcnt(6)
    v_mfma_f32_32x32x16_bf16 v[168:183], v[188:191], v[28:31], v[168:183]
    s_mov_b32 m0, s57
    s_add_u32 s57, s57, 1024
    buffer_load_dwordx4 v8, s[20:23], s59 offen lds
    s_add_u32 s59, s59, s58
    s_mul_i32 s61, s36, 1152
    s_lshl_b32 s40, s60, 6
    s_add_u32 s61, s61, s40
    s_add_u32 s61, s61, 0
    ds_read_b64_tr_b16 v[188:189], v10 offset:5120
    ds_read_b64_tr_b16 v[190:191], v10 offset:5376
    s_waitcnt lgkmcnt(6)
    v_mfma_f32_32x32x16_bf16 v[168:183], v[192:195], v[32:35], v[168:183]
    v_mul_f32 v200, 0x3eae1a93, v200
    ds_read_b64_tr_b16 v[192:193], v10 offset:6144
    ds_read_b64_tr_b16 v[194:195], v10 offset:6400
    s_waitcnt lgkmcnt(6)
    v_mfma_f32_32x32x16_bf16 v[168:183], v[196:199], v[36:39], v[168:183]
    v_mul_f32 v201, 0x3eae1a93, v201
    ds_read_b64_tr_b16 v[196:197], v10 offset:7168
    ds_read_b64_tr_b16 v[198:199], v10 offset:7424
    s_waitcnt lgkmcnt(6)
    v_mfma_f32_32x32x16_bf16 v[168:183], v[184:187], v[40:43], v[168:183]
    s_mov_b32 m0, s57
    s_add_u32 s57, s57, 1024
    buffer_load_dwordx4 v8, s[20:23], s59 offen lds
    s_add_u32 s59, s59, s58
    v_mul_f32 v202, 0x3eae1a93, v202
    ds_read_b64_tr_b16 v[184:185], v10 offset:8192
    ds_read_b64_tr_b16 v[186:187], v10 offset:8448
    s_waitcnt lgkmcnt(6)
    v_mfma_f32_32x32x16_bf16 v[168:183], v[188:191], v[44:47], v[168:183]
    v_mul_f32 v203, 0x3eae1a93, v203
    ds_read_b64_tr_b16 v[188:189], v10 offset:9216
    ds_read_b64_tr_b16 v[190:191], v10 offset:9472
    s_waitcnt lgkmcnt(6)
    v_mfma_f32_32x32x16_bf16 v[168:183], v[192:195], v[48:51], v[168:183]
    v_mul_f32 v204, 0x3eae1a93, v204
    ds_read_b64_tr_b16 v[192:193], v10 offset:10240
    ds_read_b64_tr_b16 v[194:195], v10 offset:10496
    s_waitcnt lgkmcnt(6)
    v_mfma_f32_32x32x16_bf16 v[168:183], v[196:199], v[52:55], v[168:183]
    s_mov_b32 m0, s57
    s_add_u32 s57, s57, 1024
    buffer_load_dwordx4 v8, s[20:23], s59 offen lds
    s_add_u32 s59, s59, s58
    v_mul_f32 v205, 0x3eae1a93, v205
    ds_read_b64_tr_b16 v[196:197], v10 offset:11264
    ds_read_b64_tr_b16 v[198:199], v10 offset:11520
    s_waitcnt lgkmcnt(6)
    v_mfma_f32_32x32x16_bf16 v[168:183], v[184:187], v[56:59], v[168:183]
    v_mul_f32 v206, 0x3eae1a93, v206
    ds_read_b64_tr_b16 v[184:185], v10 offset:12288
    ds_read_b64_tr_b16 v[186:187], v10 offset:12544
    s_waitcnt lgkmcnt(6)
    v_mfma_f32_32x32x16_bf16 v[168:183], v[188:191], v[60:63], v[168:183]
    v_mul_f32 v207, 0x3eae1a93, v207
    ds_read_b64_tr_b16 v[188:189], v10 offset:13312
    ds_read_b64_tr_b16 v[190:191], v10 offset:13568
    s_waitcnt lgkmcnt(6)
    v_mfma_f32_32x32x16_bf16 v[168:183], v[192:195], v[64:67], v[168:183]
    s_mov_b32 m0, s57
    s_add_u32 s57, s57, 1024
    buffer_load_dwordx4 v8, s[20:23], s59 offen lds
    s_add_u32 s59, s59, s58
    v_mul_f32 v208, 0x3eae1a93, v208
    ds_read_b64_tr_b16 v[192:193], v10 offset:14336
    ds_read_b64_tr_b16 v[194:195], v10 offset:14592
    s_waitcnt lgkmcnt(6)
    v_mfma_f32_32x32x16_bf16 v[168:183], v[196:199], v[68:71], v[168:183]
    v_mul_f32 v209, 0x3eae1a93, v209
    ds_read_b64_tr_b16 v[196:197], v10 offset:15360
    ds_read_b64_tr_b16 v[198:199], v10 offset:15616
    s_waitcnt lgkmcnt(6)
    v_mfma_f32_32x32x16_bf16 v[168:183], v[184:187], v[72:75], v[168:183]
    v_mul_f32 v210, 0x3eae1a93, v210
    ds_read_b64_tr_b16 v[184:185], v10 offset:16384
    ds_read_b64_tr_b16 v[186:187], v10 offset:16640
    s_waitcnt lgkmcnt(6)
    v_mfma_f32_32x32x16_bf16 v[168:183], v[188:191], v[76:79], v[168:183]
    s_mov_b32 m0, s57
    s_add_u32 s57, s57, 1024
    buffer_load_dwordx4 v8, s[20:23], s59 offen lds
    s_add_u32 s59, s59, s58
    v_mul_f32 v211, 0x3eae1a93, v211
    ds_read_b64_tr_b16 v[188:189], v10 offset:17408
    ds_read_b64_tr_b16 v[190:191], v10 offset:17664
    s_waitcnt lgkmcnt(6)
    v_mfma_f32_32x32x16_bf16 v[168:183], v[192:195], v[80:83], v[168:183]
    v_mul_f32 v212, 0x3eae1a93, v212
    ds_read_b64_tr_b16 v[192:193], v10 offset:18432
    ds_read_b64_tr_b16 v[194:195], v10 offset:18688
    s_waitcnt lgkmcnt(6)
    v_mfma_f32_32x32x16_bf16 v[168:183], v[196:199], v[84:87], v[168:183]
    v_mul_f32 v213, 0x3eae1a93, v213
    ds_read_b64_tr_b16 v[196:197], v10 offset:19456
    ds_read_b64_tr_b16 v[198:199], v10 offset:19712
    s_waitcnt lgkmcnt(6)
    v_mfma_f32_32x32x16_bf16 v[168:183], v[184:187], v[88:91], v[168:183]
    s_mov_b32 m0, s57
    s_add_u32 s57, s57, 1024
    buffer_load_dwordx4 v8, s[20:23], s59 offen lds
    s_add_u32 s59, s59, s58
    v_mul_f32 v214, 0x3eae1a93, v214
    ds_read_b64_tr_b16 v[184:185], v10 offset:20480
    ds_read_b64_tr_b16 v[186:187], v10 offset:20736
    s_waitcnt lgkmcnt(6)
    v_mfma_f32_32x32x16_bf16 v[168:183], v[188:191], v[92:95], v[168:183]
    v_mul_f32 v215, 0x3eae1a93, v215
    ds_read_b64_tr_b16 v[188:189], v10 offset:21504
    ds_read_b64_tr_b16 v[190:191], v10 offset:21760
    s_waitcnt lgkmcnt(6)
    v_mfma_f32_32x32x16_bf16 v[168:183], v[192:195], v[96:99], v[168:183]
    v_cvt_pk_bf16_f32 v200, v200, v201
    ds_read_b64_tr_b16 v[192:193], v10 offset:22528
    ds_read_b64_tr_b16 v[194:195], v10 offset:22784
    s_waitcnt lgkmcnt(6)
    v_mfma_f32_32x32x16_bf16 v[168:183], v[196:199], v[100:103], v[168:183]
    s_mov_b32 m0, s57
    s_add_u32 s57, s57, 1024
    buffer_load_dwordx4 v8, s[20:23], s59 offen lds
    s_add_u32 s59, s59, s58
    v_cvt_pk_bf16_f32 v201, v202, v203
    ds_read_b64_tr_b16 v[196:197], v10 offset:23552
    ds_read_b64_tr_b16 v[198:199], v10 offset:23808
    s_waitcnt lgkmcnt(6)
    v_mfma_f32_32x32x16_bf16 v[168:183], v[184:187], v[104:107], v[168:183]
    v_cvt_pk_bf16_f32 v202, v204, v205
    ds_read_b64_tr_b16 v[184:185], v10 offset:24576
    ds_read_b64_tr_b16 v[186:187], v10 offset:24832
    s_waitcnt lgkmcnt(6)
    v_mfma_f32_32x32x16_bf16 v[168:183], v[188:191], v[108:111], v[168:183]
    v_cvt_pk_bf16_f32 v203, v206, v207
    ds_read_b64_tr_b16 v[188:189], v10 offset:25600
    ds_read_b64_tr_b16 v[190:191], v10 offset:25856
    s_waitcnt lgkmcnt(6)
    v_mfma_f32_32x32x16_bf16 v[168:183], v[192:195], v[112:115], v[168:183]
    s_mov_b32 m0, s57
    s_add_u32 s57, s57, 1024
    buffer_load_dwordx4 v8, s[20:23], s59 offen lds
    s_add_u32 s59, s59, s58
    v_cvt_pk_bf16_f32 v204, v208, v209
    ds_read_b64_tr_b16 v[192:193], v10 offset:26624
    ds_read_b64_tr_b16 v[194:195], v10 offset:26880
    s_waitcnt lgkmcnt(6)
    v_mfma_f32_32x32x16_bf16 v[168:183], v[196:199], v[116:119], v[168:183]
    v_cvt_pk_bf16_f32 v205, v210, v211
    ds_read_b64_tr_b16 v[196:197], v10 offset:27648
    ds_read_b64_tr_b16 v[198:199], v10 offset:27904
    s_waitcnt lgkmcnt(6)
    v_mfma_f32_32x32x16_bf16 v[168:183], v[184:187], v[120:123], v[168:183]
    v_cvt_pk_bf16_f32 v206, v212, v213
    ds_read_b64_tr_b16 v[184:185], v10 offset:28672
    ds_read_b64_tr_b16 v[186:187], v10 offset:28928
    s_waitcnt lgkmcnt(6)
    v_mfma_f32_32x32x16_bf16 v[168:183], v[188:191], v[124:127], v[168:183]
    s_mov_b32 m0, s57
    s_add_u32 s57, s57, 1024
    buffer_load_dwordx4 v8, s[20:23], s59 offen lds
    s_add_u32 s59, s59, s58
    v_cvt_pk_bf16_f32 v207, v214, v215
    ds_read_b64_tr_b16 v[188:189], v10 offset:29696
    ds_read_b64_tr_b16 v[190:191], v10 offset:29952
    s_waitcnt lgkmcnt(6)
    v_mfma_f32_32x32x16_bf16 v[168:183], v[192:195], v[128:131], v[168:183]
    s_nop 1
    ds_read_b64_tr_b16 v[192:193], v10 offset:30720
    ds_read_b64_tr_b16 v[194:195], v10 offset:30976
    s_waitcnt lgkmcnt(6)
    v_mfma_f32_32x32x16_bf16 v[168:183], v[196:199], v[132:135], v[168:183]
    v_permlane32_swap_b32 v200, v202
    v_permlane32_swap_b32 v201, v203
    ds_read_b64_tr_b16 v[196:197], v10 offset:31744
    ds_read_b64_tr_b16 v[198:199], v10 offset:32000
    s_waitcnt lgkmcnt(6)
    v_mfma_f32_32x32x16_bf16 v[168:183], v[184:187], v[136:139], v[168:183]
    v_permlane32_swap_b32 v204, v206
    v_permlane32_swap_b32 v205, v207
    buffer_store_dwordx4 v[200:203], v12, s[24:27], s61 offen offset:0
    ds_read_b64_tr_b16 v[184:185], v10 offset:32768
    ds_read_b64_tr_b16 v[186:187], v10 offset:33024
    s_waitcnt lgkmcnt(6)
    v_mfma_f32_32x32x16_bf16 v[168:183], v[188:191], v[140:143], v[168:183]
    buffer_store_dwordx4 v[204:207], v12, s[24:27], s61 offen offset:32
    ds_read_b64_tr_b16 v[188:189], v10 offset:33792
    ds_read_b64_tr_b16 v[190:191], v10 offset:34048
    s_waitcnt lgkmcnt(6)
    v_mfma_f32_32x32x16_bf16 v[168:183], v[192:195], v[144:147], v[168:183]
    ds_read_b64_tr_b16 v[192:193], v10 offset:34816
    ds_read_b64_tr_b16 v[194:195], v10 offset:35072
    s_waitcnt lgkmcnt(6)
    v_mfma_f32_32x32x16_bf16 v[168:183], v[196:199], v[148:151], v[168:183]
    ds_read_b64_tr_b16 v[196:197], v10 offset:35840
    ds_read_b64_tr_b16 v[198:199], v10 offset:36096
    s_waitcnt lgkmcnt(6)
    v_mfma_f32_32x32x16_bf16 v[168:183], v[184:187], v[152:155], v[168:183]
    s_waitcnt lgkmcnt(4)
    v_mfma_f32_32x32x16_bf16 v[168:183], v[188:191], v[156:159], v[168:183]
    s_waitcnt lgkmcnt(2)
    v_mfma_f32_32x32x16_bf16 v[168:183], v[192:195], v[160:163], v[168:183]
    s_waitcnt lgkmcnt(0)
    v_mfma_f32_32x32x16_bf16 v[168:183], v[196:199], v[164:167], v[168:183]
    s_waitcnt vmcnt(2)
    s_branch k1_stepend
k1_wa_K:
    ds_read_b64_tr_b16 v[184:185], v10 offset:0
    ds_read_b64_tr_b16 v[186:187], v10 offset:256
    ds_read_b64_tr_b16 v[188:189], v10 offset:1024
    ds_read_b64_tr_b16 v[190:191], v10 offset:1280
    ds_read_b64_tr_b16 v[192:193], v10 offset:2048
    ds_read_b64_tr_b16 v[194:195], v10 offset:2304
    ds_read_b64_tr_b16 v[196:197], v10 offset:3072
    ds_read_b64_tr_b16 v[198:199], v10 offset:3328
    s_waitcnt lgkmcnt(6)
    v_mfma_f32_32x32x16_bf16 v[168:183], v[184:187], v[24:27], 0
    v_lshlrev_b32 v13, 3, v5
    v_lshl_add_u32 v12, v4, 5, v13
    v_lshlrev_b32 v13, 2, v4
    s_lshr_b32 s61, s36, 5
    s_mul_i32 s61, s61, 2304
    s_add_u32 s61, s61, 3145728
    ds_read_b64_tr_b16 v[184:185], v10 offset:4096
    ds_read_b64_tr_b16 v[186:187], v10 offset:4352
    s_waitcnt lgkmcnt(6)
    v_mfma_f32_32x32x16_bf16 v[168:183], v[188:191], v[28:31], v[168:183]
    s_mov_b32 m0, s57
    s_add_u32 s57, s57, 1024
    buffer_load_dwordx4 v8, s[20:23], s59 offen lds
    s_add_u32 s59, s59, s58
    v_cvt_pk_bf16_f32 v200, v200, v201
    ds_read_b64_tr_b16 v[188:189], v10 offset:5120
    ds_read_b64_tr_b16 v[190:191], v10 offset:5376
    s_waitcnt lgkmcnt(6)
    v_mfma_f32_32x32x16_bf16 v[168:183], v[192:195], v[32:35], v[168:183]
    v_cvt_pk_bf16_f32 v201, v202, v203
    ds_read_b64_tr_b16 v[192:193], v10 offset:6144
    ds_read_b64_tr_b16 v[194:195], v10 offset:6400
    s_waitcnt lgkmcnt(6)
    v_mfma_f32_32x32x16_bf16 v[168:183], v[196:199], v[36:39], v[168:183]
    v_cvt_pk_bf16_f32 v202, v204, v205
    ds_read_b64_tr_b16 v[196:197], v10 offset:7168
    ds_read_b64_tr_b16 v[198:199], v10 offset:7424
    s_waitcnt lgkmcnt(6)
    v_mfma_f32_32x32x16_bf16 v[168:183], v[184:187], v[40:43], v[168:183]
    s_mov_b32 m0, s57
    s_add_u32 s57, s57, 1024
    buffer_load_dwordx4 v8, s[20:23], s59 offen lds
    s_add_u32 s59, s59, s58
    v_cvt_pk_bf16_f32 v203, v206, v207
    ds_read_b64_tr_b16 v[184:185], v10 offset:8192
    ds_read_b64_tr_b16 v[186:187], v10 offset:8448
    s_waitcnt lgkmcnt(6)
    v_mfma_f32_32x32x16_bf16 v[168:183], v[188:191], v[44:47], v[168:183]
    v_cvt_pk_bf16_f32 v204, v208, v209
    ds_read_b64_tr_b16 v[188:189], v10 offset:9216
    ds_read_b64_tr_b16 v[190:191], v10 offset:9472
    s_waitcnt lgkmcnt(6)
    v_mfma_f32_32x32x16_bf16 v[168:183], v[192:195], v[48:51], v[168:183]
    v_cvt_pk_bf16_f32 v205, v210, v211
    ds_read_b64_tr_b16 v[192:193], v10 offset:10240
    ds_read_b64_tr_b16 v[194:195], v10 offset:10496
    s_waitcnt lgkmcnt(6)
    v_mfma_f32_32x32x16_bf16 v[168:183], v[196:199], v[52:55], v[168:183]
    s_mov_b32 m0, s57
    s_add_u32 s57, s57, 1024
    buffer_load_dwordx4 v8, s[20:23], s59 offen lds
    s_add_u32 s59, s59, s58
    v_cvt_pk_bf16_f32 v206, v212, v213
    ds_read_b64_tr_b16 v[196:197], v10 offset:11264
    ds_read_b64_tr_b16 v[198:199], v10 offset:11520
    s_waitcnt lgkmcnt(6)
    v_mfma_f32_32x32x16_bf16 v[168:183], v[184:187], v[56:59], v[168:183]
    v_cvt_pk_bf16_f32 v207, v214, v215
    ds_read_b64_tr_b16 v[184:185], v10 offset:12288
    ds_read_b64_tr_b16 v[186:187], v10 offset:12544
    s_waitcnt lgkmcnt(6)
    v_mfma_f32_32x32x16_bf16 v[168:183], v[188:191], v[60:63], v[168:183]
    ds_read_b64_tr_b16 v[188:189], v10 offset:13312
    ds_read_b64_tr_b16 v[190:191], v10 offset:13568
    s_waitcnt lgkmcnt(6)
    v_mfma_f32_32x32x16_bf16 v[168:183], v[192:195], v[64:67], v[168:183]
    s_mov_b32 m0, s57
    s_add_u32 s57, s57, 1024
    buffer_load_dwordx4 v8, s[20:23], s59 offen lds
    s_add_u32 s59, s59, s58
    ds_read_b64_tr_b16 v[192:193], v10 offset:14336
    ds_read_b64_tr_b16 v[194:195], v10 offset:14592
    s_waitcnt lgkmcnt(6)
    v_mfma_f32_32x32x16_bf16 v[168:183], v[196:199], v[68:71], v[168:183]
    ds_read_b64_tr_b16 v[196:197], v10 offset:15360
    ds_read_b64_tr_b16 v[198:199], v10 offset:15616
    s_waitcnt lgkmcnt(6)
    v_mfma_f32_32x32x16_bf16 v[168:183], v[184:187], v[72:75], v[168:183]
    ds_read_b64_tr_b16 v[184:185], v10 offset:16384
    ds_read_b64_tr_b16 v[186:187], v10 offset:16640
    s_waitcnt lgkmcnt(6)
    v_mfma_f32_32x32x16_bf16 v[168:183], v[188:191], v[76:79], v[168:183]
    s_mov_b32 m0, s57
    s_add_u32 s57, s57, 1024
    buffer_load_dwordx4 v8, s[20:23], s59 offen lds
    s_add_u32 s59, s59, s58
    ds_read_b64_tr_b16 v[188:189], v10 offset:17408
    ds_read_b64_tr_b16 v[190:191], v10 offset:17664
    s_waitcnt lgkmcnt(6)
    v_mfma_f32_32x32x16_bf16 v[168:183], v[192:195], v[80:83], v[168:183]
    ds_read_b64_tr_b16 v[192:193], v10 offset:18432
    ds_read_b64_tr_b16 v[194:195], v10 offset:18688
    s_waitcnt lgkmcnt(6)
    v_mfma_f32_32x32x16_bf16 v[168:183], v[196:199], v[84:87], v[168:183]
    ds_read_b64_tr_b16 v[196:197], v10 offset:19456
    ds_read_b64_tr_b16 v[198:199], v10 offset:19712
    s_waitcnt lgkmcnt(6)
    v_mfma_f32_32x32x16_bf16 v[168:183], v[184:187], v[88:91], v[168:183]
    s_mov_b32 m0, s57
    s_add_u32 s57, s57, 1024
    buffer_load_dwordx4 v8, s[20:23], s59 offen lds
    s_add_u32 s59, s59, s58
    ds_read_b64_tr_b16 v[184:185], v10 offset:20480
    ds_read_b64_tr_b16 v[186:187], v10 offset:20736
    s_waitcnt lgkmcnt(6)
    v_mfma_f32_32x32x16_bf16 v[168:183], v[188:191], v[92:95], v[168:183]
    ds_read_b64_tr_b16 v[188:189], v10 offset:21504
    ds_read_b64_tr_b16 v[190:191], v10 offset:21760
    s_waitcnt lgkmcnt(6)
    v_mfma_f32_32x32x16_bf16 v[168:183], v[192:195], v[96:99], v[168:183]
    ds_read_b64_tr_b16 v[192:193], v10 offset:22528
    ds_read_b64_tr_b16 v[194:195], v10 offset:22784
    s_waitcnt lgkmcnt(6)
    v_mfma_f32_32x32x16_bf16 v[168:183], v[196:199], v[100:103], v[168:183]
    s_mov_b32 m0, s57
    s_add_u32 s57, s57, 1024
    buffer_load_dwordx4 v8, s[20:23], s59 offen lds
    s_add_u32 s59, s59, s58
    ds_read_b64_tr_b16 v[196:197], v10 offset:23552
    ds_read_b64_tr_b16 v[198:199], v10 offset:23808
    s_waitcnt lgkmcnt(6)
    v_mfma_f32_32x32x16_bf16 v[168:183], v[184:187], v[104:107], v[168:183]
    ds_read_b64_tr_b16 v[184:185], v10 offset:24576
    ds_read_b64_tr_b16 v[186:187], v10 offset:24832
    s_waitcnt lgkmcnt(6)
    v_mfma_f32_32x32x16_bf16 v[168:183], v[188:191], v[108:111], v[168:183]
    ds_read_b64_tr_b16 v[188:189], v10 offset:25600
    ds_read_b64_tr_b16 v[190:191], v10 offset:25856
    s_waitcnt lgkmcnt(6)
    v_mfma_f32_32x32x16_bf16 v[168:183], v[192:195], v[112:115], v[168:183]
    s_mov_b32 m0, s57
    s_add_u32 s57, s57, 1024
    buffer_load_dwordx4 v8, s[20:23], s59 offen lds
    s_add_u32 s59, s59, s58
    ds_read_b64_tr_b16 v[192:193], v10 offset:26624
    ds_read_b64_tr_b16 v[194:195], v10 offset:26880
    s_waitcnt lgkmcnt(6)
    v_mfma_f32_32x32x16_bf16 v[168:183], v[196:199], v[116:119], v[168:183]
    ds_read_b64_tr_b16 v[196:197], v10 offset:27648
    ds_read_b64_tr_b16 v[198:199], v10 offset:27904
    s_waitcnt lgkmcnt(6)
    v_mfma_f32_32x32x16_bf16 v[168:183], v[184:187], v[120:123], v[168:183]
    ds_read_b64_tr_b16 v[184:185], v10 offset:28672
    ds_read_b64_tr_b16 v[186:187], v10 offset:28928
    s_waitcnt lgkmcnt(6)
    v_mfma_f32_32x32x16_bf16 v[168:183], v[188:191], v[124:127], v[168:183]
    s_mov_b32 m0, s57
    s_add_u32 s57, s57, 1024
    buffer_load_dwordx4 v8, s[20:23], s59 offen lds
    s_add_u32 s59, s59, s58
    ds_read_b64_tr_b16 v[188:189], v10 offset:29696
    ds_read_b64_tr_b16 v[190:191], v10 offset:29952
    s_waitcnt lgkmcnt(6)
    v_mfma_f32_32x32x16_bf16 v[168:183], v[192:195], v[128:131], v[168:183]
    ds_read_b64_tr_b16 v[192:193], v10 offset:30720
    ds_read_b64_tr_b16 v[194:195], v10 offset:30976
    s_waitcnt lgkmcnt(6)
    v_mfma_f32_32x32x16_bf16 v[168:183], v[196:199], v[132:135], v[168:183]
    buffer_store_dwordx2 v[200:201], v12, s[24:27], s61 offen offset:0
    ds_read_b64_tr_b16 v[196:197], v10 offset:31744
    ds_read_b64_tr_b16 v[198:199], v10 offset:32000
    s_waitcnt lgkmcnt(6)
    v_mfma_f32_32x32x16_bf16 v[168:183], v[184:187], v[136:139], v[168:183]
    buffer_store_dwordx2 v[202:203], v12, s[24:27], s61 offen offset:16
    ds_read_b64_tr_b16 v[184:185], v10 offset:32768
    ds_read_b64_tr_b16 v[186:187], v10 offset:33024
    s_waitcnt lgkmcnt(6)
    v_mfma_f32_32x32x16_bf16 v[168:183], v[188:191], v[140:143], v[168:183]
    s_mov_b32 exec_hi, 0
    buffer_store_dword v204, v13, s[24:27], s61 offen offset:1024
    s_mov_b64 exec, -1
    ds_read_b64_tr_b16 v[188:189], v10 offset:33792
    ds_read_b64_tr_b16 v[190:191], v10 offset:34048
    s_waitcnt lgkmcnt(6)
    v_mfma_f32_32x32x16_bf16 v[168:183], v[192:195], v[144:147], v[168:183]
    ds_read_b64_tr_b16 v[192:193], v10 offset:34816
    ds_read_b64_tr_b16 v[194:195], v10 offset:35072
    s_waitcnt lgkmcnt(6)
    v_mfma_f32_32x32x16_bf16 v[168:183], v[196:199], v[148:151], v[168:183]
    ds_read_b64_tr_b16 v[196:197], v10 offset:35840
    ds_read_b64_tr_b16 v[198:199], v10 offset:36096
    s_waitcnt lgkmcnt(6)
    v_mfma_f32_32x32x16_bf16 v[168:183], v[184:187], v[152:155], v[168:183]
    s_waitcnt lgkmcnt(4)
    v_mfma_f32_32x32x16_bf16 v[168:183], v[188:191], v[156:159], v[168:183]
    s_waitcnt lgkmcnt(2)
    v_mfma_f32_32x32x16_bf16 v[168:183], v[192:195], v[160:163], v[168:183]
    s_waitcnt lgkmcnt(0)
    v_mfma_f32_32x32x16_bf16 v[168:183], v[196:199], v[164:167], v[168:183]
    s_waitcnt vmcnt(3)
    s_branch k1_stepend
k1_wa_V:
    ds_read_b64_tr_b16 v[184:185], v10 offset:0
    ds_read_b64_tr_b16 v[186:187], v10 offset:256
    ds_read_b64_tr_b16 v[188:189], v10 offset:1024
    ds_read_b64_tr_b16 v[190:191], v10 offset:1280
    ds_read_b64_tr_b16 v[192:193], v10 offset:2048
    ds_read_b64_tr_b16 v[194:195], v10 offset:2304
    ds_read_b64_tr_b16 v[196:197], v10 offset:3072
    ds_read_b64_tr_b16 v[198:199], v10 offset:3328
    s_waitcnt lgkmcnt(6)
    v_mfma_f32_32x32x16_bf16 v[168:183], v[184:187], v[24:27], 0
    s_movk_i32 s39, 288
    v_mul_u32_u24 v13, s39, v5
    v_lshl_add_u32 v12, v4, 4, v13
    s_lshr_b32 s61, s36, 5
    s_mul_i32 s61, s61, 2304
    s_add_u32 s61, s61, 3146880
    ds_read_b64_tr_b16 v[184:185], v10 offset:4096
    ds_read_b64_tr_b16 v[186:187], v10 offset:4352
    s_waitcnt lgkmcnt(6)
    v_mfma_f32_32x32x16_bf16 v[168:183], v[188:191], v[28:31], v[168:183]
    s_mov_b32 m0, s57
    s_add_u32 s57, s57, 1024
    buffer_load_dwordx4 v8, s[20:23], s59 offen lds
    s_add_u32 s59, s59, s58
    v_cvt_pk_bf16_f32 v200, v200, v201
    ds_read_b64_tr_b16 v[188:189], v10 offset:5120
    ds_read_b64_tr_b16 v[190:191], v10 offset:5376
    s_waitcnt lgkmcnt(6)
    v_mfma_f32_32x32x16_bf16 v[168:183], v[192:195], v[32:35], v[168:183]
    v_cvt_pk_bf16_f32 v201, v202, v203
    ds_read_b64_tr_b16 v[192:193], v10 offset:6144
    ds_read_b64_tr_b16 v[194:195], v10 offset:6400
    s_waitcnt lgkmcnt(6)
    v_mfma_f32_32x32x16_bf16 v[168:183], v[196:199], v[36:39], v[168:183]
    v_cvt_pk_bf16_f32 v202, v204, v205
    ds_read_b64_tr_b16 v[196:197], v10 offset:7168
    ds_read_b64_tr_b16 v[198:199], v10 offset:7424
    s_waitcnt lgkmcnt(6)
    v_mfma_f32_32x32x16_bf16 v[168:183], v[184:187], v[40:43], v[168:183]
    s_mov_b32 m0, s57
    s_add_u32 s57, s57, 1024
    buffer_load_dwordx4 v8, s[20:23], s59 offen lds
    s_add_u32 s59, s59, s58
    v_cvt_pk_bf16_f32 v203, v206, v207
    ds_read_b64_tr_b16 v[184:185], v10 offset:8192
    ds_read_b64_tr_b16 v[186:187], v10 offset:8448
    s_waitcnt lgkmcnt(6)
    v_mfma_f32_32x32x16_bf16 v[168:183], v[188:191], v[44:47], v[168:183]
    v_cvt_pk_bf16_f32 v204, v208, v209
    ds_read_b64_tr_b16 v[188:189], v10 offset:9216
    ds_read_b64_tr_b16 v[190:191], v10 offset:9472
    s_waitcnt lgkmcnt(6)
    v_mfma_f32_32x32x16_bf16 v[168:183], v[192:195], v[48:51], v[168:183]
    v_cvt_pk_bf16_f32 v205, v210, v211
    ds_read_b64_tr_b16 v[192:193], v10 offset:10240
    ds_read_b64_tr_b16 v[194:195], v10 offset:10496
    s_waitcnt lgkmcnt(6)
    v_mfma_f32_32x32x16_bf16 v[168:183], v[196:199], v[52:55], v[168:183]
    s_mov_b32 m0, s57
    s_add_u32 s57, s57, 1024
    buffer_load_dwordx4 v8, s[20:23], s59 offen lds
    s_add_u32 s59, s59, s58
    v_cvt_pk_bf16_f32 v206, v212, v213
    ds_read_b64_tr_b16 v[196:197], v10 offset:11264
    ds_read_b64_tr_b16 v[198:199], v10 offset:11520
    s_waitcnt lgkmcnt(6)
    v_mfma_f32_32x32x16_bf16 v[168:183], v[184:187], v[56:59], v[168:183]
    v_cvt_pk_bf16_f32 v207, v214, v215
    ds_read_b64_tr_b16 v[184:185], v10 offset:12288
    ds_read_b64_tr_b16 v[186:187], v10 offset:12544
    s_waitcnt lgkmcnt(6)
    v_mfma_f32_32x32x16_bf16 v[168:183], v[188:191], v[60:63], v[168:183]
    ds_read_b64_tr_b16 v[188:189], v10 offset:13312
    ds_read_b64_tr_b16 v[190:191], v10 offset:13568
    s_waitcnt lgkmcnt(6)
    v_mfma_f32_32x32x16_bf16 v[168:183], v[192:195], v[64:67], v[168:183]
    s_mov_b32 m0, s57
    s_add_u32 s57, s57, 1024
    buffer_load_dwordx4 v8, s[20:23], s59 offen lds
    s_add_u32 s59, s59, s58
    ds_read_b64_tr_b16 v[192:193], v10 offset:14336
    ds_read_b64_tr_b16 v[194:195], v10 offset:14592
    s_waitcnt lgkmcnt(6)
    v_mfma_f32_32x32x16_bf16 v[168:183], v[196:199], v[68:71], v[168:183]
    ds_read_b64_tr_b16 v[196:197], v10 offset:15360
    ds_read_b64_tr_b16 v[198:199], v10 offset:15616
    s_waitcnt lgkmcnt(6)
    v_mfma_f32_32x32x16_bf16 v[168:183], v[184:187], v[72:75], v[168:183]
    ds_read_b64_tr_b16 v[184:185], v10 offset:16384
    ds_read_b64_tr_b16 v[186:187], v10 offset:16640
    s_waitcnt lgkmcnt(6)
    v_mfma_f32_32x32x16_bf16 v[168:183], v[188:191], v[76:79], v[168:183]
    s_mov_b32 m0, s57
    s_add_u32 s57, s57, 1024
    buffer_load_dwordx4 v8, s[20:23], s59 offen lds
    s_add_u32 s59, s59, s58
    ds_read_b64_tr_b16 v[188:189], v10 offset:17408
    ds_read_b64_tr_b16 v[190:191], v10 offset:17664
    s_waitcnt lgkmcnt(6)
    v_mfma_f32_32x32x16_bf16 v[168:183], v[192:195], v[80:83], v[168:183]
    ds_read_b64_tr_b16 v[192:193], v10 offset:18432
    ds_read_b64_tr_b16 v[194:195], v10 offset:18688
    s_waitcnt lgkmcnt(6)
    v_mfma_f32_32x32x16_bf16 v[168:183], v[196:199], v[84:87], v[168:183]
    ds_read_b64_tr_b16 v[196:197], v10 offset:19456
    ds_read_b64_tr_b16 v[198:199], v10 offset:19712
    s_waitcnt lgkmcnt(6)
    v_mfma_f32_32x32x16_bf16 v[168:183], v[184:187], v[88:91], v[168:183]
    s_mov_b32 m0, s57
    s_add_u32 s57, s57, 1024
    buffer_load_dwordx4 v8, s[20:23], s59 offen lds
    s_add_u32 s59, s59, s58
    ds_read_b64_tr_b16 v[184:185], v10 offset:20480
    ds_read_b64_tr_b16 v[186:187], v10 offset:20736
    s_waitcnt lgkmcnt(6)
    v_mfma_f32_32x32x16_bf16 v[168:183], v[188:191], v[92:95], v[168:183]
    ds_read_b64_tr_b16 v[188:189], v10 offset:21504
    ds_read_b64_tr_b16 v[190:191], v10 offset:21760
    s_waitcnt lgkmcnt(6)
    v_mfma_f32_32x32x16_bf16 v[168:183], v[192:195], v[96:99], v[168:183]
    ds_read_b64_tr_b16 v[192:193], v10 offset:22528
    ds_read_b64_tr_b16 v[194:195], v10 offset:22784
    s_waitcnt lgkmcnt(6)
    v_mfma_f32_32x32x16_bf16 v[168:183], v[196:199], v[100:103], v[168:183]
    s_mov_b32 m0, s57
    s_add_u32 s57, s57, 1024
    buffer_load_dwordx4 v8, s[20:23], s59 offen lds
    s_add_u32 s59, s59, s58
    ds_read_b64_tr_b16 v[196:197], v10 offset:23552
    ds_read_b64_tr_b16 v[198:199], v10 offset:23808
    s_waitcnt lgkmcnt(6)
    v_mfma_f32_32x32x16_bf16 v[168:183], v[184:187], v[104:107], v[168:183]
    ds_read_b64_tr_b16 v[184:185], v10 offset:24576
    ds_read_b64_tr_b16 v[186:187], v10 offset:24832
    s_waitcnt lgkmcnt(6)
    v_mfma_f32_32x32x16_bf16 v[168:183], v[188:191], v[108:111], v[168:183]
    ds_read_b64_tr_b16 v[188:189], v10 offset:25600
    ds_read_b64_tr_b16 v[190:191], v10 offset:25856
    s_waitcnt lgkmcnt(6)
    v_mfma_f32_32x32x16_bf16 v[168:183], v[192:195], v[112:115], v[168:183]
    s_mov_b32 m0, s57
    s_add_u32 s57, s57, 1024
    buffer_load_dwordx4 v8, s[20:23], s59 offen lds
    s_add_u32 s59, s59, s58
    ds_read_b64_tr_b16 v[192:193], v10 offset:26624
    ds_read_b64_tr_b16 v[194:195], v10 offset:26880
    s_waitcnt lgkmcnt(6)
    v_mfma_f32_32x32x16_bf16 v[168:183], v[196:199], v[116:119], v[168:183]
    ds_read_b64_tr_b16 v[196:197], v10 offset:27648
    ds_read_b64_tr_b16 v[198:199], v10 offset:27904
    s_waitcnt lgkmcnt(6)
    v_mfma_f32_32x32x16_bf16 v[168:183], v[184:187], v[120:123], v[168:183]
    ds_read_b64_tr_b16 v[184:185], v10 offset:28672
    ds_read_b64_tr_b16 v[186:187], v10 offset:28928
    s_waitcnt lgkmcnt(6)
    v_mfma_f32_32x32x16_bf16 v[168:183], v[188:191], v[124:127], v[168:183]
    s_mov_b32 m0, s57
    s_add_u32 s57, s57, 1024
    buffer_load_dwordx4 v8, s[20:23], s59 offen lds
    s_add_u32 s59, s59, s58
    ds_read_b64_tr_b16 v[188:189], v10 offset:29696
    ds_read_b64_tr_b16 v[190:191], v10 offset:29952
    s_waitcnt lgkmcnt(6)
    v_mfma_f32_32x32x16_bf16 v[168:183], v[192:195], v[128:131], v[168:183]
    ds_read_b64_tr_b16 v[192:193], v10 offset:30720
    ds_read_b64_tr_b16 v[194:195], v10 offset:30976
    s_waitcnt lgkmcnt(6)
    v_mfma_f32_32x32x16_bf16 v[168:183], v[196:199], v[132:135], v[168:183]
    s_mov_b32 exec_lo, 0x3ffff
    s_mov_b32 exec_hi, 0x3ffff
    buffer_store_dwordx4 v[200:203], v12, s[24:27], s61 offen
    buffer_store_dwordx4 v[204:207], v12, s[24:27], s61 offen offset:576
    s_mov_b64 exec, -1
    ds_read_b64_tr_b16 v[196:197], v10 offset:31744
    ds_read_b64_tr_b16 v[198:199], v10 offset:32000
    s_waitcnt lgkmcnt(6)
    v_mfma_f32_32x32x16_bf16 v[168:183], v[184:187], v[136:139], v[168:183]
    ds_read_b64_tr_b16 v[184:185], v10 offset:32768
    ds_read_b64_tr_b16 v[186:187], v10 offset:33024
    s_waitcnt lgkmcnt(6)
    v_mfma_f32_32x32x16_bf16 v[168:183], v[188:191], v[140:143], v[168:183]
    ds_read_b64_tr_b16 v[188:189], v10 offset:33792
    ds_read_b64_tr_b16 v[190:191], v10 offset:34048
    s_waitcnt lgkmcnt(6)
    v_mfma_f32_32x32x16_bf16 v[168:183], v[192:195], v[144:147], v[168:183]
    ds_read_b64_tr_b16 v[192:193], v10 offset:34816
    ds_read_b64_tr_b16 v[194:195], v10 offset:35072
    s_waitcnt lgkmcnt(6)
    v_mfma_f32_32x32x16_bf16 v[168:183], v[196:199], v[148:151], v[168:183]
    ds_read_b64_tr_b16 v[196:197], v10 offset:35840
    ds_read_b64_tr_b16 v[198:199], v10 offset:36096
    s_waitcnt lgkmcnt(6)
    v_mfma_f32_32x32x16_bf16 v[168:183], v[184:187], v[152:155], v[168:183]
    s_waitcnt lgkmcnt(4)
    v_mfma_f32_32x32x16_bf16 v[168:183], v[188:191], v[156:159], v[168:183]
    s_waitcnt lgkmcnt(2)
    v_mfma_f32_32x32x16_bf16 v[168:183], v[192:195], v[160:163], v[168:183]
    s_waitcnt lgkmcnt(0)
    v_mfma_f32_32x32x16_bf16 v[168:183], v[196:199], v[164:167], v[168:183]
    s_waitcnt vmcnt(2)
    s_branch k1_stepend
k1_xa:
    s_cmp_eq_u32 s60, -1
    s_cbranch_scc1 k1_xa_none
    s_cmp_lt_u32 s60, 18
    s_cbranch_scc1 k1_xa_Q
    s_cmp_lt_u32 s60, 92
    s_cbranch_scc1 k1_xa_Z1
    ds_read_b64_tr_b16 v[184:185], v10 offset:0
    ds_read_b64_tr_b16 v[186:187], v10 offset:256
    ds_read_b64_tr_b16 v[188:189], v10 offset:1024
    ds_read_b64_tr_b16 v[190:191], v10 offset:1280
    ds_read_b64_tr_b16 v[192:193], v10 offset:2048
    ds_read_b64_tr_b16 v[194:195], v10 offset:2304
    ds_read_b64_tr_b16 v[196:197], v10 offset:3072
    ds_read_b64_tr_b16 v[198:199], v10 offset:3328
    s_waitcnt lgkmcnt(6)
    v_mfma_f32_32x32x16_bf16 v[168:183], v[24:27], v[184:187], 0
    v_lshlrev_b32 v13, 4, v5
    v_lshl_add_u32 v12, v4, 12, v13
    s_sub_u32 s40, s60, 92
    s_lshl_b32 s40, s40, 17
    s_lshl_b32 s61, s36, 1
    s_add_u32 s61, s61, s40
    s_add_u32 s61, s61, 14680064
    v_mul_f32 v16, v200, v200
    v_mul_f32 v17, v201, v201
    v_mul_f32 v18, v202, v202
    v_mul_f32 v19, v203, v203
    ds_read_b64_tr_b16 v[184:185], v10 offset:4096
    ds_read_b64_tr_b16 v[186:187], v10 offset:4352
    s_waitcnt lgkmcnt(6)
    v_mfma_f32_32x32x16_bf16 v[168:183], v[28:31], v[188:191], v[168:183]
    s_mov_b32 m0, s57
    s_add_u32 s57, s57, 1024
    buffer_load_dwordx4 v8, s[20:23], s59 offen lds
    s_add_u32 s59, s59, s58
    v_fma_f32 v16, v16, s44, v11
    v_fma_f32 v17, v17, s44, v11
    v_fma_f32 v18, v18, s44, v11
    v_fma_f32 v19, v19, s44, v11
    v_mul_f32 v16, v16, v200
    ds_read_b64_tr_b16 v[188:189], v10 offset:5120
    ds_read_b64_tr_b16 v[190:191], v10 offset:5376
    s_waitcnt lgkmcnt(6)
    v_mfma_f32_32x32x16_bf16 v[168:183], v[32:35], v[192:195], v[168:183]
    v_mul_f32 v17, v17, v201
    v_mul_f32 v18, v18, v202
    v_mul_f32 v19, v19, v203
    v_exp_f32 v16, v16
    v_exp_f32 v17, v17
    ds_read_b64_tr_b16 v[192:193], v10 offset:6144
    ds_read_b64_tr_b16 v[194:195], v10 offset:6400
    s_waitcnt lgkmcnt(6)
    v_mfma_f32_32x32x16_bf16 v[168:183], v[36:39], v[196:199], v[168:183]
    v_exp_f32 v18, v18
    v_exp_f32 v19, v19
    v_add_f32 v16, 1.0, v16
    v_add_f32 v17, 1.0, v17
    v_add_f32 v18, 1.0, v18
    ds_read_b64_tr_b16 v[196:197], v10 offset:7168
    ds_read_b64_tr_b16 v[198:199], v10 offset:7424
    s_waitcnt lgkmcnt(6)
    v_mfma_f32_32x32x16_bf16 v[168:183], v[40:43], v[184:187], v[168:183]
    s_mov_b32 m0, s57
    s_add_u32 s57, s57, 1024
    buffer_load_dwordx4 v8, s[20:23], s59 offen lds
    s_add_u32 s59, s59, s58
    v_add_f32 v19, 1.0, v19
    v_rcp_f32 v16, v16
    v_rcp_f32 v17, v17
    v_rcp_f32 v18, v18
    v_rcp_f32 v19, v19
    ds_read_b64_tr_b16 v[184:185], v10 offset:8192
    ds_read_b64_tr_b16 v[186:187], v10 offset:8448
    s_waitcnt lgkmcnt(6)
    v_mfma_f32_32x32x16_bf16 v[168:183], v[44:47], v[188:191], v[168:183]
    v_mul_f32 v200, v200, v16
    v_mul_f32 v201, v201, v17
    v_mul_f32 v202, v202, v18
    v_mul_f32 v203, v203, v19
    v_mul_f32 v16, v204, v204
    ds_read_b64_tr_b16 v[188:189], v10 offset:9216
    ds_read_b64_tr_b16 v[190:191], v10 offset:9472
    s_waitcnt lgkmcnt(6)
    v_mfma_f32_32x32x16_bf16 v[168:183], v[48:51], v[192:195], v[168:183]
    v_mul_f32 v17, v205, v205
    v_mul_f32 v18, v206, v206
    v_mul_f32 v19, v207, v207
    v_fma_f32 v16, v16, s44, v11
    v_fma_f32 v17, v17, s44, v11
    ds_read_b64_tr_b16 v[192:193], v10 offset:10240
    ds_read_b64_tr_b16 v[194:195], v10 offset:10496
    s_waitcnt lgkmcnt(6)
    v_mfma_f32_32x32x16_bf16 v[168:183], v[52:55], v[196:199], v[168:183]
    s_mov_b32 m0, s57
    s_add_u32 s57, s57, 1024
    buffer_load_dwordx4 v8, s[20:23], s59 offen lds
    s_add_u32 s59, s59, s58
    v_fma_f32 v18, v18, s44, v11
    v_fma_f32 v19, v19, s44, v11
    v_mul_f32 v16, v16, v204
    v_mul_f32 v17, v17, v205
    v_mul_f32 v18, v18, v206
    ds_read_b64_tr_b16 v[196:197], v10 offset:11264
    ds_read_b64_tr_b16 v[198:199], v10 offset:11520
    s_waitcnt lgkmcnt(6)
    v_mfma_f32_32x32x16_bf16 v[168:183], v[56:59], v[184:187], v[168:183]
    v_mul_f32 v19, v19, v207
    v_exp_f32 v16, v16
    v_exp_f32 v17, v17
    v_exp_f32 v18, v18
    v_exp_f32 v19, v19
    ds_read_b64_tr_b16 v[184:185], v10 offset:12288
    ds_read_b64_tr_b16 v[186:187], v10 offset:12544
    s_waitcnt lgkmcnt(6)
    v_mfma_f32_32x32x16_bf16 v[168:183], v[60:63], v[188:191], v[168:183]
    v_add_f32 v16, 1.0, v16
    v_add_f32 v17, 1.0, v17
    v_add_f32 v18, 1.0, v18
    v_add_f32 v19, 1.0, v19
    v_rcp_f32 v16, v16
    ds_read_b64_tr_b16 v[188:189], v10 offset:13312
    ds_read_b64_tr_b16 v[190:191], v10 offset:13568
    s_waitcnt lgkmcnt(6)
    v_mfma_f32_32x32x16_bf16 v[168:183], v[64:67], v[192:195], v[168:183]
    s_mov_b32 m0, s57
    s_add_u32 s57, s57, 1024
    buffer_load_dwordx4 v8, s[20:23], s59 offen lds
    s_add_u32 s59, s59, s58
    v_rcp_f32 v17, v17
    v_rcp_f32 v18, v18
    v_rcp_f32 v19, v19
    v_mul_f32 v204, v204, v16
    v_mul_f32 v205, v205, v17
    ds_read_b64_tr_b16 v[192:193], v10 offset:14336
    ds_read_b64_tr_b16 v[194:195], v10 offset:14592
    s_waitcnt lgkmcnt(6)
    v_mfma_f32_32x32x16_bf16 v[168:183], v[68:71], v[196:199], v[168:183]
    v_mul_f32 v206, v206, v18
    v_mul_f32 v207, v207, v19
    v_mul_f32 v16, v208, v208
    v_mul_f32 v17, v209, v209
    v_mul_f32 v18, v210, v210
    ds_read_b64_tr_b16 v[196:197], v10 offset:15360
    ds_read_b64_tr_b16 v[198:199], v10 offset:15616
    s_waitcnt lgkmcnt(6)
    v_mfma_f32_32x32x16_bf16 v[168:183], v[72:75], v[184:187], v[168:183]
    v_mul_f32 v19, v211, v211
    v_fma_f32 v16, v16, s44, v11
    v_fma_f32 v17, v17, s44, v11
    v_fma_f32 v18, v18, s44, v11
    v_fma_f32 v19, v19, s44, v11
    ds_read_b64_tr_b16 v[184:185], v10 offset:16384
    ds_read_b64_tr_b16 v[186:187], v10 offset:16640
    s_waitcnt lgkmcnt(6)
    v_mfma_f32_32x32x16_bf16 v[168:183], v[76:79], v[188:191], v[168:183]
    s_mov_b32 m0, s57
    s_add_u32 s57, s57, 1024
    buffer_load_dwordx4 v8, s[20:23], s59 offen lds
    s_add_u32 s59, s59, s58
    v_mul_f32 v16, v16, v208
    v_mul_f32 v17, v17, v209
    v_mul_f32 v18, v18, v210
    v_mul_f32 v19, v19, v211
    v_exp_f32 v16, v16
    ds_read_b64_tr_b16 v[188:189], v10 offset:17408
    ds_read_b64_tr_b16 v[190:191], v10 offset:17664
    s_waitcnt lgkmcnt(6)
    v_mfma_f32_32x32x16_bf16 v[168:183], v[80:83], v[192:195], v[168:183]
    v_exp_f32 v17, v17
    v_exp_f32 v18, v18
    v_exp_f32 v19, v19
    v_add_f32 v16, 1.0, v16
    v_add_f32 v17, 1.0, v17
    ds_read_b64_tr_b16 v[192:193], v10 offset:18432
    ds_read_b64_tr_b16 v[194:195], v10 offset:18688
    s_waitcnt lgkmcnt(6)
    v_mfma_f32_32x32x16_bf16 v[168:183], v[84:87], v[196:199], v[168:183]
    v_add_f32 v18, 1.0, v18
    v_add_f32 v19, 1.0, v19
    v_rcp_f32 v16, v16
    v_rcp_f32 v17, v17
    v_rcp_f32 v18, v18
    ds_read_b64_tr_b16 v[196:197], v10 offset:19456
    ds_read_b64_tr_b16 v[198:199], v10 offset:19712
    s_waitcnt lgkmcnt(6)
    v_mfma_f32_32x32x16_bf16 v[168:183], v[88:91], v[184:187], v[168:183]
    s_mov_b32 m0, s57
    s_add_u32 s57, s57, 1024
    buffer_load_dwordx4 v8, s[20:23], s59 offen lds
    s_add_u32 s59, s59, s58
    v_rcp_f32 v19, v19
    v_mul_f32 v208, v208, v16
    v_mul_f32 v209, v209, v17
    v_mul_f32 v210, v210, v18
    v_mul_f32 v211, v211, v19
    ds_read_b64_tr_b16 v[184:185], v10 offset:20480
    ds_read_b64_tr_b16 v[186:187], v10 offset:20736
    s_waitcnt lgkmcnt(6)
    v_mfma_f32_32x32x16_bf16 v[168:183], v[92:95], v[188:191], v[168:183]
    v_mul_f32 v16, v212, v212
    v_mul_f32 v17, v213, v213
    v_mul_f32 v18, v214, v214
    v_mul_f32 v19, v215, v215
    v_fma_f32 v16, v16, s44, v11
    ds_read_b64_tr_b16 v[188:189], v10 offset:21504
    ds_read_b64_tr_b16 v[190:191], v10 offset:21760
    s_waitcnt lgkmcnt(6)
    v_mfma_f32_32x32x16_bf16 v[168:183], v[96:99], v[192:195], v[168:183]
    v_fma_f32 v17, v17, s44, v11
    v_fma_f32 v18, v18, s44, v11
    v_fma_f32 v19, v19, s44, v11
    v_mul_f32 v16, v16, v212
    v_mul_f32 v17, v17, v213
    ds_read_b64_tr_b16 v[192:193], v10 offset:22528
    ds_read_b64_tr_b16 v[194:195], v10 offset:22784
    s_waitcnt lgkmcnt(6)
    v_mfma_f32_32x32x16_bf16 v[168:183], v[100:103], v[196:199], v[168:183]
    s_mov_b32 m0, s57
    s_add_u32 s57, s57, 1024
    buffer_load_dwordx4 v8, s[20:23], s59 offen lds
    s_add_u32 s59, s59, s58
    v_mul_f32 v18, v18, v214
    v_mul_f32 v19, v19, v215
    v_exp_f32 v16, v16
    v_exp_f32 v17, v17
    v_exp_f32 v18, v18
    ds_read_b64_tr_b16 v[196:197], v10 offset:23552
    ds_read_b64_tr_b16 v[198:199], v10 offset:23808
    s_waitcnt lgkmcnt(6)
    v_mfma_f32_32x32x16_bf16 v[168:183], v[104:107], v[184:187], v[168:183]
    v_exp_f32 v19, v19
    v_add_f32 v16, 1.0, v16
    v_add_f32 v17, 1.0, v17
    v_add_f32 v18, 1.0, v18
    v_add_f32 v19, 1.0, v19
    ds_read_b64_tr_b16 v[184:185], v10 offset:24576
    ds_read_b64_tr_b16 v[186:187], v10 offset:24832
    s_waitcnt lgkmcnt(6)
    v_mfma_f32_32x32x16_bf16 v[168:183], v[108:111], v[188:191], v[168:183]
    v_rcp_f32 v16, v16
    v_rcp_f32 v17, v17
    v_rcp_f32 v18, v18
    v_rcp_f32 v19, v19
    v_mul_f32 v212, v212, v16
    ds_read_b64_tr_b16 v[188:189], v10 offset:25600
    ds_read_b64_tr_b16 v[190:191], v10 offset:25856
    s_waitcnt lgkmcnt(6)
    v_mfma_f32_32x32x16_bf16 v[168:183], v[112:115], v[192:195], v[168:183]
    s_mov_b32 m0, s57
    s_add_u32 s57, s57, 1024
    buffer_load_dwordx4 v8, s[20:23], s59 offen lds
    s_add_u32 s59, s59, s58
    v_mul_f32 v213, v213, v17
    v_mul_f32 v214, v214, v18
    v_mul_f32 v215, v215, v19
    v_add_f32 v216, v216, v200
    v_fma_f32 v217, v200, v200, v217
    ds_read_b64_tr_b16 v[192:193], v10 offset:26624
    ds_read_b64_tr_b16 v[194:195], v10 offset:26880
    s_waitcnt lgkmcnt(6)
    v_mfma_f32_32x32x16_bf16 v[168:183], v[116:119], v[196:199], v[168:183]
    v_add_f32 v218, v218, v201
    v_fma_f32 v219, v201, v201, v219
    v_add_f32 v220, v220, v202
    v_fma_f32 v221, v202, v202, v221
    v_add_f32 v222, v222, v203
    ds_read_b64_tr_b16 v[196:197], v10 offset:27648
    ds_read_b64_tr_b16 v[198:199], v10 offset:27904
    s_waitcnt lgkmcnt(6)
    v_mfma_f32_32x32x16_bf16 v[168:183], v[120:123], v[184:187], v[168:183]
    v_fma_f32 v223, v203, v203, v223
    v_add_f32 v224, v224, v204
    v_fma_f32 v225, v204, v204, v225
    v_add_f32 v226, v226, v205
    v_fma_f32 v227, v205, v205, v227
    ds_read_b64_tr_b16 v[184:185], v10 offset:28672
    ds_read_b64_tr_b16 v[186:187], v10 offset:28928
    s_waitcnt lgkmcnt(6)
    v_mfma_f32_32x32x16_bf16 v[168:183], v[124:127], v[188:191], v[168:183]
    s_mov_b32 m0, s57
    s_add_u32 s57, s57, 1024
    buffer_load_dwordx4 v8, s[20:23], s59 offen lds
    s_add_u32 s59, s59, s58
    v_add_f32 v228, v228, v206
    v_fma_f32 v229, v206, v206, v229
    v_add_f32 v230, v230, v207
    v_fma_f32 v231, v207, v207, v231
    v_add_f32 v232, v232, v208
    ds_read_b64_tr_b16 v[188:189], v10 offset:29696
    ds_read_b64_tr_b16 v[190:191], v10 offset:29952
    s_waitcnt lgkmcnt(6)
    v_mfma_f32_32x32x16_bf16 v[168:183], v[128:131], v[192:195], v[168:183]
    v_fma_f32 v233, v208, v208, v233
    v_add_f32 v234, v234, v209
    v_fma_f32 v235, v209, v209, v235
    v_add_f32 v236, v236, v210
    v_fma_f32 v237, v210, v210, v237
    ds_read_b64_tr_b16 v[192:193], v10 offset:30720
    ds_read_b64_tr_b16 v[194:195], v10 offset:30976
    s_waitcnt lgkmcnt(6)
    v_mfma_f32_32x32x16_bf16 v[168:183], v[132:135], v[196:199], v[168:183]
    v_add_f32 v238, v238, v211
    v_fma_f32 v239, v211, v211, v239
    v_add_f32 v240, v240, v212
    v_fma_f32 v241, v212, v212, v241
    v_add_f32 v242, v242, v213
    ds_read_b64_tr_b16 v[196:197], v10 offset:31744
    ds_read_b64_tr_b16 v[198:199], v10 offset:32000
    s_waitcnt lgkmcnt(6)
    v_mfma_f32_32x32x16_bf16 v[168:183], v[136:139], v[184:187], v[168:183]
    v_fma_f32 v243, v213, v213, v243
    v_add_f32 v244, v244, v214
    v_fma_f32 v245, v214, v214, v245
    v_add_f32 v246, v246, v215
    v_fma_f32 v247, v215, v215, v247
    ds_read_b64_tr_b16 v[184:185], v10 offset:32768
    ds_read_b64_tr_b16 v[186:187], v10 offset:33024
    s_waitcnt lgkmcnt(6)
    v_mfma_f32_32x32x16_bf16 v[168:183], v[140:143], v[188:191], v[168:183]
    v_cvt_pk_bf16_f32 v200, v200, v201
    v_cvt_pk_bf16_f32 v201, v202, v203
    v_cvt_pk_bf16_f32 v202, v204, v205
    v_cvt_pk_bf16_f32 v203, v206, v207
    v_cvt_pk_bf16_f32 v204, v208, v209
    ds_read_b64_tr_b16 v[188:189], v10 offset:33792
    ds_read_b64_tr_b16 v[190:191], v10 offset:34048
    s_waitcnt lgkmcnt(6)
    v_mfma_f32_32x32x16_bf16 v[168:183], v[144:147], v[192:195], v[168:183]
    v_cvt_pk_bf16_f32 v205, v210, v211
    v_cvt_pk_bf16_f32 v206, v212, v213
    v_cvt_pk_bf16_f32 v207, v214, v215
    s_nop 1
    v_permlane32_swap_b32 v200, v202
    v_permlane32_swap_b32 v201, v203
    ds_read_b64_tr_b16 v[192:193], v10 offset:34816
    ds_read_b64_tr_b16 v[194:195], v10 offset:35072
    s_waitcnt lgkmcnt(6)
    v_mfma_f32_32x32x16_bf16 v[168:183], v[148:151], v[196:199], v[168:183]
    v_permlane32_swap_b32 v204, v206
    v_permlane32_swap_b32 v205, v207
    buffer_store_dwordx4 v[200:203], v12, s[24:27], s61 offen offset:0
    ds_read_b64_tr_b16 v[196:197], v10 offset:35840
    ds_read_b64_tr_b16 v[198:199], v10 offset:36096
    s_waitcnt lgkmcnt(6)
    v_mfma_f32_32x32x16_bf16 v[168:183], v[152:155], v[184:187], v[168:183]
    buffer_store_dwordx4 v[204:207], v12, s[24:27], s61 offen offset:32
    s_waitcnt lgkmcnt(4)
    v_mfma_f32_32x32x16_bf16 v[168:183], v[156:159], v[188:191], v[168:183]
    s_waitcnt lgkmcnt(2)
    v_mfma_f32_32x32x16_bf16 v[168:183], v[160:163], v[192:195], v[168:183]
    s_waitcnt lgkmcnt(0)
    v_mfma_f32_32x32x16_bf16 v[168:183], v[164:167], v[196:199], v[168:183]
    s_waitcnt vmcnt(2)
    s_branch k1_stepend
k1_xa_none:
    ds_read_b64_tr_b16 v[184:185], v10 offset:0
    ds_read_b64_tr_b16 v[186:187], v10 offset:256
    ds_read_b64_tr_b16 v[188:189], v10 offset:1024
    ds_read_b64_tr_b16 v[190:191], v10 offset:1280
    ds_read_b64_tr_b16 v[192:193], v10 offset:2048
    ds_read_b64_tr_b16 v[194:195], v10 offset:2304
    ds_read_b64_tr_b16 v[196:197], v10 offset:3072
    ds_read_b64_tr_b16 v[198:199], v10 offset:3328
    s_waitcnt lgkmcnt(6)
    v_mfma_f32_32x32x16_bf16 v[168:183], v[24:27], v[184:187], 0
    ds_read_b64_tr_b16 v[184:185], v10 offset:4096
    ds_read_b64_tr_b16 v[186:187], v10 offset:4352
    s_waitcnt lgkmcnt(6)
    v_mfma_f32_32x32x16_bf16 v[168:183], v[28:31], v[188:191], v[168:183]
    s_mov_b32 m0, s57
    s_add_u32 s57, s57, 1024
    buffer_load_dwordx4 v8, s[20:23], s59 offen lds
    s_add_u32 s59, s59, s58
    ds_read_b64_tr_b16 v[188:189], v10 offset:5120
    ds_read_b64_tr_b16 v[190:191], v10 offset:5376
    s_waitcnt lgkmcnt(6)
    v_mfma_f32_32x32x16_bf16 v[168:183], v[32:35], v[192:195], v[168:183]
    ds_read_b64_tr_b16 v[192:193], v10 offset:6144
    ds_read_b64_tr_b16 v[194:195], v10 offset:6400
    s_waitcnt lgkmcnt(6)
    v_mfma_f32_32x32x16_bf16 v[168:183], v[36:39], v[196:199], v[168:183]
    ds_read_b64_tr_b16 v[196:197], v10 offset:7168
    ds_read_b64_tr_b16 v[198:199], v10 offset:7424
    s_waitcnt lgkmcnt(6)
    v_mfma_f32_32x32x16_bf16 v[168:183], v[40:43], v[184:187], v[168:183]
    s_mov_b32 m0, s57
    s_add_u32 s57, s57, 1024
    buffer_load_dwordx4 v8, s[20:23], s59 offen lds
    s_add_u32 s59, s59, s58
    ds_read_b64_tr_b16 v[184:185], v10 offset:8192
    ds_read_b64_tr_b16 v[186:187], v10 offset:8448
    s_waitcnt lgkmcnt(6)
    v_mfma_f32_32x32x16_bf16 v[168:183], v[44:47], v[188:191], v[168:183]
    ds_read_b64_tr_b16 v[188:189], v10 offset:9216
    ds_read_b64_tr_b16 v[190:191], v10 offset:9472
    s_waitcnt lgkmcnt(6)
    v_mfma_f32_32x32x16_bf16 v[168:183], v[48:51], v[192:195], v[168:183]
    ds_read_b64_tr_b16 v[192:193], v10 offset:10240
    ds_read_b64_tr_b16 v[194:195], v10 offset:10496
    s_waitcnt lgkmcnt(6)
    v_mfma_f32_32x32x16_bf16 v[168:183], v[52:55], v[196:199], v[168:183]
    s_mov_b32 m0, s57
    s_add_u32 s57, s57, 1024
    buffer_load_dwordx4 v8, s[20:23], s59 offen lds
    s_add_u32 s59, s59, s58
    ds_read_b64_tr_b16 v[196:197], v10 offset:11264
    ds_read_b64_tr_b16 v[198:199], v10 offset:11520
    s_waitcnt lgkmcnt(6)
    v_mfma_f32_32x32x16_bf16 v[168:183], v[56:59], v[184:187], v[168:183]
    ds_read_b64_tr_b16 v[184:185], v10 offset:12288
    ds_read_b64_tr_b16 v[186:187], v10 offset:12544
    s_waitcnt lgkmcnt(6)
    v_mfma_f32_32x32x16_bf16 v[168:183], v[60:63], v[188:191], v[168:183]
    ds_read_b64_tr_b16 v[188:189], v10 offset:13312
    ds_read_b64_tr_b16 v[190:191], v10 offset:13568
    s_waitcnt lgkmcnt(6)
    v_mfma_f32_32x32x16_bf16 v[168:183], v[64:67], v[192:195], v[168:183]
    s_mov_b32 m0, s57
    s_add_u32 s57, s57, 1024
    buffer_load_dwordx4 v8, s[20:23], s59 offen lds
    s_add_u32 s59, s59, s58
    ds_read_b64_tr_b16 v[192:193], v10 offset:14336
    ds_read_b64_tr_b16 v[194:195], v10 offset:14592
    s_waitcnt lgkmcnt(6)
    v_mfma_f32_32x32x16_bf16 v[168:183], v[68:71], v[196:199], v[168:183]
    ds_read_b64_tr_b16 v[196:197], v10 offset:15360
    ds_read_b64_tr_b16 v[198:199], v10 offset:15616
    s_waitcnt lgkmcnt(6)
    v_mfma_f32_32x32x16_bf16 v[168:183], v[72:75], v[184:187], v[168:183]
    ds_read_b64_tr_b16 v[184:185], v10 offset:16384
    ds_read_b64_tr_b16 v[186:187], v10 offset:16640
    s_waitcnt lgkmcnt(6)
    v_mfma_f32_32x32x16_bf16 v[168:183], v[76:79], v[188:191], v[168:183]
    s_mov_b32 m0, s57
    s_add_u32 s57, s57, 1024
    buffer_load_dwordx4 v8, s[20:23], s59 offen lds
    s_add_u32 s59, s59, s58
    ds_read_b64_tr_b16 v[188:189], v10 offset:17408
    ds_read_b64_tr_b16 v[190:191], v10 offset:17664
    s_waitcnt lgkmcnt(6)
    v_mfma_f32_32x32x16_bf16 v[168:183], v[80:83], v[192:195], v[168:183]
    ds_read_b64_tr_b16 v[192:193], v10 offset:18432
    ds_read_b64_tr_b16 v[194:195], v10 offset:18688
    s_waitcnt lgkmcnt(6)
    v_mfma_f32_32x32x16_bf16 v[168:183], v[84:87], v[196:199], v[168:183]
    ds_read_b64_tr_b16 v[196:197], v10 offset:19456
    ds_read_b64_tr_b16 v[198:199], v10 offset:19712
    s_waitcnt lgkmcnt(6)
    v_mfma_f32_32x32x16_bf16 v[168:183], v[88:91], v[184:187], v[168:183]
    s_mov_b32 m0, s57
    s_add_u32 s57, s57, 1024
    buffer_load_dwordx4 v8, s[20:23], s59 offen lds
    s_add_u32 s59, s59, s58
    ds_read_b64_tr_b16 v[184:185], v10 offset:20480
    ds_read_b64_tr_b16 v[186:187], v10 offset:20736
    s_waitcnt lgkmcnt(6)
    v_mfma_f32_32x32x16_bf16 v[168:183], v[92:95], v[188:191], v[168:183]
    ds_read_b64_tr_b16 v[188:189], v10 offset:21504
    ds_read_b64_tr_b16 v[190:191], v10 offset:21760
    s_waitcnt lgkmcnt(6)
    v_mfma_f32_32x32x16_bf16 v[168:183], v[96:99], v[192:195], v[168:183]
    ds_read_b64_tr_b16 v[192:193], v10 offset:22528
    ds_read_b64_tr_b16 v[194:195], v10 offset:22784
    s_waitcnt lgkmcnt(6)
    v_mfma_f32_32x32x16_bf16 v[168:183], v[100:103], v[196:199], v[168:183]
    s_mov_b32 m0, s57
    s_add_u32 s57, s57, 1024
    buffer_load_dwordx4 v8, s[20:23], s59 offen lds
    s_add_u32 s59, s59, s58
    ds_read_b64_tr_b16 v[196:197], v10 offset:23552
    ds_read_b64_tr_b16 v[198:199], v10 offset:23808
    s_waitcnt lgkmcnt(6)
    v_mfma_f32_32x32x16_bf16 v[168:183], v[104:107], v[184:187], v[168:183]
    ds_read_b64_tr_b16 v[184:185], v10 offset:24576
    ds_read_b64_tr_b16 v[186:187], v10 offset:24832
    s_waitcnt lgkmcnt(6)
    v_mfma_f32_32x32x16_bf16 v[168:183], v[108:111], v[188:191], v[168:183]
    ds_read_b64_tr_b16 v[188:189], v10 offset:25600
    ds_read_b64_tr_b16 v[190:191], v10 offset:25856
    s_waitcnt lgkmcnt(6)
    v_mfma_f32_32x32x16_bf16 v[168:183], v[112:115], v[192:195], v[168:183]
    s_mov_b32 m0, s57
    s_add_u32 s57, s57, 1024
    buffer_load_dwordx4 v8, s[20:23], s59 offen lds
    s_add_u32 s59, s59, s58
    ds_read_b64_tr_b16 v[192:193], v10 offset:26624
    ds_read_b64_tr_b16 v[194:195], v10 offset:26880
    s_waitcnt lgkmcnt(6)
    v_mfma_f32_32x32x16_bf16 v[168:183], v[116:119], v[196:199], v[168:183]
    ds_read_b64_tr_b16 v[196:197], v10 offset:27648
    ds_read_b64_tr_b16 v[198:199], v10 offset:27904
    s_waitcnt lgkmcnt(6)
    v_mfma_f32_32x32x16_bf16 v[168:183], v[120:123], v[184:187], v[168:183]
    ds_read_b64_tr_b16 v[184:185], v10 offset:28672
    ds_read_b64_tr_b16 v[186:187], v10 offset:28928
    s_waitcnt lgkmcnt(6)
    v_mfma_f32_32x32x16_bf16 v[168:183], v[124:127], v[188:191], v[168:183]
    s_mov_b32 m0, s57
    s_add_u32 s57, s57, 1024
    buffer_load_dwordx4 v8, s[20:23], s59 offen lds
    s_add_u32 s59, s59, s58
    ds_read_b64_tr_b16 v[188:189], v10 offset:29696
    ds_read_b64_tr_b16 v[190:191], v10 offset:29952
    s_waitcnt lgkmcnt(6)
    v_mfma_f32_32x32x16_bf16 v[168:183], v[128:131], v[192:195], v[168:183]
    ds_read_b64_tr_b16 v[192:193], v10 offset:30720
    ds_read_b64_tr_b16 v[194:195], v10 offset:30976
    s_waitcnt lgkmcnt(6)
    v_mfma_f32_32x32x16_bf16 v[168:183], v[132:135], v[196:199], v[168:183]
    ds_read_b64_tr_b16 v[196:197], v10 offset:31744
    ds_read_b64_tr_b16 v[198:199], v10 offset:32000
    s_waitcnt lgkmcnt(6)
    v_mfma_f32_32x32x16_bf16 v[168:183], v[136:139], v[184:187], v[168:183]
    ds_read_b64_tr_b16 v[184:185], v10 offset:32768
    ds_read_b64_tr_b16 v[186:187], v10 offset:33024
    s_waitcnt lgkmcnt(6)
    v_mfma_f32_32x32x16_bf16 v[168:183], v[140:143], v[188:191], v[168:183]
    ds_read_b64_tr_b16 v[188:189], v10 offset:33792
    ds_read_b64_tr_b16 v[190:191], v10 offset:34048
    s_waitcnt lgkmcnt(6)
    v_mfma_f32_32x32x16_bf16 v[168:183], v[144:147], v[192:195], v[168:183]
    ds_read_b64_tr_b16 v[192:193], v10 offset:34816
    ds_read_b64_tr_b16 v[194:195], v10 offset:35072
    s_waitcnt lgkmcnt(6)
    v_mfma_f32_32x32x16_bf16 v[168:183], v[148:151], v[196:199], v[168:183]
    ds_read_b64_tr_b16 v[196:197], v10 offset:35840
    ds_read_b64_tr_b16 v[198:199], v10 offset:36096
    s_waitcnt lgkmcnt(6)
    v_mfma_f32_32x32x16_bf16 v[168:183], v[152:155], v[184:187], v[168:183]
    s_waitcnt lgkmcnt(4)
    v_mfma_f32_32x32x16_bf16 v[168:183], v[156:159], v[188:191], v[168:183]
    s_waitcnt lgkmcnt(2)
    v_mfma_f32_32x32x16_bf16 v[168:183], v[160:163], v[192:195], v[168:183]
    s_waitcnt lgkmcnt(0)
    v_mfma_f32_32x32x16_bf16 v[168:183], v[164:167], v[196:199], v[168:183]
    s_waitcnt vmcnt(0)
    s_branch k1_stepend
k1_xa_Q:
    ds_read_b64_tr_b16 v[184:185], v10 offset:0
    ds_read_b64_tr_b16 v[186:187], v10 offset:256
    ds_read_b64_tr_b16 v[188:189], v10 offset:1024
    ds_read_b64_tr_b16 v[190:191], v10 offset:1280
    ds_read_b64_tr_b16 v[192:193], v10 offset:2048
    ds_read_b64_tr_b16 v[194:195], v10 offset:2304
    ds_read_b64_tr_b16 v[196:197], v10 offset:3072
    ds_read_b64_tr_b16 v[198:199], v10 offset:3328
    s_waitcnt lgkmcnt(6)
    v_mfma_f32_32x32x16_bf16 v[168:183], v[24:27], v[184:187], 0
    s_movk_i32 s39, 1152
    v_lshlrev_b32 v13, 4, v5
    v_mad_u32_u24 v12, v4, s39, v13
    ds_read_b64_tr_b16 v[184:185], v10 offset:4096
    ds_read_b64_tr_b16 v[186:187], v10 offset:4352
    s_waitcnt lgkmcnt(6)
    v_mfma_f32_32x32x16_bf16 v[168:183], v[28:31], v[188:191], v[168:183]
    s_mov_b32 m0, s57
    s_add_u32 s57, s57, 1024
    buffer_load_dwordx4 v8, s[20:23], s59 offen lds
    s_add_u32 s59, s59, s58
    s_mul_i32 s61, s36, 1152
    s_lshl_b32 s40, s60, 6
    s_add_u32 s61, s61, s40
    s_add_u32 s61, s61, 0
    ds_read_b64_tr_b16 v[188:189], v10 offset:5120
    ds_read_b64_tr_b16 v[190:191], v10 offset:5376
    s_waitcnt lgkmcnt(6)
    v_mfma_f32_32x32x16_bf16 v[168:183], v[32:35], v[192:195], v[168:183]
    v_mul_f32 v200, 0x3eae1a93, v200
    ds_read_b64_tr_b16 v[192:193], v10 offset:6144
    ds_read_b64_tr_b16 v[194:195], v10 offset:6400
    s_waitcnt lgkmcnt(6)
    v_mfma_f32_32x32x16_bf16 v[168:183], v[36:39], v[196:199], v[168:183]
    v_mul_f32 v201, 0x3eae1a93, v201
    ds_read_b64_tr_b16 v[196:197], v10 offset:7168
    ds_read_b64_tr_b16 v[198:199], v10 offset:7424
    s_waitcnt lgkmcnt(6)
    v_mfma_f32_32x32x16_bf16 v[168:183], v[40:43], v[184:187], v[168:183]
    s_mov_b32 m0, s57
    s_add_u32 s57, s57, 1024
    buffer_load_dwordx4 v8, s[20:23], s59 offen lds
    s_add_u32 s59, s59, s58
    v_mul_f32 v202, 0x3eae1a93, v202
    ds_read_b64_tr_b16 v[184:185], v10 offset:8192
    ds_read_b64_tr_b16 v[186:187], v10 offset:8448
    s_waitcnt lgkmcnt(6)
    v_mfma_f32_32x32x16_bf16 v[168:183], v[44:47], v[188:191], v[168:183]
    v_mul_f32 v203, 0x3eae1a93, v203
    ds_read_b64_tr_b16 v[188:189], v10 offset:9216
    ds_read_b64_tr_b16 v[190:191], v10 offset:9472
    s_waitcnt lgkmcnt(6)
    v_mfma_f32_32x32x16_bf16 v[168:183], v[48:51], v[192:195], v[168:183]
    v_mul_f32 v204, 0x3eae1a93, v204
    ds_read_b64_tr_b16 v[192:193], v10 offset:10240
    ds_read_b64_tr_b16 v[194:195], v10 offset:10496
    s_waitcnt lgkmcnt(6)
    v_mfma_f32_32x32x16_bf16 v[168:183], v[52:55], v[196:199], v[168:183]
    s_mov_b32 m0, s57
    s_add_u32 s57, s57, 1024
    buffer_load_dwordx4 v8, s[20:23], s59 offen lds
    s_add_u32 s59, s59, s58
    v_mul_f32 v205, 0x3eae1a93, v205
    ds_read_b64_tr_b16 v[196:197], v10 offset:11264
    ds_read_b64_tr_b16 v[198:199], v10 offset:11520
    s_waitcnt lgkmcnt(6)
    v_mfma_f32_32x32x16_bf16 v[168:183], v[56:59], v[184:187], v[168:183]
    v_mul_f32 v206, 0x3eae1a93, v206
    ds_read_b64_tr_b16 v[184:185], v10 offset:12288
    ds_read_b64_tr_b16 v[186:187], v10 offset:12544
    s_waitcnt lgkmcnt(6)
    v_mfma_f32_32x32x16_bf16 v[168:183], v[60:63], v[188:191], v[168:183]
    v_mul_f32 v207, 0x3eae1a93, v207
    ds_read_b64_tr_b16 v[188:189], v10 offset:13312
    ds_read_b64_tr_b16 v[190:191], v10 offset:13568
    s_waitcnt lgkmcnt(6)
    v_mfma_f32_32x32x16_bf16 v[168:183], v[64:67], v[192:195], v[168:183]
    s_mov_b32 m0, s57
    s_add_u32 s57, s57, 1024
    buffer_load_dwordx4 v8, s[20:23], s59 offen lds
    s_add_u32 s59, s59, s58
    v_mul_f32 v208, 0x3eae1a93, v208
    ds_read_b64_tr_b16 v[192:193], v10 offset:14336
    ds_read_b64_tr_b16 v[194:195], v10 offset:14592
    s_waitcnt lgkmcnt(6)
    v_mfma_f32_32x32x16_bf16 v[168:183], v[68:71], v[196:199], v[168:183]
    v_mul_f32 v209, 0x3eae1a93, v209
    ds_read_b64_tr_b16 v[196:197], v10 offset:15360
    ds_read_b64_tr_b16 v[198:199], v10 offset:15616
    s_waitcnt lgkmcnt(6)
    v_mfma_f32_32x32x16_bf16 v[168:183], v[72:75], v[184:187], v[168:183]
    v_mul_f32 v210, 0x3eae1a93, v210
    ds_read_b64_tr_b16 v[184:185], v10 offset:16384
    ds_read_b64_tr_b16 v[186:187], v10 offset:16640
    s_waitcnt lgkmcnt(6)
    v_mfma_f32_32x32x16_bf16 v[168:183], v[76:79], v[188:191], v[168:183]
    s_mov_b32 m0, s57
    s_add_u32 s57, s57, 1024
    buffer_load_dwordx4 v8, s[20:23], s59 offen lds
    s_add_u32 s59, s59, s58
    v_mul_f32 v211, 0x3eae1a93, v211
    ds_read_b64_tr_b16 v[188:189], v10 offset:17408
    ds_read_b64_tr_b16 v[190:191], v10 offset:17664
    s_waitcnt lgkmcnt(6)
    v_mfma_f32_32x32x16_bf16 v[168:183], v[80:83], v[192:195], v[168:183]
    v_mul_f32 v212, 0x3eae1a93, v212
    ds_read_b64_tr_b16 v[192:193], v10 offset:18432
    ds_read_b64_tr_b16 v[194:195], v10 offset:18688
    s_waitcnt lgkmcnt(6)
    v_mfma_f32_32x32x16_bf16 v[168:183], v[84:87], v[196:199], v[168:183]
    v_mul_f32 v213, 0x3eae1a93, v213
    ds_read_b64_tr_b16 v[196:197], v10 offset:19456
    ds_read_b64_tr_b16 v[198:199], v10 offset:19712
    s_waitcnt lgkmcnt(6)
    v_mfma_f32_32x32x16_bf16 v[168:183], v[88:91], v[184:187], v[168:183]
    s_mov_b32 m0, s57
    s_add_u32 s57, s57, 1024
    buffer_load_dwordx4 v8, s[20:23], s59 offen lds
    s_add_u32 s59, s59, s58
    v_mul_f32 v214, 0x3eae1a93, v214
    ds_read_b64_tr_b16 v[184:185], v10 offset:20480
    ds_read_b64_tr_b16 v[186:187], v10 offset:20736
    s_waitcnt lgkmcnt(6)
    v_mfma_f32_32x32x16_bf16 v[168:183], v[92:95], v[188:191], v[168:183]
    v_mul_f32 v215, 0x3eae1a93, v215
    ds_read_b64_tr_b16 v[188:189], v10 offset:21504
    ds_read_b64_tr_b16 v[190:191], v10 offset:21760
    s_waitcnt lgkmcnt(6)
    v_mfma_f32_32x32x16_bf16 v[168:183], v[96:99], v[192:195], v[168:183]
    v_cvt_pk_bf16_f32 v200, v200, v201
    ds_read_b64_tr_b16 v[192:193], v10 offset:22528
    ds_read_b64_tr_b16 v[194:195], v10 offset:22784
    s_waitcnt lgkmcnt(6)
    v_mfma_f32_32x32x16_bf16 v[168:183], v[100:103], v[196:199], v[168:183]
    s_mov_b32 m0, s57
    s_add_u32 s57, s57, 1024
    buffer_load_dwordx4 v8, s[20:23], s59 offen lds
    s_add_u32 s59, s59, s58
    v_cvt_pk_bf16_f32 v201, v202, v203
    ds_read_b64_tr_b16 v[196:197], v10 offset:23552
    ds_read_b64_tr_b16 v[198:199], v10 offset:23808
    s_waitcnt lgkmcnt(6)
    v_mfma_f32_32x32x16_bf16 v[168:183], v[104:107], v[184:187], v[168:183]
    v_cvt_pk_bf16_f32 v202, v204, v205
    ds_read_b64_tr_b16 v[184:185], v10 offset:24576
    ds_read_b64_tr_b16 v[186:187], v10 offset:24832
    s_waitcnt lgkmcnt(6)
    v_mfma_f32_32x32x16_bf16 v[168:183], v[108:111], v[188:191], v[168:183]
    v_cvt_pk_bf16_f32 v203, v206, v207
    ds_read_b64_tr_b16 v[188:189], v10 offset:25600
    ds_read_b64_tr_b16 v[190:191], v10 offset:25856
    s_waitcnt lgkmcnt(6)
    v_mfma_f32_32x32x16_bf16 v[168:183], v[112:115], v[192:195], v[168:183]
    s_mov_b32 m0, s57
    s_add_u32 s57, s57, 1024
    buffer_load_dwordx4 v8, s[20:23], s59 offen lds
    s_add_u32 s59, s59, s58
    v_cvt_pk_bf16_f32 v204, v208, v209
    ds_read_b64_tr_b16 v[192:193], v10 offset:26624
    ds_read_b64_tr_b16 v[194:195], v10 offset:26880
    s_waitcnt lgkmcnt(6)
    v_mfma_f32_32x32x16_bf16 v[168:183], v[116:119], v[196:199], v[168:183]
    v_cvt_pk_bf16_f32 v205, v210, v211
    ds_read_b64_tr_b16 v[196:197], v10 offset:27648
    ds_read_b64_tr_b16 v[198:199], v10 offset:27904
    s_waitcnt lgkmcnt(6)
    v_mfma_f32_32x32x16_bf16 v[168:183], v[120:123], v[184:187], v[168:183]
    v_cvt_pk_bf16_f32 v206, v212, v213
    ds_read_b64_tr_b16 v[184:185], v10 offset:28672
    ds_read_b64_tr_b16 v[186:187], v10 offset:28928
    s_waitcnt lgkmcnt(6)
    v_mfma_f32_32x32x16_bf16 v[168:183], v[124:127], v[188:191], v[168:183]
    s_mov_b32 m0, s57
    s_add_u32 s57, s57, 1024
    buffer_load_dwordx4 v8, s[20:23], s59 offen lds
    s_add_u32 s59, s59, s58
    v_cvt_pk_bf16_f32 v207, v214, v215
    ds_read_b64_tr_b16 v[188:189], v10 offset:29696
    ds_read_b64_tr_b16 v[190:191], v10 offset:29952
    s_waitcnt lgkmcnt(6)
    v_mfma_f32_32x32x16_bf16 v[168:183], v[128:131], v[192:195], v[168:183]
    s_nop 1
    ds_read_b64_tr_b16 v[192:193], v10 offset:30720
    ds_read_b64_tr_b16 v[194:195], v10 offset:30976
    s_waitcnt lgkmcnt(6)
    v_mfma_f32_32x32x16_bf16 v[168:183], v[132:135], v[196:199], v[168:183]
    v_permlane32_swap_b32 v200, v202
    v_permlane32_swap_b32 v201, v203
    ds_read_b64_tr_b16 v[196:197], v10 offset:31744
    ds_read_b64_tr_b16 v[198:199], v10 offset:32000
    s_waitcnt lgkmcnt(6)
    v_mfma_f32_32x32x16_bf16 v[168:183], v[136:139], v[184:187], v[168:183]
    v_permlane32_swap_b32 v204, v206
    v_permlane32_swap_b32 v205, v207
    buffer_store_dwordx4 v[200:203], v12, s[24:27], s61 offen offset:0
    ds_read_b64_tr_b16 v[184:185], v10 offset:32768
    ds_read_b64_tr_b16 v[186:187], v10 offset:33024
    s_waitcnt lgkmcnt(6)
    v_mfma_f32_32x32x16_bf16 v[168:183], v[140:143], v[188:191], v[168:183]
    buffer_store_dwordx4 v[204:207], v12, s[24:27], s61 offen offset:32
    ds_read_b64_tr_b16 v[188:189], v10 offset:33792
    ds_read_b64_tr_b16 v[190:191], v10 offset:34048
    s_waitcnt lgkmcnt(6)
    v_mfma_f32_32x32x16_bf16 v[168:183], v[144:147], v[192:195], v[168:183]
    ds_read_b64_tr_b16 v[192:193], v10 offset:34816
    ds_read_b64_tr_b16 v[194:195], v10 offset:35072
    s_waitcnt lgkmcnt(6)
    v_mfma_f32_32x32x16_bf16 v[168:183], v[148:151], v[196:199], v[168:183]
    ds_read_b64_tr_b16 v[196:197], v10 offset:35840
    ds_read_b64_tr_b16 v[198:199], v10 offset:36096
    s_waitcnt lgkmcnt(6)
    v_mfma_f32_32x32x16_bf16 v[168:183], v[152:155], v[184:187], v[168:183]
    s_waitcnt lgkmcnt(4)
    v_mfma_f32_32x32x16_bf16 v[168:183], v[156:159], v[188:191], v[168:183]
    s_waitcnt lgkmcnt(2)
    v_mfma_f32_32x32x16_bf16 v[168:183], v[160:163], v[192:195], v[168:183]
    s_waitcnt lgkmcnt(0)
    v_mfma_f32_32x32x16_bf16 v[168:183], v[164:167], v[196:199], v[168:183]
    s_waitcnt vmcnt(2)
    s_branch k1_stepend
k1_xa_Z1:
    ds_read_b64_tr_b16 v[184:185], v10 offset:0
    ds_read_b64_tr_b16 v[186:187], v10 offset:256
    ds_read_b64_tr_b16 v[188:189], v10 offset:1024
    ds_read_b64_tr_b16 v[190:191], v10 offset:1280
    ds_read_b64_tr_b16 v[192:193], v10 offset:2048
    ds_read_b64_tr_b16 v[194:195], v10 offset:2304
    ds_read_b64_tr_b16 v[196:197], v10 offset:3072
    ds_read_b64_tr_b16 v[198:199], v10 offset:3328
    s_waitcnt lgkmcnt(6)
    v_mfma_f32_32x32x16_bf16 v[168:183], v[24:27], v[184:187], 0
    s_movk_i32 s39, 4608
    v_lshlrev_b32 v13, 4, v5
    v_mad_u32_u24 v12, v4, s39, v13
    s_mul_i32 s61, s36, 4608
    s_sub_u32 s40, s60, 20
    s_lshl_b32 s40, s40, 6
    s_add_u32 s61, s61, s40
    s_add_u32 s61, s61, 4194304
    v_mul_f32 v16, v200, v200
    v_mul_f32 v17, v201, v201
    ds_read_b64_tr_b16 v[184:185], v10 offset:4096
    ds_read_b64_tr_b16 v[186:187], v10 offset:4352
    s_waitcnt lgkmcnt(6)
    v_mfma_f32_32x32x16_bf16 v[168:183], v[28:31], v[188:191], v[168:183]
    s_mov_b32 m0, s57
    s_add_u32 s57, s57, 1024
    buffer_load_dwordx4 v8, s[20:23], s59 offen lds
    s_add_u32 s59, s59, s58
    v_mul_f32 v18, v202, v202
    v_mul_f32 v19, v203, v203
    v_fma_f32 v16, v16, s44, v11
    v_fma_f32 v17, v17, s44, v11
    ds_read_b64_tr_b16 v[188:189], v10 offset:5120
    ds_read_b64_tr_b16 v[190:191], v10 offset:5376
    s_waitcnt lgkmcnt(6)
    v_mfma_f32_32x32x16_bf16 v[168:183], v[32:35], v[192:195], v[168:183]
    v_fma_f32 v18, v18, s44, v11
    v_fma_f32 v19, v19, s44, v11
    v_mul_f32 v16, v16, v200
    v_mul_f32 v17, v17, v201
    ds_read_b64_tr_b16 v[192:193], v10 offset:6144
    ds_read_b64_tr_b16 v[194:195], v10 offset:6400
    s_waitcnt lgkmcnt(6)
    v_mfma_f32_32x32x16_bf16 v[168:183], v[36:39], v[196:199], v[168:183]
    v_mul_f32 v18, v18, v202
    v_mul_f32 v19, v19, v203
    v_exp_f32 v16, v16
    v_exp_f32 v17, v17
    ds_read_b64_tr_b16 v[196:197], v10 offset:7168
    ds_read_b64_tr_b16 v[198:199], v10 offset:7424
    s_waitcnt lgkmcnt(6)
    v_mfma_f32_32x32x16_bf16 v[168:183], v[40:43], v[184:187], v[168:183]
    s_mov_b32 m0, s57
    s_add_u32 s57, s57, 1024
    buffer_load_dwordx4 v8, s[20:23], s59 offen lds
    s_add_u32 s59, s59, s58
    v_exp_f32 v18, v18
    v_exp_f32 v19, v19
    v_add_f32 v16, 1.0, v16
    v_add_f32 v17, 1.0, v17
    ds_read_b64_tr_b16 v[184:185], v10 offset:8192
    ds_read_b64_tr_b16 v[186:187], v10 offset:8448
    s_waitcnt lgkmcnt(6)
    v_mfma_f32_32x32x16_bf16 v[168:183], v[44:47], v[188:191], v[168:183]
    v_add_f32 v18, 1.0, v18
    v_add_f32 v19, 1.0, v19
    v_rcp_f32 v16, v16
    v_rcp_f32 v17, v17
    ds_read_b64_tr_b16 v[188:189], v10 offset:9216
    ds_read_b64_tr_b16 v[190:191], v10 offset:9472
    s_waitcnt lgkmcnt(6)
    v_mfma_f32_32x32x16_bf16 v[168:183], v[48:51], v[192:195], v[168:183]
    v_rcp_f32 v18, v18
    v_rcp_f32 v19, v19
    v_mul_f32 v200, v200, v16
    v_mul_f32 v201, v201, v17
    ds_read_b64_tr_b16 v[192:193], v10 offset:10240
    ds_read_b64_tr_b16 v[194:195], v10 offset:10496
    s_waitcnt lgkmcnt(6)
    v_mfma_f32_32x32x16_bf16 v[168:183], v[52:55], v[196:199], v[168:183]
    s_mov_b32 m0, s57
    s_add_u32 s57, s57, 1024
    buffer_load_dwordx4 v8, s[20:23], s59 offen lds
    s_add_u32 s59, s59, s58
    v_mul_f32 v202, v202, v18
    v_mul_f32 v203, v203, v19
    v_mul_f32 v16, v204, v204
    v_mul_f32 v17, v205, v205
    ds_read_b64_tr_b16 v[196:197], v10 offset:11264
    ds_read_b64_tr_b16 v[198:199], v10 offset:11520
    s_waitcnt lgkmcnt(6)
    v_mfma_f32_32x32x16_bf16 v[168:183], v[56:59], v[184:187], v[168:183]
    v_mul_f32 v18, v206, v206
    v_mul_f32 v19, v207, v207
    v_fma_f32 v16, v16, s44, v11
    v_fma_f32 v17, v17, s44, v11
    ds_read_b64_tr_b16 v[184:185], v10 offset:12288
    ds_read_b64_tr_b16 v[186:187], v10 offset:12544
    s_waitcnt lgkmcnt(6)
    v_mfma_f32_32x32x16_bf16 v[168:183], v[60:63], v[188:191], v[168:183]
    v_fma_f32 v18, v18, s44, v11
    v_fma_f32 v19, v19, s44, v11
    v_mul_f32 v16, v16, v204
    v_mul_f32 v17, v17, v205
    ds_read_b64_tr_b16 v[188:189], v10 offset:13312
    ds_read_b64_tr_b16 v[190:191], v10 offset:13568
    s_waitcnt lgkmcnt(6)
    v_mfma_f32_32x32x16_bf16 v[168:183], v[64:67], v[192:195], v[168:183]
    s_mov_b32 m0, s57
    s_add_u32 s57, s57, 1024
    buffer_load_dwordx4 v8, s[20:23], s59 offen lds
    s_add_u32 s59, s59, s58
    v_mul_f32 v18, v18, v206
    v_mul_f32 v19, v19, v207
    v_exp_f32 v16, v16
    v_exp_f32 v17, v17
    ds_read_b64_tr_b16 v[192:193], v10 offset:14336
    ds_read_b64_tr_b16 v[194:195], v10 offset:14592
    s_waitcnt lgkmcnt(6)
    v_mfma_f32_32x32x16_bf16 v[168:183], v[68:71], v[196:199], v[168:183]
    v_exp_f32 v18, v18
    v_exp_f32 v19, v19
    v_add_f32 v16, 1.0, v16
    v_add_f32 v17, 1.0, v17
    ds_read_b64_tr_b16 v[196:197], v10 offset:15360
    ds_read_b64_tr_b16 v[198:199], v10 offset:15616
    s_waitcnt lgkmcnt(6)
    v_mfma_f32_32x32x16_bf16 v[168:183], v[72:75], v[184:187], v[168:183]
    v_add_f32 v18, 1.0, v18
    v_add_f32 v19, 1.0, v19
    v_rcp_f32 v16, v16
    v_rcp_f32 v17, v17
    ds_read_b64_tr_b16 v[184:185], v10 offset:16384
    ds_read_b64_tr_b16 v[186:187], v10 offset:16640
    s_waitcnt lgkmcnt(6)
    v_mfma_f32_32x32x16_bf16 v[168:183], v[76:79], v[188:191], v[168:183]
    s_mov_b32 m0, s57
    s_add_u32 s57, s57, 1024
    buffer_load_dwordx4 v8, s[20:23], s59 offen lds
    s_add_u32 s59, s59, s58
    v_rcp_f32 v18, v18
    v_rcp_f32 v19, v19
    v_mul_f32 v204, v204, v16
    v_mul_f32 v205, v205, v17
    ds_read_b64_tr_b16 v[188:189], v10 offset:17408
    ds_read_b64_tr_b16 v[190:191], v10 offset:17664
    s_waitcnt lgkmcnt(6)
    v_mfma_f32_32x32x16_bf16 v[168:183], v[80:83], v[192:195], v[168:183]
    v_mul_f32 v206, v206, v18
    v_mul_f32 v207, v207, v19
    v_mul_f32 v16, v208, v208
    v_mul_f32 v17, v209, v209
    ds_read_b64_tr_b16 v[192:193], v10 offset:18432
    ds_read_b64_tr_b16 v[194:195], v10 offset:18688
    s_waitcnt lgkmcnt(6)
    v_mfma_f32_32x32x16_bf16 v[168:183], v[84:87], v[196:199], v[168:183]
    v_mul_f32 v18, v210, v210
    v_mul_f32 v19, v211, v211
    v_fma_f32 v16, v16, s44, v11
    v_fma_f32 v17, v17, s44, v11
    ds_read_b64_tr_b16 v[196:197], v10 offset:19456
    ds_read_b64_tr_b16 v[198:199], v10 offset:19712
    s_waitcnt lgkmcnt(6)
    v_mfma_f32_32x32x16_bf16 v[168:183], v[88:91], v[184:187], v[168:183]
    s_mov_b32 m0, s57
    s_add_u32 s57, s57, 1024
    buffer_load_dwordx4 v8, s[20:23], s59 offen lds
    s_add_u32 s59, s59, s58
    v_fma_f32 v18, v18, s44, v11
    v_fma_f32 v19, v19, s44, v11
    v_mul_f32 v16, v16, v208
    v_mul_f32 v17, v17, v209
    ds_read_b64_tr_b16 v[184:185], v10 offset:20480
    ds_read_b64_tr_b16 v[186:187], v10 offset:20736
    s_waitcnt lgkmcnt(6)
    v_mfma_f32_32x32x16_bf16 v[168:183], v[92:95], v[188:191], v[168:183]
    v_mul_f32 v18, v18, v210
    v_mul_f32 v19, v19, v211
    v_exp_f32 v16, v16
    v_exp_f32 v17, v17
    ds_read_b64_tr_b16 v[188:189], v10 offset:21504
    ds_read_b64_tr_b16 v[190:191], v10 offset:21760
    s_waitcnt lgkmcnt(6)
    v_mfma_f32_32x32x16_bf16 v[168:183], v[96:99], v[192:195], v[168:183]
    v_exp_f32 v18, v18
    v_exp_f32 v19, v19
    v_add_f32 v16, 1.0, v16
    v_add_f32 v17, 1.0, v17
    ds_read_b64_tr_b16 v[192:193], v10 offset:22528
    ds_read_b64_tr_b16 v[194:195], v10 offset:22784
    s_waitcnt lgkmcnt(6)
    v_mfma_f32_32x32x16_bf16 v[168:183], v[100:103], v[196:199], v[168:183]
    s_mov_b32 m0, s57
    s_add_u32 s57, s57, 1024
    buffer_load_dwordx4 v8, s[20:23], s59 offen lds
    s_add_u32 s59, s59, s58
    v_add_f32 v18, 1.0, v18
    v_add_f32 v19, 1.0, v19
    v_rcp_f32 v16, v16
    v_rcp_f32 v17, v17
    ds_read_b64_tr_b16 v[196:197], v10 offset:23552
    ds_read_b64_tr_b16 v[198:199], v10 offset:23808
    s_waitcnt lgkmcnt(6)
    v_mfma_f32_32x32x16_bf16 v[168:183], v[104:107], v[184:187], v[168:183]
    v_rcp_f32 v18, v18
    v_rcp_f32 v19, v19
    v_mul_f32 v208, v208, v16
    v_mul_f32 v209, v209, v17
    ds_read_b64_tr_b16 v[184:185], v10 offset:24576
    ds_read_b64_tr_b16 v[186:187], v10 offset:24832
    s_waitcnt lgkmcnt(6)
    v_mfma_f32_32x32x16_bf16 v[168:183], v[108:111], v[188:191], v[168:183]
    v_mul_f32 v210, v210, v18
    v_mul_f32 v211, v211, v19
    v_mul_f32 v16, v212, v212
    v_mul_f32 v17, v213, v213
    ds_read_b64_tr_b16 v[188:189], v10 offset:25600
    ds_read_b64_tr_b16 v[190:191], v10 offset:25856
    s_waitcnt lgkmcnt(6)
    v_mfma_f32_32x32x16_bf16 v[168:183], v[112:115], v[192:195], v[168:183]
    s_mov_b32 m0, s57
    s_add_u32 s57, s57, 1024
    buffer_load_dwordx4 v8, s[20:23], s59 offen lds
    s_add_u32 s59, s59, s58
    v_mul_f32 v18, v214, v214
    v_mul_f32 v19, v215, v215
    v_fma_f32 v16, v16, s44, v11
    v_fma_f32 v17, v17, s44, v11
    ds_read_b64_tr_b16 v[192:193], v10 offset:26624
    ds_read_b64_tr_b16 v[194:195], v10 offset:26880
    s_waitcnt lgkmcnt(6)
    v_mfma_f32_32x32x16_bf16 v[168:183], v[116:119], v[196:199], v[168:183]
    v_fma_f32 v18, v18, s44, v11
    v_fma_f32 v19, v19, s44, v11
    v_mul_f32 v16, v16, v212
    v_mul_f32 v17, v17, v213
    ds_read_b64_tr_b16 v[196:197], v10 offset:27648
    ds_read_b64_tr_b16 v[198:199], v10 offset:27904
    s_waitcnt lgkmcnt(6)
    v_mfma_f32_32x32x16_bf16 v[168:183], v[120:123], v[184:187], v[168:183]
    v_mul_f32 v18, v18, v214
    v_mul_f32 v19, v19, v215
    v_exp_f32 v16, v16
    v_exp_f32 v17, v17
    ds_read_b64_tr_b16 v[184:185], v10 offset:28672
    ds_read_b64_tr_b16 v[186:187], v10 offset:28928
    s_waitcnt lgkmcnt(6)
    v_mfma_f32_32x32x16_bf16 v[168:183], v[124:127], v[188:191], v[168:183]
    s_mov_b32 m0, s57
    s_add_u32 s57, s57, 1024
    buffer_load_dwordx4 v8, s[20:23], s59 offen lds
    s_add_u32 s59, s59, s58
    v_exp_f32 v18, v18
    v_exp_f32 v19, v19
    v_add_f32 v16, 1.0, v16
    v_add_f32 v17, 1.0, v17
    ds_read_b64_tr_b16 v[188:189], v10 offset:29696
    ds_read_b64_tr_b16 v[190:191], v10 offset:29952
    s_waitcnt lgkmcnt(6)
    v_mfma_f32_32x32x16_bf16 v[168:183], v[128:131], v[192:195], v[168:183]
    v_add_f32 v18, 1.0, v18
    v_add_f32 v19, 1.0, v19
    v_rcp_f32 v16, v16
    v_rcp_f32 v17, v17
    ds_read_b64_tr_b16 v[192:193], v10 offset:30720
    ds_read_b64_tr_b16 v[194:195], v10 offset:30976
    s_waitcnt lgkmcnt(6)
    v_mfma_f32_32x32x16_bf16 v[168:183], v[132:135], v[196:199], v[168:183]
    v_rcp_f32 v18, v18
    v_rcp_f32 v19, v19
    v_mul_f32 v212, v212, v16
    v_mul_f32 v213, v213, v17
    ds_read_b64_tr_b16 v[196:197], v10 offset:31744
    ds_read_b64_tr_b16 v[198:199], v10 offset:32000
    s_waitcnt lgkmcnt(6)
    v_mfma_f32_32x32x16_bf16 v[168:183], v[136:139], v[184:187], v[168:183]
    v_mul_f32 v214, v214, v18
    v_mul_f32 v215, v215, v19
    v_cvt_pk_bf16_f32 v200, v200, v201
    v_cvt_pk_bf16_f32 v201, v202, v203
    ds_read_b64_tr_b16 v[184:185], v10 offset:32768
    ds_read_b64_tr_b16 v[186:187], v10 offset:33024
    s_waitcnt lgkmcnt(6)
    v_mfma_f32_32x32x16_bf16 v[168:183], v[140:143], v[188:191], v[168:183]
    v_cvt_pk_bf16_f32 v202, v204, v205
    v_cvt_pk_bf16_f32 v203, v206, v207
    v_cvt_pk_bf16_f32 v204, v208, v209
    v_cvt_pk_bf16_f32 v205, v210, v211
    ds_read_b64_tr_b16 v[188:189], v10 offset:33792
    ds_read_b64_tr_b16 v[190:191], v10 offset:34048
    s_waitcnt lgkmcnt(6)
    v_mfma_f32_32x32x16_bf16 v[168:183], v[144:147], v[192:195], v[168:183]
    v_cvt_pk_bf16_f32 v206, v212, v213
    v_cvt_pk_bf16_f32 v207, v214, v215
    s_nop 1
    v_permlane32_swap_b32 v200, v202
    v_permlane32_swap_b32 v201, v203
    ds_read_b64_tr_b16 v[192:193], v10 offset:34816
    ds_read_b64_tr_b16 v[194:195], v10 offset:35072
    s_waitcnt lgkmcnt(6)
    v_mfma_f32_32x32x16_bf16 v[168:183], v[148:151], v[196:199], v[168:183]
    v_permlane32_swap_b32 v204, v206
    v_permlane32_swap_b32 v205, v207
    buffer_store_dwordx4 v[200:203], v12, s[24:27], s61 offen offset:0
    ds_read_b64_tr_b16 v[196:197], v10 offset:35840
    ds_read_b64_tr_b16 v[198:199], v10 offset:36096
    s_waitcnt lgkmcnt(6)
    v_mfma_f32_32x32x16_bf16 v[168:183], v[152:155], v[184:187], v[168:183]
    buffer_store_dwordx4 v[204:207], v12, s[24:27], s61 offen offset:32
    s_waitcnt lgkmcnt(4)
    v_mfma_f32_32x32x16_bf16 v[168:183], v[156:159], v[188:191], v[168:183]
    s_waitcnt lgkmcnt(2)
    v_mfma_f32_32x32x16_bf16 v[168:183], v[160:163], v[192:195], v[168:183]
    s_waitcnt lgkmcnt(0)
    v_mfma_f32_32x32x16_bf16 v[168:183], v[164:167], v[196:199], v[168:183]
    s_waitcnt vmcnt(2)
    s_branch k1_stepend
k1_stepend:
    s_nop 7
    s_nop 3
    v_mov_b32 v200, v168
    v_mov_b32 v201, v169
    v_mov_b32 v202, v170
    v_mov_b32 v203, v171
    v_mov_b32 v204, v172
    v_mov_b32 v205, v173
    v_mov_b32 v206, v174
    v_mov_b32 v207, v175
    v_mov_b32 v208, v176
    v_mov_b32 v209, v177
    v_mov_b32 v210, v178
    v_mov_b32 v211, v179
    v_mov_b32 v212, v180
    v_mov_b32 v213, v181
    v_mov_b32 v214, v182
    v_mov_b32 v215, v183
    s_mov_b32 s60, s41
    s_add_u32 s35, s35, 2
    s_sub_u32 s39, s35, s29
    s_cmp_ge_u32 s39, s34
    s_cbranch_scc1 k1_idle
    s_barrier
    s_branch k1_loop
k1_idle:
    s_cmp_lt_u32 s60, 18
    s_cbranch_scc1 k1_fin_Q
    s_cmp_lt_u32 s60, 92
    s_cbranch_scc1 k1_fin_Z1
    v_lshlrev_b32 v13, 4, v5
    v_lshl_add_u32 v12, v4, 12, v13
    s_sub_u32 s40, s60, 92
    s_lshl_b32 s40, s40, 17
    s_lshl_b32 s61, s36, 1
    s_add_u32 s61, s61, s40
    s_add_u32 s61, s61, 14680064
    v_mul_f32 v16, v200, v200
    v_mul_f32 v17, v201, v201
    v_mul_f32 v18, v202, v202
    v_mul_f32 v19, v203, v203
    v_fma_f32 v16, v16, s44, v11
    v_fma_f32 v17, v17, s44, v11
    v_fma_f32 v18, v18, s44, v11
    v_fma_f32 v19, v19, s44, v11
    v_mul_f32 v16, v16, v200
    v_mul_f32 v17, v17, v201
    v_mul_f32 v18, v18, v202
    v_mul_f32 v19, v19, v203
    v_exp_f32 v16, v16
    v_exp_f32 v17, v17
    v_exp_f32 v18, v18
    v_exp_f32 v19, v19
    v_add_f32 v16, 1.0, v16
    v_add_f32 v17, 1.0, v17
    v_add_f32 v18, 1.0, v18
    v_add_f32 v19, 1.0, v19
    v_rcp_f32 v16, v16
    v_rcp_f32 v17, v17
    v_rcp_f32 v18, v18
    v_rcp_f32 v19, v19
    v_mul_f32 v200, v200, v16
    v_mul_f32 v201, v201, v17
    v_mul_f32 v202, v202, v18
    v_mul_f32 v203, v203, v19
    v_mul_f32 v16, v204, v204
    v_mul_f32 v17, v205, v205
    v_mul_f32 v18, v206, v206
    v_mul_f32 v19, v207, v207
    v_fma_f32 v16, v16, s44, v11
    v_fma_f32 v17, v17, s44, v11
    v_fma_f32 v18, v18, s44, v11
    v_fma_f32 v19, v19, s44, v11
    v_mul_f32 v16, v16, v204
    v_mul_f32 v17, v17, v205
    v_mul_f32 v18, v18, v206
    v_mul_f32 v19, v19, v207
    v_exp_f32 v16, v16
    v_exp_f32 v17, v17
    v_exp_f32 v18, v18
    v_exp_f32 v19, v19
    v_add_f32 v16, 1.0, v16
    v_add_f32 v17, 1.0, v17
    v_add_f32 v18, 1.0, v18
    v_add_f32 v19, 1.0, v19
    v_rcp_f32 v16, v16
    v_rcp_f32 v17, v17
    v_rcp_f32 v18, v18
    v_rcp_f32 v19, v19
    v_mul_f32 v204, v204, v16
    v_mul_f32 v205, v205, v17
    v_mul_f32 v206, v206, v18
    v_mul_f32 v207, v207, v19
    v_mul_f32 v16, v208, v208
    v_mul_f32 v17, v209, v209
    v_mul_f32 v18, v210, v210
    v_mul_f32 v19, v211, v211
    v_fma_f32 v16, v16, s44, v11
    v_fma_f32 v17, v17, s44, v11
    v_fma_f32 v18, v18, s44, v11
    v_fma_f32 v19, v19, s44, v11
    v_mul_f32 v16, v16, v208
    v_mul_f32 v17, v17, v209
    v_mul_f32 v18, v18, v210
    v_mul_f32 v19, v19, v211
    v_exp_f32 v16, v16
    v_exp_f32 v17, v17
    v_exp_f32 v18, v18
    v_exp_f32 v19, v19
    v_add_f32 v16, 1.0, v16
    v_add_f32 v17, 1.0, v17
    v_add_f32 v18, 1.0, v18
    v_add_f32 v19, 1.0, v19
    v_rcp_f32 v16, v16
    v_rcp_f32 v17, v17
    v_rcp_f32 v18, v18
    v_rcp_f32 v19, v19
    v_mul_f32 v208, v208, v16
    v_mul_f32 v209, v209, v17
    v_mul_f32 v210, v210, v18
    v_mul_f32 v211, v211, v19
    v_mul_f32 v16, v212, v212
    v_mul_f32 v17, v213, v213
    v_mul_f32 v18, v214, v214
    v_mul_f32 v19, v215, v215
    v_fma_f32 v16, v16, s44, v11
    v_fma_f32 v17, v17, s44, v11
    v_fma_f32 v18, v18, s44, v11
    v_fma_f32 v19, v19, s44, v11
    v_mul_f32 v16, v16, v212
    v_mul_f32 v17, v17, v213
    v_mul_f32 v18, v18, v214
    v_mul_f32 v19, v19, v215
    v_exp_f32 v16, v16
    v_exp_f32 v17, v17
    v_exp_f32 v18, v18
    v_exp_f32 v19, v19
    v_add_f32 v16, 1.0, v16
    v_add_f32 v17, 1.0, v17
    v_add_f32 v18, 1.0, v18
    v_add_f32 v19, 1.0, v19
    v_rcp_f32 v16, v16
    v_rcp_f32 v17, v17
    v_rcp_f32 v18, v18
    v_rcp_f32 v19, v19
    v_mul_f32 v212, v212, v16
    v_mul_f32 v213, v213, v17
    v_mul_f32 v214, v214, v18
    v_mul_f32 v215, v215, v19
    v_add_f32 v216, v216, v200
    v_fma_f32 v217, v200, v200, v217
    v_add_f32 v218, v218, v201
    v_fma_f32 v219, v201, v201, v219
    v_add_f32 v220, v220, v202
    v_fma_f32 v221, v202, v202, v221
    v_add_f32 v222, v222, v203
    v_fma_f32 v223, v203, v203, v223
    v_add_f32 v224, v224, v204
    v_fma_f32 v225, v204, v204, v225
    v_add_f32 v226, v226, v205
    v_fma_f32 v227, v205, v205, v227
    v_add_f32 v228, v228, v206
    v_fma_f32 v229, v206, v206, v229
    v_add_f32 v230, v230, v207
    v_fma_f32 v231, v207, v207, v231
    v_add_f32 v232, v232, v208
    v_fma_f32 v233, v208, v208, v233
    v_add_f32 v234, v234, v209
    v_fma_f32 v235, v209, v209, v235
    v_add_f32 v236, v236, v210
    v_fma_f32 v237, v210, v210, v237
    v_add_f32 v238, v238, v211
    v_fma_f32 v239, v211, v211, v239
    v_add_f32 v240, v240, v212
    v_fma_f32 v241, v212, v212, v241
    v_add_f32 v242, v242, v213
    v_fma_f32 v243, v213, v213, v243
    v_add_f32 v244, v244, v214
    v_fma_f32 v245, v214, v214, v245
    v_add_f32 v246, v246, v215
    v_fma_f32 v247, v215, v215, v247
    v_cvt_pk_bf16_f32 v200, v200, v201
    v_cvt_pk_bf16_f32 v201, v202, v203
    v_cvt_pk_bf16_f32 v202, v204, v205
    v_cvt_pk_bf16_f32 v203, v206, v207
    v_cvt_pk_bf16_f32 v204, v208, v209
    v_cvt_pk_bf16_f32 v205, v210, v211
    v_cvt_pk_bf16_f32 v206, v212, v213
    v_cvt_pk_bf16_f32 v207, v214, v215
    s_nop 1
    v_permlane32_swap_b32 v200, v202
    v_permlane32_swap_b32 v201, v203
    v_permlane32_swap_b32 v204, v206
    v_permlane32_swap_b32 v205, v207
    buffer_store_dwordx4 v[200:203], v12, s[24:27], s61 offen offset:0
    buffer_store_dwordx4 v[204:207], v12, s[24:27], s61 offen offset:32
    s_branch k1_fin
k1_fin_Q:
    s_movk_i32 s39, 1152
    v_lshlrev_b32 v13, 4, v5
    v_mad_u32_u24 v12, v4, s39, v13
    s_mul_i32 s61, s36, 1152
    s_lshl_b32 s40, s60, 6
    s_add_u32 s61, s61, s40
    s_add_u32 s61, s61, 0
    v_mul_f32 v200, 0x3eae1a93, v200
    v_mul_f32 v201, 0x3eae1a93, v201
    v_mul_f32 v202, 0x3eae1a93, v202
    v_mul_f32 v203, 0x3eae1a93, v203
    v_mul_f32 v204, 0x3eae1a93, v204
    v_mul_f32 v205, 0x3eae1a93, v205
    v_mul_f32 v206, 0x3eae1a93, v206
    v_mul_f32 v207, 0x3eae1a93, v207
    v_mul_f32 v208, 0x3eae1a93, v208
    v_mul_f32 v209, 0x3eae1a93, v209
    v_mul_f32 v210, 0x3eae1a93, v210
    v_mul_f32 v211, 0x3eae1a93, v211
    v_mul_f32 v212, 0x3eae1a93, v212
    v_mul_f32 v213, 0x3eae1a93, v213
    v_mul_f32 v214, 0x3eae1a93, v214
    v_mul_f32 v215, 0x3eae1a93, v215
    v_cvt_pk_bf16_f32 v200, v200, v201
    v_cvt_pk_bf16_f32 v201, v202, v203
    v_cvt_pk_bf16_f32 v202, v204, v205
    v_cvt_pk_bf16_f32 v203, v206, v207
    v_cvt_pk_bf16_f32 v204, v208, v209
    v_cvt_pk_bf16_f32 v205, v210, v211
    v_cvt_pk_bf16_f32 v206, v212, v213
    v_cvt_pk_bf16_f32 v207, v214, v215
    s_nop 1
    v_permlane32_swap_b32 v200, v202
    v_permlane32_swap_b32 v201, v203
    v_permlane32_swap_b32 v204, v206
    v_permlane32_swap_b32 v205, v207
    buffer_store_dwordx4 v[200:203], v12, s[24:27], s61 offen offset:0
    buffer_store_dwordx4 v[204:207], v12, s[24:27], s61 offen offset:32
    s_branch k1_fin
k1_fin_Z1:
    s_movk_i32 s39, 4608
    v_lshlrev_b32 v13, 4, v5
    v_mad_u32_u24 v12, v4, s39, v13
    s_mul_i32 s61, s36, 4608
    s_sub_u32 s40, s60, 20
    s_lshl_b32 s40, s40, 6
    s_add_u32 s61, s61, s40
    s_add_u32 s61, s61, 4194304
    v_mul_f32 v16, v200, v200
    v_mul_f32 v17, v201, v201
    v_mul_f32 v18, v202, v202
    v_mul_f32 v19, v203, v203
    v_fma_f32 v16, v16, s44, v11
    v_fma_f32 v17, v17, s44, v11
    v_fma_f32 v18, v18, s44, v11
    v_fma_f32 v19, v19, s44, v11
    v_mul_f32 v16, v16, v200
    v_mul_f32 v17, v17, v201
    v_mul_f32 v18, v18, v202
    v_mul_f32 v19, v19, v203
    v_exp_f32 v16, v16
    v_exp_f32 v17, v17
    v_exp_f32 v18, v18
    v_exp_f32 v19, v19
    v_add_f32 v16, 1.0, v16
    v_add_f32 v17, 1.0, v17
    v_add_f32 v18, 1.0, v18
    v_add_f32 v19, 1.0, v19
    v_rcp_f32 v16, v16
    v_rcp_f32 v17, v17
    v_rcp_f32 v18, v18
    v_rcp_f32 v19, v19
    v_mul_f32 v200, v200, v16
    v_mul_f32 v201, v201, v17
    v_mul_f32 v202, v202, v18
    v_mul_f32 v203, v203, v19
    v_mul_f32 v16, v204, v204
    v_mul_f32 v17, v205, v205
    v_mul_f32 v18, v206, v206
    v_mul_f32 v19, v207, v207
    v_fma_f32 v16, v16, s44, v11
    v_fma_f32 v17, v17, s44, v11
    v_fma_f32 v18, v18, s44, v11
    v_fma_f32 v19, v19, s44, v11
    v_mul_f32 v16, v16, v204
    v_mul_f32 v17, v17, v205
    v_mul_f32 v18, v18, v206
    v_mul_f32 v19, v19, v207
    v_exp_f32 v16, v16
    v_exp_f32 v17, v17
    v_exp_f32 v18, v18
    v_exp_f32 v19, v19
    v_add_f32 v16, 1.0, v16
    v_add_f32 v17, 1.0, v17
    v_add_f32 v18, 1.0, v18
    v_add_f32 v19, 1.0, v19
    v_rcp_f32 v16, v16
    v_rcp_f32 v17, v17
    v_rcp_f32 v18, v18
    v_rcp_f32 v19, v19
    v_mul_f32 v204, v204, v16
    v_mul_f32 v205, v205, v17
    v_mul_f32 v206, v206, v18
    v_mul_f32 v207, v207, v19
    v_mul_f32 v16, v208, v208
    v_mul_f32 v17, v209, v209
    v_mul_f32 v18, v210, v210
    v_mul_f32 v19, v211, v211
    v_fma_f32 v16, v16, s44, v11
    v_fma_f32 v17, v17, s44, v11
    v_fma_f32 v18, v18, s44, v11
    v_fma_f32 v19, v19, s44, v11
    v_mul_f32 v16, v16, v208
    v_mul_f32 v17, v17, v209
    v_mul_f32 v18, v18, v210
    v_mul_f32 v19, v19, v211
    v_exp_f32 v16, v16
    v_exp_f32 v17, v17
    v_exp_f32 v18, v18
    v_exp_f32 v19, v19
    v_add_f32 v16, 1.0, v16
    v_add_f32 v17, 1.0, v17
    v_add_f32 v18, 1.0, v18
    v_add_f32 v19, 1.0, v19
    v_rcp_f32 v16, v16
    v_rcp_f32 v17, v17
    v_rcp_f32 v18, v18
    v_rcp_f32 v19, v19
    v_mul_f32 v208, v208, v16
    v_mul_f32 v209, v209, v17
    v_mul_f32 v210, v210, v18
    v_mul_f32 v211, v211, v19
    v_mul_f32 v16, v212, v212
    v_mul_f32 v17, v213, v213
    v_mul_f32 v18, v214, v214
    v_mul_f32 v19, v215, v215
    v_fma_f32 v16, v16, s44, v11
    v_fma_f32 v17, v17, s44, v11
    v_fma_f32 v18, v18, s44, v11
    v_fma_f32 v19, v19, s44, v11
    v_mul_f32 v16, v16, v212
    v_mul_f32 v17, v17, v213
    v_mul_f32 v18, v18, v214
    v_mul_f32 v19, v19, v215
    v_exp_f32 v16, v16
    v_exp_f32 v17, v17
    v_exp_f32 v18, v18
    v_exp_f32 v19, v19
    v_add_f32 v16, 1.0, v16
    v_add_f32 v17, 1.0, v17
    v_add_f32 v18, 1.0, v18
    v_add_f32 v19, 1.0, v19
    v_rcp_f32 v16, v16
    v_rcp_f32 v17, v17
    v_rcp_f32 v18, v18
    v_rcp_f32 v19, v19
    v_mul_f32 v212, v212, v16
    v_mul_f32 v213, v213, v17
    v_mul_f32 v214, v214, v18
    v_mul_f32 v215, v215, v19
    v_cvt_pk_bf16_f32 v200, v200, v201
    v_cvt_pk_bf16_f32 v201, v202, v203
    v_cvt_pk_bf16_f32 v202, v204, v205
    v_cvt_pk_bf16_f32 v203, v206, v207
    v_cvt_pk_bf16_f32 v204, v208, v209
    v_cvt_pk_bf16_f32 v205, v210, v211
    v_cvt_pk_bf16_f32 v206, v212, v213
    v_cvt_pk_bf16_f32 v207, v214, v215
    s_nop 1
    v_permlane32_swap_b32 v200, v202
    v_permlane32_swap_b32 v201, v203
    v_permlane32_swap_b32 v204, v206
    v_permlane32_swap_b32 v205, v207
    buffer_store_dwordx4 v[200:203], v12, s[24:27], s61 offen offset:0
    buffer_store_dwordx4 v[204:207], v12, s[24:27], s61 offen offset:32
    s_branch k1_fin
k1_fin:
    s_cmp_lt_u32 s32, 8
    s_cbranch_scc1 k1_end
    v_add_f32_dpp v216, v216, v216 row_ror:8 row_mask:0xf bank_mask:0xf
    v_add_f32_dpp v217, v217, v217 row_ror:8 row_mask:0xf bank_mask:0xf
    v_add_f32_dpp v218, v218, v218 row_ror:8 row_mask:0xf bank_mask:0xf
    v_add_f32_dpp v219, v219, v219 row_ror:8 row_mask:0xf bank_mask:0xf
    v_add_f32_dpp v220, v220, v220 row_ror:8 row_mask:0xf bank_mask:0xf
    v_add_f32_dpp v221, v221, v221 row_ror:8 row_mask:0xf bank_mask:0xf
    v_add_f32_dpp v222, v222, v222 row_ror:8 row_mask:0xf bank_mask:0xf
    v_add_f32_dpp v223, v223, v223 row_ror:8 row_mask:0xf bank_mask:0xf
    v_add_f32_dpp v224, v224, v224 row_ror:8 row_mask:0xf bank_mask:0xf
    v_add_f32_dpp v225, v225, v225 row_ror:8 row_mask:0xf bank_mask:0xf
    v_add_f32_dpp v226, v226, v226 row_ror:8 row_mask:0xf bank_mask:0xf
    v_add_f32_dpp v227, v227, v227 row_ror:8 row_mask:0xf bank_mask:0xf
    v_add_f32_dpp v228, v228, v228 row_ror:8 row_mask:0xf bank_mask:0xf
    v_add_f32_dpp v229, v229, v229 row_ror:8 row_mask:0xf bank_mask:0xf
    v_add_f32_dpp v230, v230, v230 row_ror:8 row_mask:0xf bank_mask:0xf
    v_add_f32_dpp v231, v231, v231 row_ror:8 row_mask:0xf bank_mask:0xf
    v_add_f32_dpp v232, v232, v232 row_ror:8 row_mask:0xf bank_mask:0xf
    v_add_f32_dpp v233, v233, v233 row_ror:8 row_mask:0xf bank_mask:0xf
    v_add_f32_dpp v234, v234, v234 row_ror:8 row_mask:0xf bank_mask:0xf
    v_add_f32_dpp v235, v235, v235 row_ror:8 row_mask:0xf bank_mask:0xf
    v_add_f32_dpp v236, v236, v236 row_ror:8 row_mask:0xf bank_mask:0xf
    v_add_f32_dpp v237, v237, v237 row_ror:8 row_mask:0xf bank_mask:0xf
    v_add_f32_dpp v238, v238, v238 row_ror:8 row_mask:0xf bank_mask:0xf
    v_add_f32_dpp v239, v239, v239 row_ror:8 row_mask:0xf bank_mask:0xf
    v_add_f32_dpp v240, v240, v240 row_ror:8 row_mask:0xf bank_mask:0xf
    v_add_f32_dpp v241, v241, v241 row_ror:8 row_mask:0xf bank_mask:0xf
    v_add_f32_dpp v242, v242, v242 row_ror:8 row_mask:0xf bank_mask:0xf
    v_add_f32_dpp v243, v243, v243 row_ror:8 row_mask:0xf bank_mask:0xf
    v_add_f32_dpp v244, v244, v244 row_ror:8 row_mask:0xf bank_mask:0xf
    v_add_f32_dpp v245, v245, v245 row_ror:8 row_mask:0xf bank_mask:0xf
    v_add_f32_dpp v246, v246, v246 row_ror:8 row_mask:0xf bank_mask:0xf
    v_add_f32_dpp v247, v247, v247 row_ror:8 row_mask:0xf bank_mask:0xf
    s_nop 1
    v_add_f32_dpp v216, v216, v216 row_ror:4 row_mask:0xf bank_mask:0xf
    v_add_f32_dpp v217, v217, v217 row_ror:4 row_mask:0xf bank_mask:0xf
    v_add_f32_dpp v218, v218, v218 row_ror:4 row_mask:0xf bank_mask:0xf
    v_add_f32_dpp v219, v219, v219 row_ror:4 row_mask:0xf bank_mask:0xf
    v_add_f32_dpp v220, v220, v220 row_ror:4 row_mask:0xf bank_mask:0xf
    v_add_f32_dpp v221, v221, v221 row_ror:4 row_mask:0xf bank_mask:0xf
    v_add_f32_dpp v222, v222, v222 row_ror:4 row_mask:0xf bank_mask:0xf
    v_add_f32_dpp v223, v223, v223 row_ror:4 row_mask:0xf bank_mask:0xf
    v_add_f32_dpp v224, v224, v224 row_ror:4 row_mask:0xf bank_mask:0xf
    v_add_f32_dpp v225, v225, v225 row_ror:4 row_mask:0xf bank_mask:0xf
    v_add_f32_dpp v226, v226, v226 row_ror:4 row_mask:0xf bank_mask:0xf
    v_add_f32_dpp v227, v227, v227 row_ror:4 row_mask:0xf bank_mask:0xf
    v_add_f32_dpp v228, v228, v228 row_ror:4 row_mask:0xf bank_mask:0xf
    v_add_f32_dpp v229, v229, v229 row_ror:4 row_mask:0xf bank_mask:0xf
    v_add_f32_dpp v230, v230, v230 row_ror:4 row_mask:0xf bank_mask:0xf
    v_add_f32_dpp v231, v231, v231 row_ror:4 row_mask:0xf bank_mask:0xf
    v_add_f32_dpp v232, v232, v232 row_ror:4 row_mask:0xf bank_mask:0xf
    v_add_f32_dpp v233, v233, v233 row_ror:4 row_mask:0xf bank_mask:0xf
    v_add_f32_dpp v234, v234, v234 row_ror:4 row_mask:0xf bank_mask:0xf
    v_add_f32_dpp v235, v235, v235 row_ror:4 row_mask:0xf bank_mask:0xf
    v_add_f32_dpp v236, v236, v236 row_ror:4 row_mask:0xf bank_mask:0xf
    v_add_f32_dpp v237, v237, v237 row_ror:4 row_mask:0xf bank_mask:0xf
    v_add_f32_dpp v238, v238, v238 row_ror:4 row_mask:0xf bank_mask:0xf
    v_add_f32_dpp v239, v239, v239 row_ror:4 row_mask:0xf bank_mask:0xf
    v_add_f32_dpp v240, v240, v240 row_ror:4 row_mask:0xf bank_mask:0xf
    v_add_f32_dpp v241, v241, v241 row_ror:4 row_mask:0xf bank_mask:0xf
    v_add_f32_dpp v242, v242, v242 row_ror:4 row_mask:0xf bank_mask:0xf
    v_add_f32_dpp v243, v243, v243 row_ror:4 row_mask:0xf bank_mask:0xf
    v_add_f32_dpp v244, v244, v244 row_ror:4 row_mask:0xf bank_mask:0xf
    v_add_f32_dpp v245, v245, v245 row_ror:4 row_mask:0xf bank_mask:0xf
    v_add_f32_dpp v246, v246, v246 row_ror:4 row_mask:0xf bank_mask:0xf
    v_add_f32_dpp v247, v247, v247 row_ror:4 row_mask:0xf bank_mask:0xf
    s_nop 1
    v_add_f32_dpp v216, v216, v216 row_ror:2 row_mask:0xf bank_mask:0xf
    v_add_f32_dpp v217, v217, v217 row_ror:2 row_mask:0xf bank_mask:0xf
    v_add_f32_dpp v218, v218, v218 row_ror:2 row_mask:0xf bank_mask:0xf
    v_add_f32_dpp v219, v219, v219 row_ror:2 row_mask:0xf bank_mask:0xf
    v_add_f32_dpp v220, v220, v220 row_ror:2 row_mask:0xf bank_mask:0xf
    v_add_f32_dpp v221, v221, v221 row_ror:2 row_mask:0xf bank_mask:0xf
    v_add_f32_dpp v222, v222, v222 row_ror:2 row_mask:0xf bank_mask:0xf
    v_add_f32_dpp v223, v223, v223 row_ror:2 row_mask:0xf bank_mask:0xf
    v_add_f32_dpp v224, v224, v224 row_ror:2 row_mask:0xf bank_mask:0xf
    v_add_f32_dpp v225, v225, v225 row_ror:2 row_mask:0xf bank_mask:0xf
    v_add_f32_dpp v226, v226, v226 row_ror:2 row_mask:0xf bank_mask:0xf
    v_add_f32_dpp v227, v227, v227 row_ror:2 row_mask:0xf bank_mask:0xf
    v_add_f32_dpp v228, v228, v228 row_ror:2 row_mask:0xf bank_mask:0xf
    v_add_f32_dpp v229, v229, v229 row_ror:2 row_mask:0xf bank_mask:0xf
    v_add_f32_dpp v230, v230, v230 row_ror:2 row_mask:0xf bank_mask:0xf
    v_add_f32_dpp v231, v231, v231 row_ror:2 row_mask:0xf bank_mask:0xf
    v_add_f32_dpp v232, v232, v232 row_ror:2 row_mask:0xf bank_mask:0xf
    v_add_f32_dpp v233, v233, v233 row_ror:2 row_mask:0xf bank_mask:0xf
    v_add_f32_dpp v234, v234, v234 row_ror:2 row_mask:0xf bank_mask:0xf
    v_add_f32_dpp v235, v235, v235 row_ror:2 row_mask:0xf bank_mask:0xf
    v_add_f32_dpp v236, v236, v236 row_ror:2 row_mask:0xf bank_mask:0xf
    v_add_f32_dpp v237, v237, v237 row_ror:2 row_mask:0xf bank_mask:0xf
    v_add_f32_dpp v238, v238, v238 row_ror:2 row_mask:0xf bank_mask:0xf
    v_add_f32_dpp v239, v239, v239 row_ror:2 row_mask:0xf bank_mask:0xf
    v_add_f32_dpp v240, v240, v240 row_ror:2 row_mask:0xf bank_mask:0xf
    v_add_f32_dpp v241, v241, v241 row_ror:2 row_mask:0xf bank_mask:0xf
    v_add_f32_dpp v242, v242, v242 row_ror:2 row_mask:0xf bank_mask:0xf
    v_add_f32_dpp v243, v243, v243 row_ror:2 row_mask:0xf bank_mask:0xf
    v_add_f32_dpp v244, v244, v244 row_ror:2 row_mask:0xf bank_mask:0xf
    v_add_f32_dpp v245, v245, v245 row_ror:2 row_mask:0xf bank_mask:0xf
    v_add_f32_dpp v246, v246, v246 row_ror:2 row_mask:0xf bank_mask:0xf
    v_add_f32_dpp v247, v247, v247 row_ror:2 row_mask:0xf bank_mask:0xf
    s_nop 1
    v_add_f32_dpp v216, v216, v216 row_ror:1 row_mask:0xf bank_mask:0xf
    v_add_f32_dpp v217, v217, v217 row_ror:1 row_mask:0xf bank_mask:0xf
    v_add_f32_dpp v218, v218, v218 row_ror:1 row_mask:0xf bank_mask:0xf
    v_add_f32_dpp v219, v219, v219 row_ror:1 row_mask:0xf bank_mask:0xf
    v_add_f32_dpp v220, v220, v220 row_ror:1 row_mask:0xf bank_mask:0xf
    v_add_f32_dpp v221, v221, v221 row_ror:1 row_mask:0xf bank_mask:0xf
    v_add_f32_dpp v222, v222, v222 row_ror:1 row_mask:0xf bank_mask:0xf
    v_add_f32_dpp v223, v223, v223 row_ror:1 row_mask:0xf bank_mask:0xf
    v_add_f32_dpp v224, v224, v224 row_ror:1 row_mask:0xf bank_mask:0xf
    v_add_f32_dpp v225, v225, v225 row_ror:1 row_mask:0xf bank_mask:0xf
    v_add_f32_dpp v226, v226, v226 row_ror:1 row_mask:0xf bank_mask:0xf
    v_add_f32_dpp v227, v227, v227 row_ror:1 row_mask:0xf bank_mask:0xf
    v_add_f32_dpp v228, v228, v228 row_ror:1 row_mask:0xf bank_mask:0xf
    v_add_f32_dpp v229, v229, v229 row_ror:1 row_mask:0xf bank_mask:0xf
    v_add_f32_dpp v230, v230, v230 row_ror:1 row_mask:0xf bank_mask:0xf
    v_add_f32_dpp v231, v231, v231 row_ror:1 row_mask:0xf bank_mask:0xf
    v_add_f32_dpp v232, v232, v232 row_ror:1 row_mask:0xf bank_mask:0xf
    v_add_f32_dpp v233, v233, v233 row_ror:1 row_mask:0xf bank_mask:0xf
    v_add_f32_dpp v234, v234, v234 row_ror:1 row_mask:0xf bank_mask:0xf
    v_add_f32_dpp v235, v235, v235 row_ror:1 row_mask:0xf bank_mask:0xf
    v_add_f32_dpp v236, v236, v236 row_ror:1 row_mask:0xf bank_mask:0xf
    v_add_f32_dpp v237, v237, v237 row_ror:1 row_mask:0xf bank_mask:0xf
    v_add_f32_dpp v238, v238, v238 row_ror:1 row_mask:0xf bank_mask:0xf
    v_add_f32_dpp v239, v239, v239 row_ror:1 row_mask:0xf bank_mask:0xf
    v_add_f32_dpp v240, v240, v240 row_ror:1 row_mask:0xf bank_mask:0xf
    v_add_f32_dpp v241, v241, v241 row_ror:1 row_mask:0xf bank_mask:0xf
    v_add_f32_dpp v242, v242, v242 row_ror:1 row_mask:0xf bank_mask:0xf
    v_add_f32_dpp v243, v243, v243 row_ror:1 row_mask:0xf bank_mask:0xf
    v_add_f32_dpp v244, v244, v244 row_ror:1 row_mask:0xf bank_mask:0xf
    v_add_f32_dpp v245, v245, v245 row_ror:1 row_mask:0xf bank_mask:0xf
    v_add_f32_dpp v246, v246, v246 row_ror:1 row_mask:0xf bank_mask:0xf
    v_add_f32_dpp v247, v247, v247 row_ror:1 row_mask:0xf bank_mask:0xf
    s_nop 1
    ds_swizzle_b32 v24, v216 offset:0x401F
    ds_swizzle_b32 v25, v217 offset:0x401F
    ds_swizzle_b32 v26, v218 offset:0x401F
    ds_swizzle_b32 v27, v219 offset:0x401F
    ds_swizzle_b32 v28, v220 offset:0x401F
    ds_swizzle_b32 v29, v221 offset:0x401F
    ds_swizzle_b32 v30, v222 offset:0x401F
    ds_swizzle_b32 v31, v223 offset:0x401F
    ds_swizzle_b32 v32, v224 offset:0x401F
    ds_swizzle_b32 v33, v225 offset:0x401F
    ds_swizzle_b32 v34, v226 offset:0x401F
    ds_swizzle_b32 v35, v227 offset:0x401F
    ds_swizzle_b32 v36, v228 offset:0x401F
    ds_swizzle_b32 v37, v229 offset:0x401F
    ds_swizzle_b32 v38, v230 offset:0x401F
    ds_swizzle_b32 v39, v231 offset:0x401F
    ds_swizzle_b32 v40, v232 offset:0x401F
    ds_swizzle_b32 v41, v233 offset:0x401F
    ds_swizzle_b32 v42, v234 offset:0x401F
    ds_swizzle_b32 v43, v235 offset:0x401F
    ds_swizzle_b32 v44, v236 offset:0x401F
    ds_swizzle_b32 v45, v237 offset:0x401F
    ds_swizzle_b32 v46, v238 offset:0x401F
    ds_swizzle_b32 v47, v239 offset:0x401F
    ds_swizzle_b32 v48, v240 offset:0x401F
    ds_swizzle_b32 v49, v241 offset:0x401F
    ds_swizzle_b32 v50, v242 offset:0x401F
    ds_swizzle_b32 v51, v243 offset:0x401F
    ds_swizzle_b32 v52, v244 offset:0x401F
    ds_swizzle_b32 v53, v245 offset:0x401F
    ds_swizzle_b32 v54, v246 offset:0x401F
    ds_swizzle_b32 v55, v247 offset:0x401F
    s_waitcnt lgkmcnt(0)
    v_add_f32 v216, v216, v24
    v_add_f32 v217, v217, v25
    v_add_f32 v218, v218, v26
    v_add_f32 v219, v219, v27
    v_add_f32 v220, v220, v28
    v_add_f32 v221, v221, v29
    v_add_f32 v222, v222, v30
    v_add_f32 v223, v223, v31
    v_add_f32 v224, v224, v32
    v_add_f32 v225, v225, v33
    v_add_f32 v226, v226, v34
    v_add_f32 v227, v227, v35
    v_add_f32 v228, v228, v36
    v_add_f32 v229, v229, v37
    v_add_f32 v230, v230, v38
    v_add_f32 v231, v231, v39
    v_add_f32 v232, v232, v40
    v_add_f32 v233, v233, v41
    v_add_f32 v234, v234, v42
    v_add_f32 v235, v235, v43
    v_add_f32 v236, v236, v44
    v_add_f32 v237, v237, v45
    v_add_f32 v238, v238, v46
    v_add_f32 v239, v239, v47
    v_add_f32 v240, v240, v48
    v_add_f32 v241, v241, v49
    v_add_f32 v242, v242, v50
    v_add_f32 v243, v243, v51
    v_add_f32 v244, v244, v52
    v_add_f32 v245, v245, v53
    v_add_f32 v246, v246, v54
    v_add_f32 v247, v247, v55
    v_lshlrev_b32 v12, 5, v5
    s_sub_u32 s39, s32, 8
    s_lshl_b32 s39, s39, 1
    s_add_u32 s39, s39, s29
    s_lshl_b32 s39, s39, 14
    s_lshl_b32 s40, s36, 3
    s_add_u32 s39, s39, s40
    s_add_u32 s39, s39, 3407872
    v_cmp_eq_u32 vcc, 0, v4
    s_and_saveexec_b64 s[54:55], vcc
    buffer_store_dwordx4 v[216:219], v12, s[24:27], s39 offen offset:0
    buffer_store_dwordx4 v[220:223], v12, s[24:27], s39 offen offset:16
    buffer_store_dwordx4 v[224:227], v12, s[24:27], s39 offen offset:64
    buffer_store_dwordx4 v[228:231], v12, s[24:27], s39 offen offset:80
    buffer_store_dwordx4 v[232:235], v12, s[24:27], s39 offen offset:128
    buffer_store_dwordx4 v[236:239], v12, s[24:27], s39 offen offset:144
    buffer_store_dwordx4 v[240:243], v12, s[24:27], s39 offen offset:192
    buffer_store_dwordx4 v[244:247], v12, s[24:27], s39 offen offset:208
k1_end:
    s_endpgm
.text
.globl kn_kernel
.p2align 8
.type kn_kernel,@function
kn_kernel:
    s_cmp_ge_u32 s2, 256
    s_cbranch_scc1 kn_end
    s_load_dwordx2 s[14:15], s[0:1], 96
    s_load_dwordx2 s[4:5], s[0:1], 32
    s_load_dwordx2 s[6:7], s[0:1], 56
    s_load_dwordx2 s[8:9], s[0:1], 72
    v_lshrrev_b32 v4, 6, v0
    s_nop 0
    v_readfirstlane_b32 s28, v4
    s_mov_b32 s45, 0xffff0000
    s_lshr_b32 s32, s2, 4
    s_and_b32 s33, s2, 15
    v_and_b32 v7, 15, v0
    v_lshrrev_b32 v8, 4, v0
    v_lshlrev_b32 v8, 12, v8
    v_lshl_add_u32 v12, v7, 4, v8
    v_lshlrev_b32 v13, 3, v0
    s_mul_i32 s39, s32, 589824
    s_lshl_b32 s40, s33, 8
    s_add_u32 s39, s39, s40
    s_add_u32 s34, s39, 25165824
    s_add_u32 s36, s39, 14680064
    s_lshl_b32 s39, s2, 8
    v_and_b32 v6, 255, v0
    v_add_u32 v6, s39, v6
    v_lshlrev_b32 v6, 7, v6
    s_waitcnt lgkmcnt(0)
    s_mov_b32 s24, s14
    s_mov_b32 s25, s15
    s_mov_b32 s26, 0x10000000
    s_mov_b32 s27, 0x00020000
    s_mov_b32 s52, s6
    s_mov_b32 s53, s7
    s_mov_b32 s54, 8388608
    s_mov_b32 s55, 0x00020000
    s_mov_b32 s56, s4
    s_mov_b32 s57, s5
    s_mov_b32 s58, 663552
    s_mov_b32 s59, 0x00020000
    s_mov_b32 s60, s8
    s_mov_b32 s61, s9
    s_mov_b32 s62, 2654208
    s_mov_b32 s63, 0x00020000
    s_cmp_ge_u32 s28, 2
    s_cbranch_scc1 kn_nostat0
    s_lshl_b32 s39, s33, 10
    s_add_u32 s39, s39, 3407872
    buffer_load_dwordx2 v[36:37], v13, s[24:27], s39 offen
    s_add_u32 s39, s39, 16384
    buffer_load_dwordx2 v[38:39], v13, s[24:27], s39 offen
    s_add_u32 s39, s39, 16384
    buffer_load_dwordx2 v[40:41], v13, s[24:27], s39 offen
    s_add_u32 s39, s39, 16384
    buffer_load_dwordx2 v[42:43], v13, s[24:27], s39 offen
    s_add_u32 s39, s39, 16384
    buffer_load_dwordx2 v[44:45], v13, s[24:27], s39 offen
    s_add_u32 s39, s39, 16384
    buffer_load_dwordx2 v[46:47], v13, s[24:27], s39 offen
    s_add_u32 s39, s39, 16384
    buffer_load_dwordx2 v[48:49], v13, s[24:27], s39 offen
    s_add_u32 s39, s39, 16384
    buffer_load_dwordx2 v[50:51], v13, s[24:27], s39 offen
    s_add_u32 s39, s39, 16384
    buffer_load_dwordx2 v[52:53], v13, s[24:27], s39 offen
    s_add_u32 s39, s39, 16384
    buffer_load_dwordx2 v[54:55], v13, s[24:27], s39 offen
    s_add_u32 s39, s39, 16384
    buffer_load_dwordx2 v[56:57], v13, s[24:27], s39 offen
    s_add_u32 s39, s39, 16384
    buffer_load_dwordx2 v[58:59], v13, s[24:27], s39 offen
    s_add_u32 s39, s39, 16384
    buffer_load_dwordx2 v[60:61], v13, s[24:27], s39 offen
    s_add_u32 s39, s39, 16384
    buffer_load_dwordx2 v[62:63], v13, s[24:27], s39 offen
    s_add_u32 s39, s39, 16384
    buffer_load_dwordx2 v[64:65], v13, s[24:27], s39 offen
    s_add_u32 s39, s39, 16384
    buffer_load_dwordx2 v[66:67], v13, s[24:27], s39 offen
    s_add_u32 s39, s39, 16384
kn_nostat0:
    buffer_load_dwordx4 v[16:19], v12, s[24:27], s36 offen
    s_add_u32 s36, s36, 131072
    buffer_load_dwordx4 v[20:23], v12, s[24:27], s36 offen
    s_add_u32 s36, s36, 131072
    buffer_load_dwordx4 v[24:27], v12, s[24:27], s36 offen
    s_add_u32 s36, s36, 131072
    buffer_load_dwordx4 v[28:31], v12, s[24:27], s36 offen
    s_add_u32 s36, s36, 131072
    s_cmp_ge_u32 s28, 4
    s_cbranch_scc1 kn_a
    buffer_load_dwordx4 v[32:35], v12, s[24:27], s36 offen
kn_a:
    s_cmp_ge_u32 s28, 2
    s_cbranch_scc1 kn_nostat
    s_waitcnt vmcnt(5)
    v_add_f32 v36, v36, v38
    v_add_f32 v37, v37, v39
    v_add_f32 v36, v36, v40
    v_add_f32 v37, v37, v41
    v_add_f32 v36, v36, v42
    v_add_f32 v37, v37, v43
    v_add_f32 v36, v36, v44
    v_add_f32 v37, v37, v45
    v_add_f32 v36, v36, v46
    v_add_f32 v37, v37, v47
    v_add_f32 v36, v36, v48
    v_add_f32 v37, v37, v49
    v_add_f32 v36, v36, v50
    v_add_f32 v37, v37, v51
    v_add_f32 v36, v36, v52
    v_add_f32 v37, v37, v53
    v_add_f32 v36, v36, v54
    v_add_f32 v37, v37, v55
    v_add_f32 v36, v36, v56
    v_add_f32 v37, v37, v57
    v_add_f32 v36, v36, v58
    v_add_f32 v37, v37, v59
    v_add_f32 v36, v36, v60
    v_add_f32 v37, v37, v61
    v_add_f32 v36, v36, v62
    v_add_f32 v37, v37, v63
    v_add_f32 v36, v36, v64
    v_add_f32 v37, v37, v65
    v_add_f32 v36, v36, v66
    v_add_f32 v37, v37, v67
    v_mul_f32 v9, 0x39e38e39, v36
    v_mul_f32 v8, 0x39e38e39, v37
    v_fma_f32 v8, -v9, v9, v8
    v_max_f32 v8, 0, v8
    v_cvt_pk_bf16_f32 v10, v9, v9
    v_lshlrev_b32 v9, 16, v10
    v_cvt_pk_bf16_f32 v10, v8, v8
    v_lshlrev_b32 v8, 16, v10
    v_add_f32 v8, 0x3727c5ac, v8
    v_cvt_pk_bf16_f32 v10, v8, v8
    v_lshlrev_b32 v8, 16, v10
    v_sqrt_f32 v8, v8
    s_nop 0
    v_cvt_pk_bf16_f32 v10, v8, v8
    v_lshlrev_b32 v8, 16, v10
    v_rcp_f32 v38, v8
    s_nop 0
    v_mul_f32 v39, v9, v38
    v_sub_f32 v39, 0, v39
    ds_write_b64 v13, v[38:39]
kn_nostat:
    s_waitcnt lgkmcnt(0)
    s_barrier
    v_lshlrev_b32 v9, 6, v7
    ds_read_b128 v[52:55], v9 offset:0
    ds_read_b128 v[56:59], v9 offset:16
    ds_read_b128 v[60:63], v9 offset:32
    ds_read_b128 v[64:67], v9 offset:48
    s_waitcnt vmcnt(0) lgkmcnt(0)
    v_lshlrev_b32 v4, 16, v16
    v_and_b32 v5, s45, v16
    v_fma_f32 v4, v4, v52, v53
    v_fma_f32 v5, v5, v54, v55
    v_cvt_pk_bf16_f32 v16, v4, v5
    v_lshlrev_b32 v4, 16, v17
    v_and_b32 v5, s45, v17
    v_fma_f32 v4, v4, v56, v57
    v_fma_f32 v5, v5, v58, v59
    v_cvt_pk_bf16_f32 v17, v4, v5
    v_lshlrev_b32 v4, 16, v18
    v_and_b32 v5, s45, v18
    v_fma_f32 v4, v4, v60, v61
    v_fma_f32 v5, v5, v62, v63
    v_cvt_pk_bf16_f32 v18, v4, v5
    v_lshlrev_b32 v4, 16, v19
    v_and_b32 v5, s45, v19
    v_fma_f32 v4, v4, v64, v65
    v_fma_f32 v5, v5, v66, v67
    v_cvt_pk_bf16_f32 v19, v4, v5
    buffer_store_dwordx4 v[16:19], v12, s[24:27], s34 offen
    s_add_u32 s34, s34, 131072
    v_lshlrev_b32 v4, 16, v20
    v_and_b32 v5, s45, v20
    v_fma_f32 v4, v4, v52, v53
    v_fma_f32 v5, v5, v54, v55
    v_cvt_pk_bf16_f32 v20, v4, v5
    v_lshlrev_b32 v4, 16, v21
    v_and_b32 v5, s45, v21
    v_fma_f32 v4, v4, v56, v57
    v_fma_f32 v5, v5, v58, v59
    v_cvt_pk_bf16_f32 v21, v4, v5
    v_lshlrev_b32 v4, 16, v22
    v_and_b32 v5, s45, v22
    v_fma_f32 v4, v4, v60, v61
    v_fma_f32 v5, v5, v62, v63
    v_cvt_pk_bf16_f32 v22, v4, v5
    v_lshlrev_b32 v4, 16, v23
    v_and_b32 v5, s45, v23
    v_fma_f32 v4, v4, v64, v65
    v_fma_f32 v5, v5, v66, v67
    v_cvt_pk_bf16_f32 v23, v4, v5
    buffer_store_dwordx4 v[20:23], v12, s[24:27], s34 offen
    s_add_u32 s34, s34, 131072
    v_lshlrev_b32 v4, 16, v24
    v_and_b32 v5, s45, v24
    v_fma_f32 v4, v4, v52, v53
    v_fma_f32 v5, v5, v54, v55
    v_cvt_pk_bf16_f32 v24, v4, v5
    v_lshlrev_b32 v4, 16, v25
    v_and_b32 v5, s45, v25
    v_fma_f32 v4, v4, v56, v57
    v_fma_f32 v5, v5, v58, v59
    v_cvt_pk_bf16_f32 v25, v4, v5
    v_lshlrev_b32 v4, 16, v26
    v_and_b32 v5, s45, v26
    v_fma_f32 v4, v4, v60, v61
    v_fma_f32 v5, v5, v62, v63
    v_cvt_pk_bf16_f32 v26, v4, v5
    v_lshlrev_b32 v4, 16, v27
    v_and_b32 v5, s45, v27
    v_fma_f32 v4, v4, v64, v65
    v_fma_f32 v5, v5, v66, v67
    v_cvt_pk_bf16_f32 v27, v4, v5
    buffer_store_dwordx4 v[24:27], v12, s[24:27], s34 offen
    s_add_u32 s34, s34, 131072
    v_lshlrev_b32 v4, 16, v28
    v_and_b32 v5, s45, v28
    v_fma_f32 v4, v4, v52, v53
    v_fma_f32 v5, v5, v54, v55
    v_cvt_pk_bf16_f32 v28, v4, v5
    v_lshlrev_b32 v4, 16, v29
    v_and_b32 v5, s45, v29
    v_fma_f32 v4, v4, v56, v57
    v_fma_f32 v5, v5, v58, v59
    v_cvt_pk_bf16_f32 v29, v4, v5
    v_lshlrev_b32 v4, 16, v30
    v_and_b32 v5, s45, v30
    v_fma_f32 v4, v4, v60, v61
    v_fma_f32 v5, v5, v62, v63
    v_cvt_pk_bf16_f32 v30, v4, v5
    v_lshlrev_b32 v4, 16, v31
    v_and_b32 v5, s45, v31
    v_fma_f32 v4, v4, v64, v65
    v_fma_f32 v5, v5, v66, v67
    v_cvt_pk_bf16_f32 v31, v4, v5
    buffer_store_dwordx4 v[28:31], v12, s[24:27], s34 offen
    s_add_u32 s34, s34, 131072
    s_cmp_ge_u32 s28, 4
    s_cbranch_scc1 kn_end
    v_lshlrev_b32 v4, 16, v32
    v_and_b32 v5, s45, v32
    v_fma_f32 v4, v4, v52, v53
    v_fma_f32 v5, v5, v54, v55
    v_cvt_pk_bf16_f32 v32, v4, v5
    v_lshlrev_b32 v4, 16, v33
    v_and_b32 v5, s45, v33
    v_fma_f32 v4, v4, v56, v57
    v_fma_f32 v5, v5, v58, v59
    v_cvt_pk_bf16_f32 v33, v4, v5
    v_lshlrev_b32 v4, 16, v34
    v_and_b32 v5, s45, v34
    v_fma_f32 v4, v4, v60, v61
    v_fma_f32 v5, v5, v62, v63
    v_cvt_pk_bf16_f32 v34, v4, v5
    v_lshlrev_b32 v4, 16, v35
    v_and_b32 v5, s45, v35
    v_fma_f32 v4, v4, v64, v65
    v_fma_f32 v5, v5, v66, v67
    v_cvt_pk_bf16_f32 v35, v4, v5
    buffer_store_dwordx4 v[32:35], v12, s[24:27], s34 offen
    s_add_u32 s34, s34, 131072
kn_end:
    s_endpgm
.text
.globl kf_kernel
.p2align 8
.type kf_kernel,@function
kf_kernel:
    s_cmp_ge_u32 s2, 256
    s_cbranch_scc1 kf_end
    s_load_dwordx4 s[4:7], s[0:1], 56
    s_load_dwordx2 s[14:15], s[0:1], 96
    s_load_dwordx2 s[8:9], s[0:1], 32
    s_load_dwordx2 s[10:11], s[0:1], 72
    v_lshrrev_b32 v1, 6, v0
    s_nop 0
    v_readfirstlane_b32 s28, v1
    s_waitcnt lgkmcnt(0)
    s_mov_b32 s24, s14
    s_mov_b32 s25, s15
    s_mov_b32 s26, 0x10000000
    s_mov_b32 s27, 0x00020000
    s_cmp_ge_u32 s28, 8
    s_cbranch_scc1 kf_gemm
    v_and_b32 v1, 63, v0
    v_and_b32 v2, 31, v1
    v_lshrrev_b32 v3, 5, v1
    s_and_b32 s30, s2, 3
    s_lshl_b32 s30, s30, 3
    s_add_u32 s30, s30, s28
    s_lshr_b32 s31, s2, 2
    s_lshl_b32 s31, s31, 5
    s_mul_i32 s39, s31, 1152
    s_mul_i32 s40, s30, 36
    s_add_u32 s39, s39, s40
    s_add_u32 s39, s39, 0
    s_movk_i32 s40, 1152
    v_lshlrev_b32 v5, 4, v3
    v_mad_u32_u24 v5, v2, s40, v5
    v_mul_u32_u24 v4, s40, v2
    s_mov_b32 s46, -1
    s_mov_b32 s47, 0
    s_mov_b32 s48, 0x3ffff
    s_mov_b32 s49, 0x3ffff
    buffer_load_dwordx4 v[16:19], v5, s[24:27], s39 offen
    buffer_load_dword v20, v4, s[24:27], s39 offen offset:32
    v_lshlrev_b32 v13, 4, v1
    s_lshl_b32 s43, s28, 10
    s_add_u32 s42, s43, 3145728
    s_add_u32 s43, s43, 139264
    s_mov_b32 s54, -1
    s_cmp_lt_u32 s28, 4
    s_cselect_b32 s55, -1, 0
    s_cmp_ge_u32 s28, 5
    s_cbranch_scc1 kfkv_1
    s_add_u32 m0, s43, 0
    s_mov_b64 exec, s[54:55]
    buffer_load_dwordx4 v13, s[24:27], s42 offen lds
    s_mov_b64 exec, -1
    s_add_u32 s42, s42, 4608
kfkv_1:
    s_cmp_ge_u32 s28, 5
    s_cbranch_scc1 kfkv_2
    s_add_u32 m0, s43, 4608
    s_mov_b64 exec, s[54:55]
    buffer_load_dwordx4 v13, s[24:27], s42 offen lds
    s_mov_b64 exec, -1
    s_add_u32 s42, s42, 4608
kfkv_2:
    s_cmp_ge_u32 s28, 5
    s_cbranch_scc1 kfkv_3
    s_add_u32 m0, s43, 9216
    s_mov_b64 exec, s[54:55]
    buffer_load_dwordx4 v13, s[24:27], s42 offen lds
    s_mov_b64 exec, -1
    s_add_u32 s42, s42, 4608
kfkv_3:
    v_lshlrev_b32 v8, 4, v3
    v_lshl_add_u32 v8, v2, 5, v8
    v_add_u32 v8, 139264, v8
    v_lshlrev_b32 v9, 2, v2
    v_add_u32 v9, 139264, v9
    s_movk_i32 s39, 288
    v_mul_u32_u24 v10, s39, v3
    v_lshl_add_u32 v10, v2, 4, v10
    v_add_u32 v10, 139264, v10
    s_mov_b32 s50, 0xff800000
    s_mov_b32 s51, 0xff800000
    s_mov_b32 s52, 0x07060302
    v_cmp_eq_u32 vcc, 18, v2
    v_mov_b32 v4, 0x3f803f80
    v_mov_b32 v21, 0
    v_mov_b32 v22, 0
    v_mov_b32 v23, 0
    v_mov_b32 v144, 0
    v_mov_b32 v145, 0
    v_mov_b32 v146, 0
    v_mov_b32 v147, 0
    v_cndmask_b32 v152, 0, v4, vcc
    v_cndmask_b32 v153, 0, v4, vcc
    v_cndmask_b32 v154, 0, v4, vcc
    v_cndmask_b32 v155, 0, v4, vcc
    v_cndmask_b32 v156, 0, v4, vcc
    v_cndmask_b32 v157, 0, v4, vcc
    v_cndmask_b32 v158, 0, v4, vcc
    v_cndmask_b32 v159, 0, v4, vcc
    v_mov_b32 v148, 0
    v_mov_b32 v149, 0
    v_mov_b32 v150, 0
    v_mov_b32 v151, 0
    v_cndmask_b32 v160, 0, v4, vcc
    v_cndmask_b32 v161, 0, v4, vcc
    v_cndmask_b32 v162, 0, v4, vcc
    v_cndmask_b32 v163, 0, v4, vcc
    v_cndmask_b32 v164, 0, v4, vcc
    v_cndmask_b32 v165, 0, v4, vcc
    v_cndmask_b32 v166, 0, v4, vcc
    v_cndmask_b32 v167, 0, v4, vcc
    v_mov_b32 v88, 0
    v_mov_b32 v104, 0
    v_mov_b32 v120, 0
    v_mov_b32 v89, 0
    v_mov_b32 v105, 0
    v_mov_b32 v121, 0
    v_mov_b32 v90, 0
    v_mov_b32 v106, 0
    v_mov_b32 v122, 0
    v_mov_b32 v91, 0
    v_mov_b32 v107, 0
    v_mov_b32 v123, 0
    v_mov_b32 v92, 0
    v_mov_b32 v108, 0
    v_mov_b32 v124, 0
    v_mov_b32 v93, 0
    v_mov_b32 v109, 0
    v_mov_b32 v125, 0
    v_mov_b32 v94, 0
    v_mov_b32 v110, 0
    v_mov_b32 v126, 0
    v_mov_b32 v95, 0
    v_mov_b32 v111, 0
    v_mov_b32 v127, 0
    v_mov_b32 v96, 0
    v_mov_b32 v112, 0
    v_mov_b32 v128, 0
    v_mov_b32 v97, 0
    v_mov_b32 v113, 0
    v_mov_b32 v129, 0
    v_mov_b32 v98, 0
    v_mov_b32 v114, 0
    v_mov_b32 v130, 0
    v_mov_b32 v99, 0
    v_mov_b32 v115, 0
    v_mov_b32 v131, 0
    v_mov_b32 v100, 0
    v_mov_b32 v116, 0
    v_mov_b32 v132, 0
    v_mov_b32 v101, 0
    v_mov_b32 v117, 0
    v_mov_b32 v133, 0
    v_mov_b32 v102, 0
    v_mov_b32 v118, 0
    v_mov_b32 v134, 0
    v_mov_b32 v103, 0
    v_mov_b32 v119, 0
    v_mov_b32 v135, 0
    s_waitcnt vmcnt(0)
    s_barrier
    v_cmp_gt_u32 vcc, 32, v1
    s_nop 1
    v_cndmask_b32 v20, 0, v20, vcc
    ds_read_b128 v[136:139], v8 offset:0
    ds_read_b128 v[140:143], v8 offset:2304
    s_mov_b64 exec, s[46:47]
    ds_read_b32 v144, v9 offset:1024
    ds_read_b32 v148, v9 offset:3328
    s_mov_b64 exec, -1
    s_waitcnt lgkmcnt(0)
    s_nop 0
    v_mfma_f32_32x32x16_bf16 v[24:39], v[136:139], v[16:19], v[120:135]
    v_mfma_f32_32x32x16_bf16 v[40:55], v[140:143], v[16:19], v[120:135]
    v_mfma_f32_32x32x16_bf16 v[24:39], v[144:147], v[20:23], v[24:39]
    v_mfma_f32_32x32x16_bf16 v[40:55], v[148:151], v[20:23], v[40:55]
    ds_read_b128 v[136:139], v8 offset:4608
    ds_read_b128 v[140:143], v8 offset:6912
    s_mov_b64 exec, s[46:47]
    ds_read_b32 v144, v9 offset:5632
    ds_read_b32 v148, v9 offset:7936
    s_mov_b64 exec, -1
    s_cmp_lt_u32 s28, 6
    s_cbranch_scc1 kf_nopf
    s_mov_b32 s56, s8
    s_mov_b32 s57, s9
    s_mov_b32 s58, 663552
    s_mov_b32 s59, 0x00020000
    s_mov_b32 s60, s10
    s_mov_b32 s61, s11
    s_mov_b32 s62, 2654208
    s_mov_b32 s63, 0x00020000
    s_lshl_b32 s39, s2, 7
    v_and_b32 v5, 127, v0
    v_add_u32 v5, s39, v5
    v_lshlrev_b32 v5, 7, v5
    buffer_load_dword v13, v5, s[56:59], 0 offen
    buffer_load_dword v13, v5, s[60:63], 0 offen
kf_nopf:
    s_waitcnt lgkmcnt(0)
    s_nop 7
    s_nop 7
    s_mov_b32 s35, 0
kf_aloop:
    s_cmp_ge_u32 s35, 29
    s_cbranch_scc1 kfsk_4
    s_cmp_ge_u32 s28, 5
    s_cbranch_scc1 kfkv_5
    s_add_u32 m0, s43, 13824
    s_mov_b64 exec, s[54:55]
    buffer_load_dwordx4 v13, s[24:27], s42 offen lds
    s_mov_b64 exec, -1
    s_add_u32 s42, s42, 4608
kfkv_5:
kfsk_4:
    v_mfma_f32_32x32x16_bf16 v[104:119], v[160:163], v[96:99], v[104:119]
    s_mov_b64 exec, s[48:49]
    ds_read_b128 v[152:155], v10 offset:1152
    ds_read_b128 v[156:159], v10 offset:1728
    s_mov_b64 exec, -1
    v_max3_f32 v11, v24, v25, v26
    v_max3_f32 v4, v27, v28, v29
    v_max3_f32 v11, v11, v30, v31
    v_max3_f32 v4, v4, v32, v33
    v_max3_f32 v11, v11, v34, v35
    v_max3_f32 v4, v4, v36, v37
    v_max3_f32 v11, v11, v38, v39
    v_mfma_f32_32x32x16_bf16 v[104:119], v[164:167], v[100:103], v[104:119]
    v_max3_f32 v4, v4, v40, v41
    v_max3_f32 v11, v11, v42, v43
    v_max3_f32 v4, v4, v44, v45
    v_max3_f32 v11, v11, v46, v47
    v_max3_f32 v4, v4, v48, v49
    v_max3_f32 v11, v11, v50, v51
    v_max3_f32 v4, v4, v52, v53
    v_max3_f32 v11, v11, v54, v55
    v_max_f32 v11, v11, v4
    v_cmp_lt_f32 vcc, s50, v11
    s_nop 0
    s_cbranch_vccnz kfrare_6
kfback_7:
    v_mfma_f32_32x32x16_bf16 v[56:71], v[136:139], v[16:19], v[120:135]
    s_mov_b64 exec, s[48:49]
    ds_read_b128 v[160:163], v10 offset:3456
    ds_read_b128 v[164:167], v10 offset:4032
    s_mov_b64 exec, -1
    v_exp_f32 v24, v24
    v_exp_f32 v25, v25
    v_exp_f32 v26, v26
    v_exp_f32 v27, v27
    v_exp_f32 v28, v28
    v_exp_f32 v29, v29
    v_mfma_f32_32x32x16_bf16 v[72:87], v[140:143], v[16:19], v[120:135]
    v_exp_f32 v30, v30
    v_exp_f32 v31, v31
    v_exp_f32 v32, v32
    v_exp_f32 v33, v33
    v_exp_f32 v34, v34
    v_exp_f32 v35, v35
    v_mfma_f32_32x32x16_bf16 v[56:71], v[144:147], v[20:23], v[56:71]
    v_exp_f32 v36, v36
    v_exp_f32 v37, v37
    v_exp_f32 v38, v38
    v_exp_f32 v39, v39
    v_exp_f32 v40, v40
    v_exp_f32 v41, v41
    v_mfma_f32_32x32x16_bf16 v[72:87], v[148:151], v[20:23], v[72:87]
    v_cvt_pk_bf16_f32 v88, v24, v25
    v_cvt_pk_bf16_f32 v89, v26, v27
    v_cvt_pk_bf16_f32 v90, v28, v29
    v_cvt_pk_bf16_f32 v91, v30, v31
    v_cvt_pk_bf16_f32 v92, v32, v33
    v_cvt_pk_bf16_f32 v93, v34, v35
    v_cvt_pk_bf16_f32 v94, v36, v37
    v_cvt_pk_bf16_f32 v95, v38, v39
    s_waitcnt lgkmcnt(2)
    s_nop 0
    v_mfma_f32_32x32x16_bf16 v[104:119], v[152:155], v[88:91], v[104:119]
    v_exp_f32 v42, v42
    v_exp_f32 v43, v43
    v_exp_f32 v44, v44
    v_exp_f32 v45, v45
    v_exp_f32 v46, v46
    v_exp_f32 v47, v47
    ds_read_b128 v[136:139], v8 offset:9216
    ds_read_b128 v[140:143], v8 offset:11520
    s_mov_b64 exec, s[46:47]
    ds_read_b32 v144, v9 offset:10240
    ds_read_b32 v148, v9 offset:12544
    s_mov_b64 exec, -1
    v_mfma_f32_32x32x16_bf16 v[104:119], v[156:159], v[92:95], v[104:119]
    v_exp_f32 v48, v48
    v_exp_f32 v49, v49
    v_exp_f32 v50, v50
    v_exp_f32 v51, v51
    v_exp_f32 v52, v52
    v_exp_f32 v53, v53
    v_exp_f32 v54, v54
    v_exp_f32 v55, v55
    s_nop 0
    v_cvt_pk_bf16_f32 v96, v40, v41
    v_cvt_pk_bf16_f32 v97, v42, v43
    v_cvt_pk_bf16_f32 v98, v44, v45
    v_cvt_pk_bf16_f32 v99, v46, v47
    v_cvt_pk_bf16_f32 v100, v48, v49
    v_cvt_pk_bf16_f32 v101, v50, v51
    v_cvt_pk_bf16_f32 v102, v52, v53
    v_cvt_pk_bf16_f32 v103, v54, v55
    s_cmp_ge_u32 s28, 5
    s_cbranch_scc1 kfw_8
    s_waitcnt vmcnt(0)
kfw_8:
    s_waitcnt lgkmcnt(0)
    s_barrier
    s_cmp_ge_u32 s35, 28
    s_cbranch_scc1 kfsk_9
    s_cmp_ge_u32 s28, 5
    s_cbranch_scc1 kfkv_10
    s_add_u32 m0, s43, 0
    s_mov_b64 exec, s[54:55]
    buffer_load_dwordx4 v13, s[24:27], s42 offen lds
    s_mov_b64 exec, -1
    s_add_u32 s42, s42, 4608
kfkv_10:
kfsk_9:
    v_mfma_f32_32x32x16_bf16 v[104:119], v[160:163], v[96:99], v[104:119]
    s_mov_b64 exec, s[48:49]
    ds_read_b128 v[152:155], v10 offset:5760
    ds_read_b128 v[156:159], v10 offset:6336
    s_mov_b64 exec, -1
    v_max3_f32 v11, v56, v57, v58
    v_max3_f32 v4, v59, v60, v61
    v_max3_f32 v11, v11, v62, v63
    v_max3_f32 v4, v4, v64, v65
    v_max3_f32 v11, v11, v66, v67
    v_max3_f32 v4, v4, v68, v69
    v_max3_f32 v11, v11, v70, v71
    v_mfma_f32_32x32x16_bf16 v[104:119], v[164:167], v[100:103], v[104:119]
    v_max3_f32 v4, v4, v72, v73
    v_max3_f32 v11, v11, v74, v75
    v_max3_f32 v4, v4, v76, v77
    v_max3_f32 v11, v11, v78, v79
    v_max3_f32 v4, v4, v80, v81
    v_max3_f32 v11, v11, v82, v83
    v_max3_f32 v4, v4, v84, v85
    v_max3_f32 v11, v11, v86, v87
    v_max_f32 v11, v11, v4
    v_cmp_lt_f32 vcc, s50, v11
    s_nop 0
    s_cbranch_vccnz kfrare_11
kfback_12:
    v_mfma_f32_32x32x16_bf16 v[24:39], v[136:139], v[16:19], v[120:135]
    s_mov_b64 exec, s[48:49]
    ds_read_b128 v[160:163], v10 offset:8064
    ds_read_b128 v[164:167], v10 offset:8640
    s_mov_b64 exec, -1
    v_exp_f32 v56, v56
    v_exp_f32 v57, v57
    v_exp_f32 v58, v58
    v_exp_f32 v59, v59
    v_exp_f32 v60, v60
    v_exp_f32 v61, v61
    v_mfma_f32_32x32x16_bf16 v[40:55], v[140:143], v[16:19], v[120:135]
    v_exp_f32 v62, v62
    v_exp_f32 v63, v63
    v_exp_f32 v64, v64
    v_exp_f32 v65, v65
    v_exp_f32 v66, v66
    v_exp_f32 v67, v67
    v_mfma_f32_32x32x16_bf16 v[24:39], v[144:147], v[20:23], v[24:39]
    v_exp_f32 v68, v68
    v_exp_f32 v69, v69
    v_exp_f32 v70, v70
    v_exp_f32 v71, v71
    v_exp_f32 v72, v72
    v_exp_f32 v73, v73
    v_mfma_f32_32x32x16_bf16 v[40:55], v[148:151], v[20:23], v[40:55]
    v_cvt_pk_bf16_f32 v88, v56, v57
    v_cvt_pk_bf16_f32 v89, v58, v59
    v_cvt_pk_bf16_f32 v90, v60, v61
    v_cvt_pk_bf16_f32 v91, v62, v63
    v_cvt_pk_bf16_f32 v92, v64, v65
    v_cvt_pk_bf16_f32 v93, v66, v67
    v_cvt_pk_bf16_f32 v94, v68, v69
    v_cvt_pk_bf16_f32 v95, v70, v71
    s_waitcnt lgkmcnt(2)
    s_nop 0
    v_mfma_f32_32x32x16_bf16 v[104:119], v[152:155], v[88:91], v[104:119]
    v_exp_f32 v74, v74
    v_exp_f32 v75, v75
    v_exp_f32 v76, v76
    v_exp_f32 v77, v77
    v_exp_f32 v78, v78
    v_exp_f32 v79, v79
    ds_read_b128 v[136:139], v8 offset:13824
    ds_read_b128 v[140:143], v8 offset:16128
    s_mov_b64 exec, s[46:47]
    ds_read_b32 v144, v9 offset:14848
    ds_read_b32 v148, v9 offset:17152
    s_mov_b64 exec, -1
    v_mfma_f32_32x32x16_bf16 v[104:119], v[156:159], v[92:95], v[104:119]
    v_exp_f32 v80, v80
    v_exp_f32 v81, v81
    v_exp_f32 v82, v82
    v_exp_f32 v83, v83
    v_exp_f32 v84, v84
    v_exp_f32 v85, v85
    v_exp_f32 v86, v86
    v_exp_f32 v87, v87
    s_nop 0
    v_cvt_pk_bf16_f32 v96, v72, v73
    v_cvt_pk_bf16_f32 v97, v74, v75
    v_cvt_pk_bf16_f32 v98, v76, v77
    v_cvt_pk_bf16_f32 v99, v78, v79
    v_cvt_pk_bf16_f32 v100, v80, v81
    v_cvt_pk_bf16_f32 v101, v82, v83
    v_cvt_pk_bf16_f32 v102, v84, v85
    v_cvt_pk_bf16_f32 v103, v86, v87
    s_cmp_ge_u32 s28, 5
    s_cbranch_scc1 kfw_13
    s_waitcnt vmcnt(0)
kfw_13:
    s_waitcnt lgkmcnt(0)
    s_barrier
    s_cmp_ge_u32 s35, 27
    s_cbranch_scc1 kfsk_14
    s_cmp_ge_u32 s28, 5
    s_cbranch_scc1 kfkv_15
    s_add_u32 m0, s43, 4608
    s_mov_b64 exec, s[54:55]
    buffer_load_dwordx4 v13, s[24:27], s42 offen lds
    s_mov_b64 exec, -1
    s_add_u32 s42, s42, 4608
kfkv_15:
kfsk_14:
    v_mfma_f32_32x32x16_bf16 v[104:119], v[160:163], v[96:99], v[104:119]
    s_mov_b64 exec, s[48:49]
    ds_read_b128 v[152:155], v10 offset:10368
    ds_read_b128 v[156:159], v10 offset:10944
    s_mov_b64 exec, -1
    v_max3_f32 v11, v24, v25, v26
    v_max3_f32 v4, v27, v28, v29
    v_max3_f32 v11, v11, v30, v31
    v_max3_f32 v4, v4, v32, v33
    v_max3_f32 v11, v11, v34, v35
    v_max3_f32 v4, v4, v36, v37
    v_max3_f32 v11, v11, v38, v39
    v_mfma_f32_32x32x16_bf16 v[104:119], v[164:167], v[100:103], v[104:119]
    v_max3_f32 v4, v4, v40, v41
    v_max3_f32 v11, v11, v42, v43
    v_max3_f32 v4, v4, v44, v45
    v_max3_f32 v11, v11, v46, v47
    v_max3_f32 v4, v4, v48, v49
    v_max3_f32 v11, v11, v50, v51
    v_max3_f32 v4, v4, v52, v53
    v_max3_f32 v11, v11, v54, v55
    v_max_f32 v11, v11, v4
    v_cmp_lt_f32 vcc, s50, v11
    s_nop 0
    s_cbranch_vccnz kfrare_16
kfback_17:
    v_mfma_f32_32x32x16_bf16 v[56:71], v[136:139], v[16:19], v[120:135]
    s_mov_b64 exec, s[48:49]
    ds_read_b128 v[160:163], v10 offset:12672
    ds_read_b128 v[164:167], v10 offset:13248
    s_mov_b64 exec, -1
    v_exp_f32 v24, v24
    v_exp_f32 v25, v25
    v_exp_f32 v26, v26
    v_exp_f32 v27, v27
    v_exp_f32 v28, v28
    v_exp_f32 v29, v29
    v_mfma_f32_32x32x16_bf16 v[72:87], v[140:143], v[16:19], v[120:135]
    v_exp_f32 v30, v30
    v_exp_f32 v31, v31
    v_exp_f32 v32, v32
    v_exp_f32 v33, v33
    v_exp_f32 v34, v34
    v_exp_f32 v35, v35
    v_mfma_f32_32x32x16_bf16 v[56:71], v[144:147], v[20:23], v[56:71]
    v_exp_f32 v36, v36
    v_exp_f32 v37, v37
    v_exp_f32 v38, v38
    v_exp_f32 v39, v39
    v_exp_f32 v40, v40
    v_exp_f32 v41, v41
    v_mfma_f32_32x32x16_bf16 v[72:87], v[148:151], v[20:23], v[72:87]
    v_cvt_pk_bf16_f32 v88, v24, v25
    v_cvt_pk_bf16_f32 v89, v26, v27
    v_cvt_pk_bf16_f32 v90, v28, v29
    v_cvt_pk_bf16_f32 v91, v30, v31
    v_cvt_pk_bf16_f32 v92, v32, v33
    v_cvt_pk_bf16_f32 v93, v34, v35
    v_cvt_pk_bf16_f32 v94, v36, v37
    v_cvt_pk_bf16_f32 v95, v38, v39
    s_waitcnt lgkmcnt(2)
    s_nop 0
    v_mfma_f32_32x32x16_bf16 v[104:119], v[152:155], v[88:91], v[104:119]
    v_exp_f32 v42, v42
    v_exp_f32 v43, v43
    v_exp_f32 v44, v44
    v_exp_f32 v45, v45
    v_exp_f32 v46, v46
    v_exp_f32 v47, v47
    ds_read_b128 v[136:139], v8 offset:0
    ds_read_b128 v[140:143], v8 offset:2304
    s_mov_b64 exec, s[46:47]
    ds_read_b32 v144, v9 offset:1024
    ds_read_b32 v148, v9 offset:3328
    s_mov_b64 exec, -1
    v_mfma_f32_32x32x16_bf16 v[104:119], v[156:159], v[92:95], v[104:119]
    v_exp_f32 v48, v48
    v_exp_f32 v49, v49
    v_exp_f32 v50, v50
    v_exp_f32 v51, v51
    v_exp_f32 v52, v52
    v_exp_f32 v53, v53
    v_exp_f32 v54, v54
    v_exp_f32 v55, v55
    s_nop 0
    v_cvt_pk_bf16_f32 v96, v40, v41
    v_cvt_pk_bf16_f32 v97, v42, v43
    v_cvt_pk_bf16_f32 v98, v44, v45
    v_cvt_pk_bf16_f32 v99, v46, v47
    v_cvt_pk_bf16_f32 v100, v48, v49
    v_cvt_pk_bf16_f32 v101, v50, v51
    v_cvt_pk_bf16_f32 v102, v52, v53
    v_cvt_pk_bf16_f32 v103, v54, v55
    s_cmp_ge_u32 s28, 5
    s_cbranch_scc1 kfw_18
    s_waitcnt vmcnt(0)
kfw_18:
    s_waitcnt lgkmcnt(0)
    s_barrier
    s_cmp_ge_u32 s35, 26
    s_cbranch_scc1 kfsk_19
    s_cmp_ge_u32 s28, 5
    s_cbranch_scc1 kfkv_20
    s_add_u32 m0, s43, 9216
    s_mov_b64 exec, s[54:55]
    buffer_load_dwordx4 v13, s[24:27], s42 offen lds
    s_mov_b64 exec, -1
    s_add_u32 s42, s42, 4608
kfkv_20:
kfsk_19:
    v_mfma_f32_32x32x16_bf16 v[104:119], v[160:163], v[96:99], v[104:119]
    s_mov_b64 exec, s[48:49]
    ds_read_b128 v[152:155], v10 offset:14976
    ds_read_b128 v[156:159], v10 offset:15552
    s_mov_b64 exec, -1
    v_max3_f32 v11, v56, v57, v58
    v_max3_f32 v4, v59, v60, v61
    v_max3_f32 v11, v11, v62, v63
    v_max3_f32 v4, v4, v64, v65
    v_max3_f32 v11, v11, v66, v67
    v_max3_f32 v4, v4, v68, v69
    v_max3_f32 v11, v11, v70, v71
    v_mfma_f32_32x32x16_bf16 v[104:119], v[164:167], v[100:103], v[104:119]
    v_max3_f32 v4, v4, v72, v73
    v_max3_f32 v11, v11, v74, v75
    v_max3_f32 v4, v4, v76, v77
    v_max3_f32 v11, v11, v78, v79
    v_max3_f32 v4, v4, v80, v81
    v_max3_f32 v11, v11, v82, v83
    v_max3_f32 v4, v4, v84, v85
    v_max3_f32 v11, v11, v86, v87
    v_max_f32 v11, v11, v4
    v_cmp_lt_f32 vcc, s50, v11
    s_nop 0
    s_cbranch_vccnz kfrare_21
kfback_22:
    v_mfma_f32_32x32x16_bf16 v[24:39], v[136:139], v[16:19], v[120:135]
    s_mov_b64 exec, s[48:49]
    ds_read_b128 v[160:163], v10 offset:17280
    ds_read_b128 v[164:167], v10 offset:17856
    s_mov_b64 exec, -1
    v_exp_f32 v56, v56
    v_exp_f32 v57, v57
    v_exp_f32 v58, v58
    v_exp_f32 v59, v59
    v_exp_f32 v60, v60
    v_exp_f32 v61, v61
    v_mfma_f32_32x32x16_bf16 v[40:55], v[140:143], v[16:19], v[120:135]
    v_exp_f32 v62, v62
    v_exp_f32 v63, v63
    v_exp_f32 v64, v64
    v_exp_f32 v65, v65
    v_exp_f32 v66, v66
    v_exp_f32 v67, v67
    v_mfma_f32_32x32x16_bf16 v[24:39], v[144:147], v[20:23], v[24:39]
    v_exp_f32 v68, v68
    v_exp_f32 v69, v69
    v_exp_f32 v70, v70
    v_exp_f32 v71, v71
    v_exp_f32 v72, v72
    v_exp_f32 v73, v73
    v_mfma_f32_32x32x16_bf16 v[40:55], v[148:151], v[20:23], v[40:55]
    v_cvt_pk_bf16_f32 v88, v56, v57
    v_cvt_pk_bf16_f32 v89, v58, v59
    v_cvt_pk_bf16_f32 v90, v60, v61
    v_cvt_pk_bf16_f32 v91, v62, v63
    v_cvt_pk_bf16_f32 v92, v64, v65
    v_cvt_pk_bf16_f32 v93, v66, v67
    v_cvt_pk_bf16_f32 v94, v68, v69
    v_cvt_pk_bf16_f32 v95, v70, v71
    s_waitcnt lgkmcnt(2)
    s_nop 0
    v_mfma_f32_32x32x16_bf16 v[104:119], v[152:155], v[88:91], v[104:119]
    v_exp_f32 v74, v74
    v_exp_f32 v75, v75
    v_exp_f32 v76, v76
    v_exp_f32 v77, v77
    v_exp_f32 v78, v78
    v_exp_f32 v79, v79
    ds_read_b128 v[136:139], v8 offset:4608
    ds_read_b128 v[140:143], v8 offset:6912
    s_mov_b64 exec, s[46:47]
    ds_read_b32 v144, v9 offset:5632
    ds_read_b32 v148, v9 offset:7936
    s_mov_b64 exec, -1
    v_mfma_f32_32x32x16_bf16 v[104:119], v[156:159], v[92:95], v[104:119]
    v_exp_f32 v80, v80
    v_exp_f32 v81, v81
    v_exp_f32 v82, v82
    v_exp_f32 v83, v83
    v_exp_f32 v84, v84
    v_exp_f32 v85, v85
    v_exp_f32 v86, v86
    v_exp_f32 v87, v87
    s_nop 0
    v_cvt_pk_bf16_f32 v96, v72, v73
    v_cvt_pk_bf16_f32 v97, v74, v75
    v_cvt_pk_bf16_f32 v98, v76, v77
    v_cvt_pk_bf16_f32 v99, v78, v79
    v_cvt_pk_bf16_f32 v100, v80, v81
    v_cvt_pk_bf16_f32 v101, v82, v83
    v_cvt_pk_bf16_f32 v102, v84, v85
    v_cvt_pk_bf16_f32 v103, v86, v87
    s_add_u32 s35, s35, 4
    s_cmp_ge_u32 s35, 32
    s_cbranch_scc1 kf_adone
    s_cmp_ge_u32 s28, 5
    s_cbranch_scc1 kfw_23
    s_waitcnt vmcnt(0)
kfw_23:
    s_waitcnt lgkmcnt(0)
    s_barrier
    s_branch kf_aloop
kf_adone:
    s_waitcnt lgkmcnt(0)
    s_nop 1
    v_mfma_f32_32x32x16_bf16 v[104:119], v[160:163], v[96:99], v[104:119]
    v_mfma_f32_32x32x16_bf16 v[104:119], v[164:167], v[100:103], v[104:119]
    s_nop 7
    s_nop 7
    v_mov_b32 v4, v114
    v_mov_b32 v5, v114
    s_nop 1
    v_permlane32_swap_b32 v5, v4
    v_cmp_gt_u32 vcc, 32, v1
    s_nop 1
    v_cndmask_b32 v4, v5, v114, vcc
    v_rcp_f32 v4, v4
    s_nop 0
    v_mul_f32 v104, v104, v4
    v_mul_f32 v105, v105, v4
    v_mul_f32 v106, v106, v4
    v_mul_f32 v107, v107, v4
    v_mul_f32 v108, v108, v4
    v_mul_f32 v109, v109, v4
    v_mul_f32 v110, v110, v4
    v_mul_f32 v111, v111, v4
    v_mul_f32 v112, v112, v4
    v_mul_f32 v113, v113, v4
    v_cvt_pk_bf16_f32 v88, v104, v105
    v_cvt_pk_bf16_f32 v89, v106, v107
    v_cvt_pk_bf16_f32 v90, v108, v109
    v_cvt_pk_bf16_f32 v91, v110, v111
    v_cvt_pk_bf16_f32 v92, v112, v113
    s_movk_i32 s40, 5760
    v_lshlrev_b32 v5, 3, v3
    v_mad_u32_u24 v5, v2, s40, v5
    s_mul_i32 s39, s31, 5760
    s_mul_i32 s40, s30, 36
    s_add_u32 s39, s39, s40
    s_add_u32 s39, s39, 35651584
    buffer_store_dwordx2 v[88:89], v5, s[24:27], s39 offen
    buffer_store_dwordx2 v[90:91], v5, s[24:27], s39 offen offset:16
    s_mov_b64 exec, s[46:47]
    buffer_store_dword v92, v5, s[24:27], s39 offen offset:32
    s_mov_b64 exec, -1
    s_branch kf_coop
kfrare_6:
    v_mov_b32 v5, v11
    s_nop 1
    v_permlane32_swap_b32 v5, v11
    s_nop 1
    v_max_f32 v11, v11, v5
    v_max_f32 v11, s51, v11
    v_max_f32 v12, 0, v11
    v_exp_f32 v12, -v12
    s_mov_b32 s50, 0x42700000
    s_mov_b32 s51, 0
    v_sub_f32 v24, v24, v11
    v_sub_f32 v25, v25, v11
    v_sub_f32 v26, v26, v11
    v_sub_f32 v27, v27, v11
    v_sub_f32 v28, v28, v11
    v_sub_f32 v29, v29, v11
    v_sub_f32 v30, v30, v11
    v_sub_f32 v31, v31, v11
    v_sub_f32 v32, v32, v11
    v_sub_f32 v33, v33, v11
    v_sub_f32 v34, v34, v11
    v_sub_f32 v35, v35, v11
    v_sub_f32 v36, v36, v11
    v_sub_f32 v37, v37, v11
    v_sub_f32 v38, v38, v11
    v_sub_f32 v39, v39, v11
    v_sub_f32 v40, v40, v11
    v_sub_f32 v41, v41, v11
    v_sub_f32 v42, v42, v11
    v_sub_f32 v43, v43, v11
    v_sub_f32 v44, v44, v11
    v_sub_f32 v45, v45, v11
    v_sub_f32 v46, v46, v11
    v_sub_f32 v47, v47, v11
    v_sub_f32 v48, v48, v11
    v_sub_f32 v49, v49, v11
    v_sub_f32 v50, v50, v11
    v_sub_f32 v51, v51, v11
    v_sub_f32 v52, v52, v11
    v_sub_f32 v53, v53, v11
    v_sub_f32 v54, v54, v11
    v_sub_f32 v55, v55, v11
    v_sub_f32 v120, v120, v11
    v_sub_f32 v121, v121, v11
    v_sub_f32 v122, v122, v11
    v_sub_f32 v123, v123, v11
    v_sub_f32 v124, v124, v11
    v_sub_f32 v125, v125, v11
    v_sub_f32 v126, v126, v11
    v_sub_f32 v127, v127, v11
    v_sub_f32 v128, v128, v11
    v_sub_f32 v129, v129, v11
    v_sub_f32 v130, v130, v11
    v_sub_f32 v131, v131, v11
    v_sub_f32 v132, v132, v11
    v_sub_f32 v133, v133, v11
    v_sub_f32 v134, v134, v11
    v_sub_f32 v135, v135, v11
    v_mul_f32 v104, v104, v12
    v_mul_f32 v105, v105, v12
    v_mul_f32 v106, v106, v12
    v_mul_f32 v107, v107, v12
    v_mul_f32 v108, v108, v12
    v_mul_f32 v109, v109, v12
    v_mul_f32 v110, v110, v12
    v_mul_f32 v111, v111, v12
    v_mul_f32 v112, v112, v12
    v_mul_f32 v113, v113, v12
    v_mul_f32 v114, v114, v12
    v_mul_f32 v115, v115, v12
    s_nop 1
    s_branch kfback_7
kfrare_11:
    v_mov_b32 v5, v11
    s_nop 1
    v_permlane32_swap_b32 v5, v11
    s_nop 1
    v_max_f32 v11, v11, v5
    v_max_f32 v11, s51, v11
    v_max_f32 v12, 0, v11
    v_exp_f32 v12, -v12
    s_mov_b32 s50, 0x42700000
    s_mov_b32 s51, 0
    v_sub_f32 v56, v56, v11
    v_sub_f32 v57, v57, v11
    v_sub_f32 v58, v58, v11
    v_sub_f32 v59, v59, v11
    v_sub_f32 v60, v60, v11
    v_sub_f32 v61, v61, v11
    v_sub_f32 v62, v62, v11
    v_sub_f32 v63, v63, v11
    v_sub_f32 v64, v64, v11
    v_sub_f32 v65, v65, v11
    v_sub_f32 v66, v66, v11
    v_sub_f32 v67, v67, v11
    v_sub_f32 v68, v68, v11
    v_sub_f32 v69, v69, v11
    v_sub_f32 v70, v70, v11
    v_sub_f32 v71, v71, v11
    v_sub_f32 v72, v72, v11
    v_sub_f32 v73, v73, v11
    v_sub_f32 v74, v74, v11
    v_sub_f32 v75, v75, v11
    v_sub_f32 v76, v76, v11
    v_sub_f32 v77, v77, v11
    v_sub_f32 v78, v78, v11
    v_sub_f32 v79, v79, v11
    v_sub_f32 v80, v80, v11
    v_sub_f32 v81, v81, v11
    v_sub_f32 v82, v82, v11
    v_sub_f32 v83, v83, v11
    v_sub_f32 v84, v84, v11
    v_sub_f32 v85, v85, v11
    v_sub_f32 v86, v86, v11
    v_sub_f32 v87, v87, v11
    v_sub_f32 v120, v120, v11
    v_sub_f32 v121, v121, v11
    v_sub_f32 v122, v122, v11
    v_sub_f32 v123, v123, v11
    v_sub_f32 v124, v124, v11
    v_sub_f32 v125, v125, v11
    v_sub_f32 v126, v126, v11
    v_sub_f32 v127, v127, v11
    v_sub_f32 v128, v128, v11
    v_sub_f32 v129, v129, v11
    v_sub_f32 v130, v130, v11
    v_sub_f32 v131, v131, v11
    v_sub_f32 v132, v132, v11
    v_sub_f32 v133, v133, v11
    v_sub_f32 v134, v134, v11
    v_sub_f32 v135, v135, v11
    v_mul_f32 v104, v104, v12
    v_mul_f32 v105, v105, v12
    v_mul_f32 v106, v106, v12
    v_mul_f32 v107, v107, v12
    v_mul_f32 v108, v108, v12
    v_mul_f32 v109, v109, v12
    v_mul_f32 v110, v110, v12
    v_mul_f32 v111, v111, v12
    v_mul_f32 v112, v112, v12
    v_mul_f32 v113, v113, v12
    v_mul_f32 v114, v114, v12
    v_mul_f32 v115, v115, v12
    s_nop 1
    s_branch kfback_12
kfrare_16:
    v_mov_b32 v5, v11
    s_nop 1
    v_permlane32_swap_b32 v5, v11
    s_nop 1
    v_max_f32 v11, v11, v5
    v_max_f32 v11, s51, v11
    v_max_f32 v12, 0, v11
    v_exp_f32 v12, -v12
    s_mov_b32 s50, 0x42700000
    s_mov_b32 s51, 0
    v_sub_f32 v24, v24, v11
    v_sub_f32 v25, v25, v11
    v_sub_f32 v26, v26, v11
    v_sub_f32 v27, v27, v11
    v_sub_f32 v28, v28, v11
    v_sub_f32 v29, v29, v11
    v_sub_f32 v30, v30, v11
    v_sub_f32 v31, v31, v11
    v_sub_f32 v32, v32, v11
    v_sub_f32 v33, v33, v11
    v_sub_f32 v34, v34, v11
    v_sub_f32 v35, v35, v11
    v_sub_f32 v36, v36, v11
    v_sub_f32 v37, v37, v11
    v_sub_f32 v38, v38, v11
    v_sub_f32 v39, v39, v11
    v_sub_f32 v40, v40, v11
    v_sub_f32 v41, v41, v11
    v_sub_f32 v42, v42, v11
    v_sub_f32 v43, v43, v11
    v_sub_f32 v44, v44, v11
    v_sub_f32 v45, v45, v11
    v_sub_f32 v46, v46, v11
    v_sub_f32 v47, v47, v11
    v_sub_f32 v48, v48, v11
    v_sub_f32 v49, v49, v11
    v_sub_f32 v50, v50, v11
    v_sub_f32 v51, v51, v11
    v_sub_f32 v52, v52, v11
    v_sub_f32 v53, v53, v11
    v_sub_f32 v54, v54, v11
    v_sub_f32 v55, v55, v11
    v_sub_f32 v120, v120, v11
    v_sub_f32 v121, v121, v11
    v_sub_f32 v122, v122, v11
    v_sub_f32 v123, v123, v11
    v_sub_f32 v124, v124, v11
    v_sub_f32 v125, v125, v11
    v_sub_f32 v126, v126, v11
    v_sub_f32 v127, v127, v11
    v_sub_f32 v128, v128, v11
    v_sub_f32 v129, v129, v11
    v_sub_f32 v130, v130, v11
    v_sub_f32 v131, v131, v11
    v_sub_f32 v132, v132, v11
    v_sub_f32 v133, v133, v11
    v_sub_f32 v134, v134, v11
    v_sub_f32 v135, v135, v11
    v_mul_f32 v104, v104, v12
    v_mul_f32 v105, v105, v12
    v_mul_f32 v106, v106, v12
    v_mul_f32 v107, v107, v12
    v_mul_f32 v108, v108, v12
    v_mul_f32 v109, v109, v12
    v_mul_f32 v110, v110, v12
    v_mul_f32 v111, v111, v12
    v_mul_f32 v112, v112, v12
    v_mul_f32 v113, v113, v12
    v_mul_f32 v114, v114, v12
    v_mul_f32 v115, v115, v12
    s_nop 1
    s_branch kfback_17
kfrare_21:
    v_mov_b32 v5, v11
    s_nop 1
    v_permlane32_swap_b32 v5, v11
    s_nop 1
    v_max_f32 v11, v11, v5
    v_max_f32 v11, s51, v11
    v_max_f32 v12, 0, v11
    v_exp_f32 v12, -v12
    s_mov_b32 s50, 0x42700000
    s_mov_b32 s51, 0
    v_sub_f32 v56, v56, v11
    v_sub_f32 v57, v57, v11
    v_sub_f32 v58, v58, v11
    v_sub_f32 v59, v59, v11
    v_sub_f32 v60, v60, v11
    v_sub_f32 v61, v61, v11
    v_sub_f32 v62, v62, v11
    v_sub_f32 v63, v63, v11
    v_sub_f32 v64, v64, v11
    v_sub_f32 v65, v65, v11
    v_sub_f32 v66, v66, v11
    v_sub_f32 v67, v67, v11
    v_sub_f32 v68, v68, v11
    v_sub_f32 v69, v69, v11
    v_sub_f32 v70, v70, v11
    v_sub_f32 v71, v71, v11
    v_sub_f32 v72, v72, v11
    v_sub_f32 v73, v73, v11
    v_sub_f32 v74, v74, v11
    v_sub_f32 v75, v75, v11
    v_sub_f32 v76, v76, v11
    v_sub_f32 v77, v77, v11
    v_sub_f32 v78, v78, v11
    v_sub_f32 v79, v79, v11
    v_sub_f32 v80, v80, v11
    v_sub_f32 v81, v81, v11
    v_sub_f32 v82, v82, v11
    v_sub_f32 v83, v83, v11
    v_sub_f32 v84, v84, v11
    v_sub_f32 v85, v85, v11
    v_sub_f32 v86, v86, v11
    v_sub_f32 v87, v87, v11
    v_sub_f32 v120, v120, v11
    v_sub_f32 v121, v121, v11
    v_sub_f32 v122, v122, v11
    v_sub_f32 v123, v123, v11
    v_sub_f32 v124, v124, v11
    v_sub_f32 v125, v125, v11
    v_sub_f32 v126, v126, v11
    v_sub_f32 v127, v127, v11
    v_sub_f32 v128, v128, v11
    v_sub_f32 v129, v129, v11
    v_sub_f32 v130, v130, v11
    v_sub_f32 v131, v131, v11
    v_sub_f32 v132, v132, v11
    v_sub_f32 v133, v133, v11
    v_sub_f32 v134, v134, v11
    v_sub_f32 v135, v135, v11
    v_mul_f32 v104, v104, v12
    v_mul_f32 v105, v105, v12
    v_mul_f32 v106, v106, v12
    v_mul_f32 v107, v107, v12
    v_mul_f32 v108, v108, v12
    v_mul_f32 v109, v109, v12
    v_mul_f32 v110, v110, v12
    v_mul_f32 v111, v111, v12
    v_mul_f32 v112, v112, v12
    v_mul_f32 v113, v113, v12
    v_mul_f32 v114, v114, v12
    v_mul_f32 v115, v115, v12
    s_nop 1
    s_branch kfback_22
kf_gemm:
    v_and_b32 v2, 63, v0
    v_and_b32 v3, 15, v2
    v_lshrrev_b32 v4, 4, v2
    v_and_b32 v5, 31, v2
    v_lshrrev_b32 v6, 5, v2
    s_and_b32 s29, s28, 3
    s_and_b32 s39, s2, 7
    s_lshr_b32 s40, s2, 3
    s_and_b32 s41, s39, 3
    s_lshl_b32 s41, s41, 2
    s_and_b32 s42, s40, 3
    s_add_u32 s31, s41, s42
    s_lshr_b32 s41, s39, 2
    s_lshl_b32 s41, s41, 3
    s_lshr_b32 s42, s40, 2
    s_add_u32 s32, s41, s42
    s_mul_i32 s33, s31, 144
    s_lshl_b32 s34, s32, 7
    v_lshrrev_b32 v8, 3, v2
    v_and_b32 v9, 7, v2
    v_lshrrev_b32 v10, 1, v8
    v_xor_b32 v9, v9, v10
    v_lshlrev_b32 v8, 12, v8
    v_lshl_add_u32 v16, v9, 4, v8
    v_xor_b32 v17, 64, v16
    s_and_b32 s39, s29, 1
    s_lshl_b32 s39, s39, 6
    v_xor_b32 v18, s39, v16
    s_lshl_b32 s39, s29, 12
    s_add_u32 s39, s39, 18432
    v_bfe_u32 v9, v3, 1, 3
    v_xor_b32 v8, v4, v9
    v_lshlrev_b32 v8, 4, v8
    v_lshl_add_u32 v8, v3, 7, v8
    v_add_u32 v27, 16384, v8
    v_xor_b32 v28, 64, v27
    v_add_u32 v29, s39, v8
    v_xor_b32 v30, 64, v29
    v_bfe_u32 v9, v5, 1, 3
    v_xor_b32 v8, v6, v9
    v_lshlrev_b32 v8, 4, v8
    v_lshl_add_u32 v19, v5, 7, v8
    v_xor_b32 v20, 32, v19
    v_xor_b32 v21, 64, v19
    v_xor_b32 v22, 96, v19
    v_add_u32 v23, s39, v19
    v_add_u32 v24, s39, v20
    v_add_u32 v25, s39, v21
    v_add_u32 v26, s39, v22
    s_mov_b32 s16, s4
    s_mov_b32 s17, s5
    s_mov_b32 s18, 8388608
    s_mov_b32 s19, 0x00020000
    s_mov_b32 s20, s6
    s_mov_b32 s21, s7
    s_mov_b32 s22, 4096
    s_mov_b32 s23, 0x00020000
    s_lshl_b32 s39, s29, 5
    s_add_u32 s40, s33, s39
    s_lshl_b32 s44, s40, 12
    s_add_u32 s44, s44, 25165824
    s_lshl_b32 s41, s29, 3
    s_add_u32 s41, s41, 128
    s_add_u32 s41, s41, s33
    s_lshl_b32 s45, s41, 12
    s_add_u32 s45, s45, 25165824
    s_add_u32 s40, s34, s39
    s_lshl_b32 s46, s40, 12
    s_lshl_b32 s47, s29, 12
    s_lshl_b32 s48, s29, 10
    s_add_u32 s48, s48, 16384
    s_add_u32 s49, s47, 18432
    s_add_u32 m0, s47, 0
    s_add_u32 s50, s44, 0
    buffer_load_dwordx4 v16, s[24:27], s50 offen lds
    s_add_u32 m0, s47, 1024
    s_add_u32 s50, s44, 32768
    buffer_load_dwordx4 v17, s[24:27], s50 offen lds
    s_add_u32 m0, s47, 2048
    s_add_u32 s50, s44, 65536
    buffer_load_dwordx4 v16, s[24:27], s50 offen lds
    s_add_u32 m0, s47, 3072
    s_add_u32 s50, s44, 98304
    buffer_load_dwordx4 v17, s[24:27], s50 offen lds
    s_add_u32 m0, s49, 0
    s_add_u32 s50, s46, 0
    buffer_load_dwordx4 v16, s[16:19], s50 offen lds
    s_add_u32 m0, s49, 1024
    s_add_u32 s50, s46, 32768
    buffer_load_dwordx4 v17, s[16:19], s50 offen lds
    s_add_u32 m0, s49, 2048
    s_add_u32 s50, s46, 65536
    buffer_load_dwordx4 v16, s[16:19], s50 offen lds
    s_add_u32 m0, s49, 3072
    s_add_u32 s50, s46, 98304
    buffer_load_dwordx4 v17, s[16:19], s50 offen lds
    s_cmp_ge_u32 s29, 2
    s_cbranch_scc1 kfd_24
    s_add_u32 m0, s48, 0
    s_add_u32 s50, s45, 0
    buffer_load_dwordx4 v18, s[24:27], s50 offen lds
kfd_24:
    s_add_u32 m0, s47, 34816
    s_add_u32 s50, s44, 128
    buffer_load_dwordx4 v16, s[24:27], s50 offen lds
    s_add_u32 m0, s47, 35840
    s_add_u32 s50, s44, 32896
    buffer_load_dwordx4 v17, s[24:27], s50 offen lds
    s_add_u32 m0, s47, 36864
    s_add_u32 s50, s44, 65664
    buffer_load_dwordx4 v16, s[24:27], s50 offen lds
    s_add_u32 m0, s47, 37888
    s_add_u32 s50, s44, 98432
    buffer_load_dwordx4 v17, s[24:27], s50 offen lds
    s_add_u32 m0, s49, 34816
    s_add_u32 s50, s46, 128
    buffer_load_dwordx4 v16, s[16:19], s50 offen lds
    s_add_u32 m0, s49, 35840
    s_add_u32 s50, s46, 32896
    buffer_load_dwordx4 v17, s[16:19], s50 offen lds
    s_add_u32 m0, s49, 36864
    s_add_u32 s50, s46, 65664
    buffer_load_dwordx4 v16, s[16:19], s50 offen lds
    s_add_u32 m0, s49, 37888
    s_add_u32 s50, s46, 98432
    buffer_load_dwordx4 v17, s[16:19], s50 offen lds
    s_cmp_ge_u32 s29, 2
    s_cbranch_scc1 kfd_25
    s_add_u32 m0, s48, 34816
    s_add_u32 s50, s45, 128
    buffer_load_dwordx4 v18, s[24:27], s50 offen lds
kfd_25:
    s_add_u32 m0, s47, 69632
    s_add_u32 s50, s44, 256
    buffer_load_dwordx4 v16, s[24:27], s50 offen lds
    s_add_u32 m0, s47, 70656
    s_add_u32 s50, s44, 33024
    buffer_load_dwordx4 v17, s[24:27], s50 offen lds
    s_add_u32 m0, s47, 71680
    s_add_u32 s50, s44, 65792
    buffer_load_dwordx4 v16, s[24:27], s50 offen lds
    s_add_u32 m0, s47, 72704
    s_add_u32 s50, s44, 98560
    buffer_load_dwordx4 v17, s[24:27], s50 offen lds
    s_add_u32 m0, s49, 69632
    s_add_u32 s50, s46, 256
    buffer_load_dwordx4 v16, s[16:19], s50 offen lds
    s_add_u32 m0, s49, 70656
    s_add_u32 s50, s46, 33024
    buffer_load_dwordx4 v17, s[16:19], s50 offen lds
    s_add_u32 m0, s49, 71680
    s_add_u32 s50, s46, 65792
    buffer_load_dwordx4 v16, s[16:19], s50 offen lds
    s_add_u32 m0, s49, 72704
    s_add_u32 s50, s46, 98560
    buffer_load_dwordx4 v17, s[16:19], s50 offen lds
    s_cmp_ge_u32 s29, 2
    s_cbranch_scc1 kfd_26
    s_add_u32 m0, s48, 69632
    s_add_u32 s50, s45, 256
    buffer_load_dwordx4 v18, s[24:27], s50 offen lds
kfd_26:
    s_waitcnt vmcnt(8)
    s_barrier
    ds_read_b128 v[124:127], v23 offset:0
    ds_read_b128 v[108:111], v19 offset:0
    ds_read_b128 v[112:115], v19 offset:4096
    ds_read_b128 v[116:119], v19 offset:8192
    ds_read_b128 v[120:123], v19 offset:12288
    ds_read_b128 v[132:135], v27 offset:0
    ds_read_b128 v[136:139], v29 offset:0
    ds_read_b128 v[140:143], v29 offset:2048
    ds_read_b128 v[128:131], v24 offset:0
    s_waitcnt lgkmcnt(7)
    v_mfma_f32_32x32x16_bf16 v[36:51], v[108:111], v[124:127], 0
    ds_read_b128 v[108:111], v20 offset:0
    s_add_u32 m0, s47, 104448
    s_add_u32 s50, s44, 384
    buffer_load_dwordx4 v16, s[24:27], s50 offen lds
    s_waitcnt lgkmcnt(7)
    v_mfma_f32_32x32x16_bf16 v[52:67], v[112:115], v[124:127], 0
    ds_read_b128 v[112:115], v20 offset:4096
    s_waitcnt lgkmcnt(7)
    v_mfma_f32_32x32x16_bf16 v[68:83], v[116:119], v[124:127], 0
    ds_read_b128 v[116:119], v20 offset:8192
    s_add_u32 m0, s47, 105472
    s_add_u32 s50, s44, 33152
    buffer_load_dwordx4 v17, s[24:27], s50 offen lds
    s_waitcnt lgkmcnt(7)
    v_mfma_f32_32x32x16_bf16 v[84:99], v[120:123], v[124:127], 0
    ds_read_b128 v[120:123], v20 offset:12288
    s_waitcnt lgkmcnt(5)
    v_mfma_f32_16x16x32_bf16 v[100:103], v[132:135], v[136:139], 0
    v_mfma_f32_16x16x32_bf16 v[104:107], v[132:135], v[140:143], 0
    ds_read_b128 v[132:135], v28 offset:0
    ds_read_b128 v[136:139], v30 offset:0
    ds_read_b128 v[140:143], v30 offset:2048
    ds_read_b128 v[124:127], v25 offset:0
    s_waitcnt lgkmcnt(7)
    v_mfma_f32_32x32x16_bf16 v[36:51], v[108:111], v[128:131], v[36:51]
    ds_read_b128 v[108:111], v21 offset:0
    s_add_u32 m0, s47, 106496
    s_add_u32 s50, s44, 65920
    buffer_load_dwordx4 v16, s[24:27], s50 offen lds
    s_waitcnt lgkmcnt(7)
    v_mfma_f32_32x32x16_bf16 v[52:67], v[112:115], v[128:131], v[52:67]
    ds_read_b128 v[112:115], v21 offset:4096
    s_waitcnt lgkmcnt(7)
    v_mfma_f32_32x32x16_bf16 v[68:83], v[116:119], v[128:131], v[68:83]
    ds_read_b128 v[116:119], v21 offset:8192
    s_add_u32 m0, s47, 107520
    s_add_u32 s50, s44, 98688
    buffer_load_dwordx4 v17, s[24:27], s50 offen lds
    s_waitcnt lgkmcnt(7)
    v_mfma_f32_32x32x16_bf16 v[84:99], v[120:123], v[128:131], v[84:99]
    ds_read_b128 v[120:123], v21 offset:12288
    ds_read_b128 v[128:131], v26 offset:0
    s_waitcnt lgkmcnt(4)
    v_mfma_f32_32x32x16_bf16 v[36:51], v[108:111], v[124:127], v[36:51]
    ds_read_b128 v[108:111], v22 offset:0
    s_add_u32 m0, s49, 104448
    s_add_u32 s50, s46, 384
    buffer_load_dwordx4 v16, s[16:19], s50 offen lds
    s_waitcnt lgkmcnt(4)
    v_mfma_f32_32x32x16_bf16 v[52:67], v[112:115], v[124:127], v[52:67]
    ds_read_b128 v[112:115], v22 offset:4096
    s_waitcnt lgkmcnt(4)
    v_mfma_f32_32x32x16_bf16 v[68:83], v[116:119], v[124:127], v[68:83]
    ds_read_b128 v[116:119], v22 offset:8192
    s_add_u32 m0, s49, 105472
    s_add_u32 s50, s46, 33152
    buffer_load_dwordx4 v17, s[16:19], s50 offen lds
    s_waitcnt lgkmcnt(4)
    v_mfma_f32_32x32x16_bf16 v[84:99], v[120:123], v[124:127], v[84:99]
    ds_read_b128 v[120:123], v22 offset:12288
    s_waitcnt lgkmcnt(10)
    v_mfma_f32_16x16x32_bf16 v[100:103], v[132:135], v[136:139], v[100:103]
    v_mfma_f32_16x16x32_bf16 v[104:107], v[132:135], v[140:143], v[104:107]
    ds_read_b128 v[132:135], v27 offset:34816
    ds_read_b128 v[136:139], v29 offset:34816
    ds_read_b128 v[140:143], v29 offset:36864
    ds_read_b128 v[124:127], v23 offset:34816
    s_waitcnt lgkmcnt(7)
    v_mfma_f32_32x32x16_bf16 v[36:51], v[108:111], v[128:131], v[36:51]
    ds_read_b128 v[108:111], v19 offset:34816
    s_add_u32 m0, s49, 106496
    s_add_u32 s50, s46, 65920
    buffer_load_dwordx4 v16, s[16:19], s50 offen lds
    s_waitcnt lgkmcnt(7)
    v_mfma_f32_32x32x16_bf16 v[52:67], v[112:115], v[128:131], v[52:67]
    ds_read_b128 v[112:115], v19 offset:38912
    s_waitcnt lgkmcnt(7)
    v_mfma_f32_32x32x16_bf16 v[68:83], v[116:119], v[128:131], v[68:83]
    ds_read_b128 v[116:119], v19 offset:43008
    s_add_u32 m0, s49, 107520
    s_add_u32 s50, s46, 98688
    buffer_load_dwordx4 v17, s[16:19], s50 offen lds
    s_waitcnt lgkmcnt(7)
    v_mfma_f32_32x32x16_bf16 v[84:99], v[120:123], v[128:131], v[84:99]
    ds_read_b128 v[120:123], v19 offset:47104
    s_cmp_ge_u32 s29, 2
    s_cbranch_scc1 kfd_27
    s_add_u32 m0, s48, 104448
    s_add_u32 s50, s45, 384
    buffer_load_dwordx4 v18, s[24:27], s50 offen lds
kfd_27:
    s_waitcnt vmcnt(8)
    s_barrier
    ds_read_b128 v[128:131], v24 offset:34816
    s_waitcnt lgkmcnt(4)
    v_mfma_f32_32x32x16_bf16 v[36:51], v[108:111], v[124:127], v[36:51]
    ds_read_b128 v[108:111], v20 offset:34816
    s_add_u32 m0, s47, 0
    s_add_u32 s50, s44, 512
    buffer_load_dwordx4 v16, s[24:27], s50 offen lds
    s_waitcnt lgkmcnt(4)
    v_mfma_f32_32x32x16_bf16 v[52:67], v[112:115], v[124:127], v[52:67]
    ds_read_b128 v[112:115], v20 offset:38912
    s_waitcnt lgkmcnt(4)
    v_mfma_f32_32x32x16_bf16 v[68:83], v[116:119], v[124:127], v[68:83]
    ds_read_b128 v[116:119], v20 offset:43008
    s_add_u32 m0, s47, 1024
    s_add_u32 s50, s44, 33280
    buffer_load_dwordx4 v17, s[24:27], s50 offen lds
    s_waitcnt lgkmcnt(4)
    v_mfma_f32_32x32x16_bf16 v[84:99], v[120:123], v[124:127], v[84:99]
    ds_read_b128 v[120:123], v20 offset:47104
    s_waitcnt lgkmcnt(10)
    v_mfma_f32_16x16x32_bf16 v[100:103], v[132:135], v[136:139], v[100:103]
    v_mfma_f32_16x16x32_bf16 v[104:107], v[132:135], v[140:143], v[104:107]
    ds_read_b128 v[132:135], v28 offset:34816
    ds_read_b128 v[136:139], v30 offset:34816
    ds_read_b128 v[140:143], v30 offset:36864
    ds_read_b128 v[124:127], v25 offset:34816
    s_waitcnt lgkmcnt(7)
    v_mfma_f32_32x32x16_bf16 v[36:51], v[108:111], v[128:131], v[36:51]
    ds_read_b128 v[108:111], v21 offset:34816
    s_add_u32 m0, s47, 2048
    s_add_u32 s50, s44, 66048
    buffer_load_dwordx4 v16, s[24:27], s50 offen lds
    s_waitcnt lgkmcnt(7)
    v_mfma_f32_32x32x16_bf16 v[52:67], v[112:115], v[128:131], v[52:67]
    ds_read_b128 v[112:115], v21 offset:38912
    s_waitcnt lgkmcnt(7)
    v_mfma_f32_32x32x16_bf16 v[68:83], v[116:119], v[128:131], v[68:83]
    ds_read_b128 v[116:119], v21 offset:43008
    s_add_u32 m0, s47, 3072
    s_add_u32 s50, s44, 98816
    buffer_load_dwordx4 v17, s[24:27], s50 offen lds
    s_waitcnt lgkmcnt(7)
    v_mfma_f32_32x32x16_bf16 v[84:99], v[120:123], v[128:131], v[84:99]
    ds_read_b128 v[120:123], v21 offset:47104
    ds_read_b128 v[128:131], v26 offset:34816
    s_waitcnt lgkmcnt(4)
    v_mfma_f32_32x32x16_bf16 v[36:51], v[108:111], v[124:127], v[36:51]
    ds_read_b128 v[108:111], v22 offset:34816
    s_add_u32 m0, s49, 0
    s_add_u32 s50, s46, 512
    buffer_load_dwordx4 v16, s[16:19], s50 offen lds
    s_waitcnt lgkmcnt(4)
    v_mfma_f32_32x32x16_bf16 v[52:67], v[112:115], v[124:127], v[52:67]
    ds_read_b128 v[112:115], v22 offset:38912
    s_waitcnt lgkmcnt(4)
    v_mfma_f32_32x32x16_bf16 v[68:83], v[116:119], v[124:127], v[68:83]
    ds_read_b128 v[116:119], v22 offset:43008
    s_add_u32 m0, s49, 1024
    s_add_u32 s50, s46, 33280
    buffer_load_dwordx4 v17, s[16:19], s50 offen lds
    s_waitcnt lgkmcnt(4)
    v_mfma_f32_32x32x16_bf16 v[84:99], v[120:123], v[124:127], v[84:99]
    ds_read_b128 v[120:123], v22 offset:47104
    s_waitcnt lgkmcnt(10)
    v_mfma_f32_16x16x32_bf16 v[100:103], v[132:135], v[136:139], v[100:103]
    v_mfma_f32_16x16x32_bf16 v[104:107], v[132:135], v[140:143], v[104:107]
    v_add_u32 v19, 69632, v19
    v_add_u32 v20, 69632, v20
    v_add_u32 v21, 69632, v21
    v_add_u32 v22, 69632, v22
    v_add_u32 v23, 69632, v23
    v_add_u32 v24, 69632, v24
    v_add_u32 v25, 69632, v25
    v_add_u32 v26, 69632, v26
    v_add_u32 v27, 69632, v27
    v_add_u32 v28, 69632, v28
    v_add_u32 v29, 69632, v29
    v_add_u32 v30, 69632, v30
    ds_read_b128 v[132:135], v27 offset:0
    ds_read_b128 v[136:139], v29 offset:0
    ds_read_b128 v[140:143], v29 offset:2048
    ds_read_b128 v[124:127], v23 offset:0
    s_waitcnt lgkmcnt(7)
    v_mfma_f32_32x32x16_bf16 v[36:51], v[108:111], v[128:131], v[36:51]
    ds_read_b128 v[108:111], v19 offset:0
    s_add_u32 m0, s49, 2048
    s_add_u32 s50, s46, 66048
    buffer_load_dwordx4 v16, s[16:19], s50 offen lds
    s_waitcnt lgkmcnt(7)
    v_mfma_f32_32x32x16_bf16 v[52:67], v[112:115], v[128:131], v[52:67]
    ds_read_b128 v[112:115], v19 offset:4096
    s_waitcnt lgkmcnt(7)
    v_mfma_f32_32x32x16_bf16 v[68:83], v[116:119], v[128:131], v[68:83]
    ds_read_b128 v[116:119], v19 offset:8192
    s_add_u32 m0, s49, 3072
    s_add_u32 s50, s46, 98816
    buffer_load_dwordx4 v17, s[16:19], s50 offen lds
    s_waitcnt lgkmcnt(7)
    v_mfma_f32_32x32x16_bf16 v[84:99], v[120:123], v[128:131], v[84:99]
    ds_read_b128 v[120:123], v19 offset:12288
    s_cmp_ge_u32 s29, 2
    s_cbranch_scc1 kfd_28
    s_add_u32 m0, s48, 0
    s_add_u32 s50, s45, 512
    buffer_load_dwordx4 v18, s[24:27], s50 offen lds
kfd_28:
    s_waitcnt vmcnt(8)
    s_barrier
    ds_read_b128 v[128:131], v24 offset:0
    s_waitcnt lgkmcnt(4)
    v_mfma_f32_32x32x16_bf16 v[36:51], v[108:111], v[124:127], v[36:51]
    ds_read_b128 v[108:111], v20 offset:0
    s_add_u32 m0, s47, 34816
    s_add_u32 s50, s44, 640
    buffer_load_dwordx4 v16, s[24:27], s50 offen lds
    s_waitcnt lgkmcnt(4)
    v_mfma_f32_32x32x16_bf16 v[52:67], v[112:115], v[124:127], v[52:67]
    ds_read_b128 v[112:115], v20 offset:4096
    s_waitcnt lgkmcnt(4)
    v_mfma_f32_32x32x16_bf16 v[68:83], v[116:119], v[124:127], v[68:83]
    ds_read_b128 v[116:119], v20 offset:8192
    s_add_u32 m0, s47, 35840
    s_add_u32 s50, s44, 33408
    buffer_load_dwordx4 v17, s[24:27], s50 offen lds
    s_waitcnt lgkmcnt(4)
    v_mfma_f32_32x32x16_bf16 v[84:99], v[120:123], v[124:127], v[84:99]
    ds_read_b128 v[120:123], v20 offset:12288
    s_waitcnt lgkmcnt(10)
    v_mfma_f32_16x16x32_bf16 v[100:103], v[132:135], v[136:139], v[100:103]
    v_mfma_f32_16x16x32_bf16 v[104:107], v[132:135], v[140:143], v[104:107]
    ds_read_b128 v[132:135], v28 offset:0
    ds_read_b128 v[136:139], v30 offset:0
    ds_read_b128 v[140:143], v30 offset:2048
    ds_read_b128 v[124:127], v25 offset:0
    s_waitcnt lgkmcnt(7)
    v_mfma_f32_32x32x16_bf16 v[36:51], v[108:111], v[128:131], v[36:51]
    ds_read_b128 v[108:111], v21 offset:0
    s_add_u32 m0, s47, 36864
    s_add_u32 s50, s44, 66176
    buffer_load_dwordx4 v16, s[24:27], s50 offen lds
    s_waitcnt lgkmcnt(7)
    v_mfma_f32_32x32x16_bf16 v[52:67], v[112:115], v[128:131], v[52:67]
    ds_read_b128 v[112:115], v21 offset:4096
    s_waitcnt lgkmcnt(7)
    v_mfma_f32_32x32x16_bf16 v[68:83], v[116:119], v[128:131], v[68:83]
    ds_read_b128 v[116:119], v21 offset:8192
    s_add_u32 m0, s47, 37888
    s_add_u32 s50, s44, 98944
    buffer_load_dwordx4 v17, s[24:27], s50 offen lds
    s_waitcnt lgkmcnt(7)
    v_mfma_f32_32x32x16_bf16 v[84:99], v[120:123], v[128:131], v[84:99]
    ds_read_b128 v[120:123], v21 offset:12288
    ds_read_b128 v[128:131], v26 offset:0
    s_waitcnt lgkmcnt(4)
    v_mfma_f32_32x32x16_bf16 v[36:51], v[108:111], v[124:127], v[36:51]
    ds_read_b128 v[108:111], v22 offset:0
    s_add_u32 m0, s49, 34816
    s_add_u32 s50, s46, 640
    buffer_load_dwordx4 v16, s[16:19], s50 offen lds
    s_waitcnt lgkmcnt(4)
    v_mfma_f32_32x32x16_bf16 v[52:67], v[112:115], v[124:127], v[52:67]
    ds_read_b128 v[112:115], v22 offset:4096
    s_waitcnt lgkmcnt(4)
    v_mfma_f32_32x32x16_bf16 v[68:83], v[116:119], v[124:127], v[68:83]
    ds_read_b128 v[116:119], v22 offset:8192
    s_add_u32 m0, s49, 35840
    s_add_u32 s50, s46, 33408
    buffer_load_dwordx4 v17, s[16:19], s50 offen lds
    s_waitcnt lgkmcnt(4)
    v_mfma_f32_32x32x16_bf16 v[84:99], v[120:123], v[124:127], v[84:99]
    ds_read_b128 v[120:123], v22 offset:12288
    s_waitcnt lgkmcnt(10)
    v_mfma_f32_16x16x32_bf16 v[100:103], v[132:135], v[136:139], v[100:103]
    v_mfma_f32_16x16x32_bf16 v[104:107], v[132:135], v[140:143], v[104:107]
    ds_read_b128 v[132:135], v27 offset:34816
    ds_read_b128 v[136:139], v29 offset:34816
    ds_read_b128 v[140:143], v29 offset:36864
    ds_read_b128 v[124:127], v23 offset:34816
    s_waitcnt lgkmcnt(7)
    v_mfma_f32_32x32x16_bf16 v[36:51], v[108:111], v[128:131], v[36:51]
    ds_read_b128 v[108:111], v19 offset:34816
    s_add_u32 m0, s49, 36864
    s_add_u32 s50, s46, 66176
    buffer_load_dwordx4 v16, s[16:19], s50 offen lds
    s_waitcnt lgkmcnt(7)
    v_mfma_f32_32x32x16_bf16 v[52:67], v[112:115], v[128:131], v[52:67]
    ds_read_b128 v[112:115], v19 offset:38912
    s_waitcnt lgkmcnt(7)
    v_mfma_f32_32x32x16_bf16 v[68:83], v[116:119], v[128:131], v[68:83]
    ds_read_b128 v[116:119], v19 offset:43008
    s_add_u32 m0, s49, 37888
    s_add_u32 s50, s46, 98944
    buffer_load_dwordx4 v17, s[16:19], s50 offen lds
    s_waitcnt lgkmcnt(7)
    v_mfma_f32_32x32x16_bf16 v[84:99], v[120:123], v[128:131], v[84:99]
    ds_read_b128 v[120:123], v19 offset:47104
    s_cmp_ge_u32 s29, 2
    s_cbranch_scc1 kfd_29
    s_add_u32 m0, s48, 34816
    s_add_u32 s50, s45, 640
    buffer_load_dwordx4 v18, s[24:27], s50 offen lds
kfd_29:
    s_waitcnt vmcnt(8)
    s_barrier
    ds_read_b128 v[128:131], v24 offset:34816
    s_waitcnt lgkmcnt(4)
    v_mfma_f32_32x32x16_bf16 v[36:51], v[108:111], v[124:127], v[36:51]
    ds_read_b128 v[108:111], v20 offset:34816
    s_add_u32 m0, s47, 69632
    s_add_u32 s50, s44, 768
    buffer_load_dwordx4 v16, s[24:27], s50 offen lds
    s_waitcnt lgkmcnt(4)
    v_mfma_f32_32x32x16_bf16 v[52:67], v[112:115], v[124:127], v[52:67]
    ds_read_b128 v[112:115], v20 offset:38912
    s_waitcnt lgkmcnt(4)
    v_mfma_f32_32x32x16_bf16 v[68:83], v[116:119], v[124:127], v[68:83]
    ds_read_b128 v[116:119], v20 offset:43008
    s_add_u32 m0, s47, 70656
    s_add_u32 s50, s44, 33536
    buffer_load_dwordx4 v17, s[24:27], s50 offen lds
    s_waitcnt lgkmcnt(4)
    v_mfma_f32_32x32x16_bf16 v[84:99], v[120:123], v[124:127], v[84:99]
    ds_read_b128 v[120:123], v20 offset:47104
    s_waitcnt lgkmcnt(10)
    v_mfma_f32_16x16x32_bf16 v[100:103], v[132:135], v[136:139], v[100:103]
    v_mfma_f32_16x16x32_bf16 v[104:107], v[132:135], v[140:143], v[104:107]
    ds_read_b128 v[132:135], v28 offset:34816
    ds_read_b128 v[136:139], v30 offset:34816
    ds_read_b128 v[140:143], v30 offset:36864
    ds_read_b128 v[124:127], v25 offset:34816
    s_waitcnt lgkmcnt(7)
    v_mfma_f32_32x32x16_bf16 v[36:51], v[108:111], v[128:131], v[36:51]
    ds_read_b128 v[108:111], v21 offset:34816
    s_add_u32 m0, s47, 71680
    s_add_u32 s50, s44, 66304
    buffer_load_dwordx4 v16, s[24:27], s50 offen lds
    s_waitcnt lgkmcnt(7)
    v_mfma_f32_32x32x16_bf16 v[52:67], v[112:115], v[128:131], v[52:67]
    ds_read_b128 v[112:115], v21 offset:38912
    s_waitcnt lgkmcnt(7)
    v_mfma_f32_32x32x16_bf16 v[68:83], v[116:119], v[128:131], v[68:83]
    ds_read_b128 v[116:119], v21 offset:43008
    s_add_u32 m0, s47, 72704
    s_add_u32 s50, s44, 99072
    buffer_load_dwordx4 v17, s[24:27], s50 offen lds
    s_waitcnt lgkmcnt(7)
    v_mfma_f32_32x32x16_bf16 v[84:99], v[120:123], v[128:131], v[84:99]
    ds_read_b128 v[120:123], v21 offset:47104
    ds_read_b128 v[128:131], v26 offset:34816
    s_waitcnt lgkmcnt(4)
    v_mfma_f32_32x32x16_bf16 v[36:51], v[108:111], v[124:127], v[36:51]
    ds_read_b128 v[108:111], v22 offset:34816
    s_add_u32 m0, s49, 69632
    s_add_u32 s50, s46, 768
    buffer_load_dwordx4 v16, s[16:19], s50 offen lds
    s_waitcnt lgkmcnt(4)
    v_mfma_f32_32x32x16_bf16 v[52:67], v[112:115], v[124:127], v[52:67]
    ds_read_b128 v[112:115], v22 offset:38912
    s_waitcnt lgkmcnt(4)
    v_mfma_f32_32x32x16_bf16 v[68:83], v[116:119], v[124:127], v[68:83]
    ds_read_b128 v[116:119], v22 offset:43008
    s_add_u32 m0, s49, 70656
    s_add_u32 s50, s46, 33536
    buffer_load_dwordx4 v17, s[16:19], s50 offen lds
    s_waitcnt lgkmcnt(4)
    v_mfma_f32_32x32x16_bf16 v[84:99], v[120:123], v[124:127], v[84:99]
    ds_read_b128 v[120:123], v22 offset:47104
    s_waitcnt lgkmcnt(10)
    v_mfma_f32_16x16x32_bf16 v[100:103], v[132:135], v[136:139], v[100:103]
    v_mfma_f32_16x16x32_bf16 v[104:107], v[132:135], v[140:143], v[104:107]
    v_add_u32 v19, 4294897664, v19
    v_add_u32 v20, 4294897664, v20
    v_add_u32 v21, 4294897664, v21
    v_add_u32 v22, 4294897664, v22
    v_add_u32 v23, 4294897664, v23
    v_add_u32 v24, 4294897664, v24
    v_add_u32 v25, 4294897664, v25
    v_add_u32 v26, 4294897664, v26
    v_add_u32 v27, 4294897664, v27
    v_add_u32 v28, 4294897664, v28
    v_add_u32 v29, 4294897664, v29
    v_add_u32 v30, 4294897664, v30
    ds_read_b128 v[132:135], v27 offset:0
    ds_read_b128 v[136:139], v29 offset:0
    ds_read_b128 v[140:143], v29 offset:2048
    ds_read_b128 v[124:127], v23 offset:0
    s_waitcnt lgkmcnt(7)
    v_mfma_f32_32x32x16_bf16 v[36:51], v[108:111], v[128:131], v[36:51]
    ds_read_b128 v[108:111], v19 offset:0
    s_add_u32 m0, s49, 71680
    s_add_u32 s50, s46, 66304
    buffer_load_dwordx4 v16, s[16:19], s50 offen lds
    s_waitcnt lgkmcnt(7)
    v_mfma_f32_32x32x16_bf16 v[52:67], v[112:115], v[128:131], v[52:67]
    ds_read_b128 v[112:115], v19 offset:4096
    s_waitcnt lgkmcnt(7)
    v_mfma_f32_32x32x16_bf16 v[68:83], v[116:119], v[128:131], v[68:83]
    ds_read_b128 v[116:119], v19 offset:8192
    s_add_u32 m0, s49, 72704
    s_add_u32 s50, s46, 99072
    buffer_load_dwordx4 v17, s[16:19], s50 offen lds
    s_waitcnt lgkmcnt(7)
    v_mfma_f32_32x32x16_bf16 v[84:99], v[120:123], v[128:131], v[84:99]
    ds_read_b128 v[120:123], v19 offset:12288
    s_cmp_ge_u32 s29, 2
    s_cbranch_scc1 kfd_30
    s_add_u32 m0, s48, 69632
    s_add_u32 s50, s45, 768
    buffer_load_dwordx4 v18, s[24:27], s50 offen lds
kfd_30:
    s_waitcnt vmcnt(8)
    s_barrier
    ds_read_b128 v[128:131], v24 offset:0
    s_waitcnt lgkmcnt(4)
    v_mfma_f32_32x32x16_bf16 v[36:51], v[108:111], v[124:127], v[36:51]
    ds_read_b128 v[108:111], v20 offset:0
    s_add_u32 m0, s47, 104448
    s_add_u32 s50, s44, 896
    buffer_load_dwordx4 v16, s[24:27], s50 offen lds
    s_waitcnt lgkmcnt(4)
    v_mfma_f32_32x32x16_bf16 v[52:67], v[112:115], v[124:127], v[52:67]
    ds_read_b128 v[112:115], v20 offset:4096
    s_waitcnt lgkmcnt(4)
    v_mfma_f32_32x32x16_bf16 v[68:83], v[116:119], v[124:127], v[68:83]
    ds_read_b128 v[116:119], v20 offset:8192
    s_add_u32 m0, s47, 105472
    s_add_u32 s50, s44, 33664
    buffer_load_dwordx4 v17, s[24:27], s50 offen lds
    s_waitcnt lgkmcnt(4)
    v_mfma_f32_32x32x16_bf16 v[84:99], v[120:123], v[124:127], v[84:99]
    ds_read_b128 v[120:123], v20 offset:12288
    s_waitcnt lgkmcnt(10)
    v_mfma_f32_16x16x32_bf16 v[100:103], v[132:135], v[136:139], v[100:103]
    v_mfma_f32_16x16x32_bf16 v[104:107], v[132:135], v[140:143], v[104:107]
    ds_read_b128 v[132:135], v28 offset:0
    ds_read_b128 v[136:139], v30 offset:0
    ds_read_b128 v[140:143], v30 offset:2048
    ds_read_b128 v[124:127], v25 offset:0
    s_waitcnt lgkmcnt(7)
    v_mfma_f32_32x32x16_bf16 v[36:51], v[108:111], v[128:131], v[36:51]
    ds_read_b128 v[108:111], v21 offset:0
    s_add_u32 m0, s47, 106496
    s_add_u32 s50, s44, 66432
    buffer_load_dwordx4 v16, s[24:27], s50 offen lds
    s_waitcnt lgkmcnt(7)
    v_mfma_f32_32x32x16_bf16 v[52:67], v[112:115], v[128:131], v[52:67]
    ds_read_b128 v[112:115], v21 offset:4096
    s_waitcnt lgkmcnt(7)
    v_mfma_f32_32x32x16_bf16 v[68:83], v[116:119], v[128:131], v[68:83]
    ds_read_b128 v[116:119], v21 offset:8192
    s_add_u32 m0, s47, 107520
    s_add_u32 s50, s44, 99200
    buffer_load_dwordx4 v17, s[24:27], s50 offen lds
    s_waitcnt lgkmcnt(7)
    v_mfma_f32_32x32x16_bf16 v[84:99], v[120:123], v[128:131], v[84:99]
    ds_read_b128 v[120:123], v21 offset:12288
    ds_read_b128 v[128:131], v26 offset:0
    s_waitcnt lgkmcnt(4)
    v_mfma_f32_32x32x16_bf16 v[36:51], v[108:111], v[124:127], v[36:51]
    ds_read_b128 v[108:111], v22 offset:0
    s_add_u32 m0, s49, 104448
    s_add_u32 s50, s46, 896
    buffer_load_dwordx4 v16, s[16:19], s50 offen lds
    s_waitcnt lgkmcnt(4)
    v_mfma_f32_32x32x16_bf16 v[52:67], v[112:115], v[124:127], v[52:67]
    ds_read_b128 v[112:115], v22 offset:4096
    s_waitcnt lgkmcnt(4)
    v_mfma_f32_32x32x16_bf16 v[68:83], v[116:119], v[124:127], v[68:83]
    ds_read_b128 v[116:119], v22 offset:8192
    s_add_u32 m0, s49, 105472
    s_add_u32 s50, s46, 33664
    buffer_load_dwordx4 v17, s[16:19], s50 offen lds
    s_waitcnt lgkmcnt(4)
    v_mfma_f32_32x32x16_bf16 v[84:99], v[120:123], v[124:127], v[84:99]
    ds_read_b128 v[120:123], v22 offset:12288
    s_waitcnt lgkmcnt(10)
    v_mfma_f32_16x16x32_bf16 v[100:103], v[132:135], v[136:139], v[100:103]
    v_mfma_f32_16x16x32_bf16 v[104:107], v[132:135], v[140:143], v[104:107]
    ds_read_b128 v[132:135], v27 offset:34816
    ds_read_b128 v[136:139], v29 offset:34816
    ds_read_b128 v[140:143], v29 offset:36864
    ds_read_b128 v[124:127], v23 offset:34816
    s_waitcnt lgkmcnt(7)
    v_mfma_f32_32x32x16_bf16 v[36:51], v[108:111], v[128:131], v[36:51]
    ds_read_b128 v[108:111], v19 offset:34816
    s_add_u32 m0, s49, 106496
    s_add_u32 s50, s46, 66432
    buffer_load_dwordx4 v16, s[16:19], s50 offen lds
    s_waitcnt lgkmcnt(7)
    v_mfma_f32_32x32x16_bf16 v[52:67], v[112:115], v[128:131], v[52:67]
    ds_read_b128 v[112:115], v19 offset:38912
    s_waitcnt lgkmcnt(7)
    v_mfma_f32_32x32x16_bf16 v[68:83], v[116:119], v[128:131], v[68:83]
    ds_read_b128 v[116:119], v19 offset:43008
    s_add_u32 m0, s49, 107520
    s_add_u32 s50, s46, 99200
    buffer_load_dwordx4 v17, s[16:19], s50 offen lds
    s_waitcnt lgkmcnt(7)
    v_mfma_f32_32x32x16_bf16 v[84:99], v[120:123], v[128:131], v[84:99]
    ds_read_b128 v[120:123], v19 offset:47104
    s_cmp_ge_u32 s29, 2
    s_cbranch_scc1 kfd_31
    s_add_u32 m0, s48, 104448
    s_add_u32 s50, s45, 896
    buffer_load_dwordx4 v18, s[24:27], s50 offen lds
kfd_31:
    s_waitcnt vmcnt(8)
    s_barrier
    ds_read_b128 v[128:131], v24 offset:34816
    s_waitcnt lgkmcnt(4)
    v_mfma_f32_32x32x16_bf16 v[36:51], v[108:111], v[124:127], v[36:51]
    ds_read_b128 v[108:111], v20 offset:34816
    s_add_u32 m0, s47, 0
    s_add_u32 s50, s44, 1024
    buffer_load_dwordx4 v16, s[24:27], s50 offen lds
    s_waitcnt lgkmcnt(4)
    v_mfma_f32_32x32x16_bf16 v[52:67], v[112:115], v[124:127], v[52:67]
    ds_read_b128 v[112:115], v20 offset:38912
    s_waitcnt lgkmcnt(4)
    v_mfma_f32_32x32x16_bf16 v[68:83], v[116:119], v[124:127], v[68:83]
    ds_read_b128 v[116:119], v20 offset:43008
    s_add_u32 m0, s47, 1024
    s_add_u32 s50, s44, 33792
    buffer_load_dwordx4 v17, s[24:27], s50 offen lds
    s_waitcnt lgkmcnt(4)
    v_mfma_f32_32x32x16_bf16 v[84:99], v[120:123], v[124:127], v[84:99]
    ds_read_b128 v[120:123], v20 offset:47104
    s_waitcnt lgkmcnt(10)
    v_mfma_f32_16x16x32_bf16 v[100:103], v[132:135], v[136:139], v[100:103]
    v_mfma_f32_16x16x32_bf16 v[104:107], v[132:135], v[140:143], v[104:107]
    ds_read_b128 v[132:135], v28 offset:34816
    ds_read_b128 v[136:139], v30 offset:34816
    ds_read_b128 v[140:143], v30 offset:36864
    ds_read_b128 v[124:127], v25 offset:34816
    s_waitcnt lgkmcnt(7)
    v_mfma_f32_32x32x16_bf16 v[36:51], v[108:111], v[128:131], v[36:51]
    ds_read_b128 v[108:111], v21 offset:34816
    s_add_u32 m0, s47, 2048
    s_add_u32 s50, s44, 66560
    buffer_load_dwordx4 v16, s[24:27], s50 offen lds
    s_waitcnt lgkmcnt(7)
    v_mfma_f32_32x32x16_bf16 v[52:67], v[112:115], v[128:131], v[52:67]
    ds_read_b128 v[112:115], v21 offset:38912
    s_waitcnt lgkmcnt(7)
    v_mfma_f32_32x32x16_bf16 v[68:83], v[116:119], v[128:131], v[68:83]
    ds_read_b128 v[116:119], v21 offset:43008
    s_add_u32 m0, s47, 3072
    s_add_u32 s50, s44, 99328
    buffer_load_dwordx4 v17, s[24:27], s50 offen lds
    s_waitcnt lgkmcnt(7)
    v_mfma_f32_32x32x16_bf16 v[84:99], v[120:123], v[128:131], v[84:99]
    ds_read_b128 v[120:123], v21 offset:47104
    ds_read_b128 v[128:131], v26 offset:34816
    s_waitcnt lgkmcnt(4)
    v_mfma_f32_32x32x16_bf16 v[36:51], v[108:111], v[124:127], v[36:51]
    ds_read_b128 v[108:111], v22 offset:34816
    s_add_u32 m0, s49, 0
    s_add_u32 s50, s46, 1024
    buffer_load_dwordx4 v16, s[16:19], s50 offen lds
    s_waitcnt lgkmcnt(4)
    v_mfma_f32_32x32x16_bf16 v[52:67], v[112:115], v[124:127], v[52:67]
    ds_read_b128 v[112:115], v22 offset:38912
    s_waitcnt lgkmcnt(4)
    v_mfma_f32_32x32x16_bf16 v[68:83], v[116:119], v[124:127], v[68:83]
    ds_read_b128 v[116:119], v22 offset:43008
    s_add_u32 m0, s49, 1024
    s_add_u32 s50, s46, 33792
    buffer_load_dwordx4 v17, s[16:19], s50 offen lds
    s_waitcnt lgkmcnt(4)
    v_mfma_f32_32x32x16_bf16 v[84:99], v[120:123], v[124:127], v[84:99]
    ds_read_b128 v[120:123], v22 offset:47104
    s_waitcnt lgkmcnt(10)
    v_mfma_f32_16x16x32_bf16 v[100:103], v[132:135], v[136:139], v[100:103]
    v_mfma_f32_16x16x32_bf16 v[104:107], v[132:135], v[140:143], v[104:107]
    v_add_u32 v19, 69632, v19
    v_add_u32 v20, 69632, v20
    v_add_u32 v21, 69632, v21
    v_add_u32 v22, 69632, v22
    v_add_u32 v23, 69632, v23
    v_add_u32 v24, 69632, v24
    v_add_u32 v25, 69632, v25
    v_add_u32 v26, 69632, v26
    v_add_u32 v27, 69632, v27
    v_add_u32 v28, 69632, v28
    v_add_u32 v29, 69632, v29
    v_add_u32 v30, 69632, v30
    ds_read_b128 v[132:135], v27 offset:0
    ds_read_b128 v[136:139], v29 offset:0
    ds_read_b128 v[140:143], v29 offset:2048
    ds_read_b128 v[124:127], v23 offset:0
    s_waitcnt lgkmcnt(7)
    v_mfma_f32_32x32x16_bf16 v[36:51], v[108:111], v[128:131], v[36:51]
    ds_read_b128 v[108:111], v19 offset:0
    s_add_u32 m0, s49, 2048
    s_add_u32 s50, s46, 66560
    buffer_load_dwordx4 v16, s[16:19], s50 offen lds
    s_waitcnt lgkmcnt(7)
    v_mfma_f32_32x32x16_bf16 v[52:67], v[112:115], v[128:131], v[52:67]
    ds_read_b128 v[112:115], v19 offset:4096
    s_waitcnt lgkmcnt(7)
    v_mfma_f32_32x32x16_bf16 v[68:83], v[116:119], v[128:131], v[68:83]
    ds_read_b128 v[116:119], v19 offset:8192
    s_add_u32 m0, s49, 3072
    s_add_u32 s50, s46, 99328
    buffer_load_dwordx4 v17, s[16:19], s50 offen lds
    s_waitcnt lgkmcnt(7)
    v_mfma_f32_32x32x16_bf16 v[84:99], v[120:123], v[128:131], v[84:99]
    ds_read_b128 v[120:123], v19 offset:12288
    s_cmp_ge_u32 s29, 2
    s_cbranch_scc1 kfd_32
    s_add_u32 m0, s48, 0
    s_add_u32 s50, s45, 1024
    buffer_load_dwordx4 v18, s[24:27], s50 offen lds
kfd_32:
    s_waitcnt vmcnt(8)
    s_barrier
    ds_read_b128 v[128:131], v24 offset:0
    s_waitcnt lgkmcnt(4)
    v_mfma_f32_32x32x16_bf16 v[36:51], v[108:111], v[124:127], v[36:51]
    ds_read_b128 v[108:111], v20 offset:0
    s_add_u32 m0, s47, 34816
    s_add_u32 s50, s44, 1152
    buffer_load_dwordx4 v16, s[24:27], s50 offen lds
    s_waitcnt lgkmcnt(4)
    v_mfma_f32_32x32x16_bf16 v[52:67], v[112:115], v[124:127], v[52:67]
    ds_read_b128 v[112:115], v20 offset:4096
    s_waitcnt lgkmcnt(4)
    v_mfma_f32_32x32x16_bf16 v[68:83], v[116:119], v[124:127], v[68:83]
    ds_read_b128 v[116:119], v20 offset:8192
    s_add_u32 m0, s47, 35840
    s_add_u32 s50, s44, 33920
    buffer_load_dwordx4 v17, s[24:27], s50 offen lds
    s_waitcnt lgkmcnt(4)
    v_mfma_f32_32x32x16_bf16 v[84:99], v[120:123], v[124:127], v[84:99]
    ds_read_b128 v[120:123], v20 offset:12288
    s_waitcnt lgkmcnt(10)
    v_mfma_f32_16x16x32_bf16 v[100:103], v[132:135], v[136:139], v[100:103]
    v_mfma_f32_16x16x32_bf16 v[104:107], v[132:135], v[140:143], v[104:107]
    ds_read_b128 v[132:135], v28 offset:0
    ds_read_b128 v[136:139], v30 offset:0
    ds_read_b128 v[140:143], v30 offset:2048
    ds_read_b128 v[124:127], v25 offset:0
    s_waitcnt lgkmcnt(7)
    v_mfma_f32_32x32x16_bf16 v[36:51], v[108:111], v[128:131], v[36:51]
    ds_read_b128 v[108:111], v21 offset:0
    s_add_u32 m0, s47, 36864
    s_add_u32 s50, s44, 66688
    buffer_load_dwordx4 v16, s[24:27], s50 offen lds
    s_waitcnt lgkmcnt(7)
    v_mfma_f32_32x32x16_bf16 v[52:67], v[112:115], v[128:131], v[52:67]
    ds_read_b128 v[112:115], v21 offset:4096
    s_waitcnt lgkmcnt(7)
    v_mfma_f32_32x32x16_bf16 v[68:83], v[116:119], v[128:131], v[68:83]
    ds_read_b128 v[116:119], v21 offset:8192
    s_add_u32 m0, s47, 37888
    s_add_u32 s50, s44, 99456
    buffer_load_dwordx4 v17, s[24:27], s50 offen lds
    s_waitcnt lgkmcnt(7)
    v_mfma_f32_32x32x16_bf16 v[84:99], v[120:123], v[128:131], v[84:99]
    ds_read_b128 v[120:123], v21 offset:12288
    ds_read_b128 v[128:131], v26 offset:0
    s_waitcnt lgkmcnt(4)
    v_mfma_f32_32x32x16_bf16 v[36:51], v[108:111], v[124:127], v[36:51]
    ds_read_b128 v[108:111], v22 offset:0
    s_add_u32 m0, s49, 34816
    s_add_u32 s50, s46, 1152
    buffer_load_dwordx4 v16, s[16:19], s50 offen lds
    s_waitcnt lgkmcnt(4)
    v_mfma_f32_32x32x16_bf16 v[52:67], v[112:115], v[124:127], v[52:67]
    ds_read_b128 v[112:115], v22 offset:4096
    s_waitcnt lgkmcnt(4)
    v_mfma_f32_32x32x16_bf16 v[68:83], v[116:119], v[124:127], v[68:83]
    ds_read_b128 v[116:119], v22 offset:8192
    s_add_u32 m0, s49, 35840
    s_add_u32 s50, s46, 33920
    buffer_load_dwordx4 v17, s[16:19], s50 offen lds
    s_waitcnt lgkmcnt(4)
    v_mfma_f32_32x32x16_bf16 v[84:99], v[120:123], v[124:127], v[84:99]
    ds_read_b128 v[120:123], v22 offset:12288
    s_waitcnt lgkmcnt(10)
    v_mfma_f32_16x16x32_bf16 v[100:103], v[132:135], v[136:139], v[100:103]
    v_mfma_f32_16x16x32_bf16 v[104:107], v[132:135], v[140:143], v[104:107]
    ds_read_b128 v[132:135], v27 offset:34816
    ds_read_b128 v[136:139], v29 offset:34816
    ds_read_b128 v[140:143], v29 offset:36864
    ds_read_b128 v[124:127], v23 offset:34816
    s_waitcnt lgkmcnt(7)
    v_mfma_f32_32x32x16_bf16 v[36:51], v[108:111], v[128:131], v[36:51]
    ds_read_b128 v[108:111], v19 offset:34816
    s_add_u32 m0, s49, 36864
    s_add_u32 s50, s46, 66688
    buffer_load_dwordx4 v16, s[16:19], s50 offen lds
    s_waitcnt lgkmcnt(7)
    v_mfma_f32_32x32x16_bf16 v[52:67], v[112:115], v[128:131], v[52:67]
    ds_read_b128 v[112:115], v19 offset:38912
    s_waitcnt lgkmcnt(7)
    v_mfma_f32_32x32x16_bf16 v[68:83], v[116:119], v[128:131], v[68:83]
    ds_read_b128 v[116:119], v19 offset:43008
    s_add_u32 m0, s49, 37888
    s_add_u32 s50, s46, 99456
    buffer_load_dwordx4 v17, s[16:19], s50 offen lds
    s_waitcnt lgkmcnt(7)
    v_mfma_f32_32x32x16_bf16 v[84:99], v[120:123], v[128:131], v[84:99]
    ds_read_b128 v[120:123], v19 offset:47104
    s_cmp_ge_u32 s29, 2
    s_cbranch_scc1 kfd_33
    s_add_u32 m0, s48, 34816
    s_add_u32 s50, s45, 1152
    buffer_load_dwordx4 v18, s[24:27], s50 offen lds
kfd_33:
    s_waitcnt vmcnt(8)
    s_barrier
    ds_read_b128 v[128:131], v24 offset:34816
    s_waitcnt lgkmcnt(4)
    v_mfma_f32_32x32x16_bf16 v[36:51], v[108:111], v[124:127], v[36:51]
    ds_read_b128 v[108:111], v20 offset:34816
    s_add_u32 m0, s47, 69632
    s_add_u32 s50, s44, 1280
    buffer_load_dwordx4 v16, s[24:27], s50 offen lds
    s_waitcnt lgkmcnt(4)
    v_mfma_f32_32x32x16_bf16 v[52:67], v[112:115], v[124:127], v[52:67]
    ds_read_b128 v[112:115], v20 offset:38912
    s_waitcnt lgkmcnt(4)
    v_mfma_f32_32x32x16_bf16 v[68:83], v[116:119], v[124:127], v[68:83]
    ds_read_b128 v[116:119], v20 offset:43008
    s_add_u32 m0, s47, 70656
    s_add_u32 s50, s44, 34048
    buffer_load_dwordx4 v17, s[24:27], s50 offen lds
    s_waitcnt lgkmcnt(4)
    v_mfma_f32_32x32x16_bf16 v[84:99], v[120:123], v[124:127], v[84:99]
    ds_read_b128 v[120:123], v20 offset:47104
    s_waitcnt lgkmcnt(10)
    v_mfma_f32_16x16x32_bf16 v[100:103], v[132:135], v[136:139], v[100:103]
    v_mfma_f32_16x16x32_bf16 v[104:107], v[132:135], v[140:143], v[104:107]
    ds_read_b128 v[132:135], v28 offset:34816
    ds_read_b128 v[136:139], v30 offset:34816
    ds_read_b128 v[140:143], v30 offset:36864
    ds_read_b128 v[124:127], v25 offset:34816
    s_waitcnt lgkmcnt(7)
    v_mfma_f32_32x32x16_bf16 v[36:51], v[108:111], v[128:131], v[36:51]
    ds_read_b128 v[108:111], v21 offset:34816
    s_add_u32 m0, s47, 71680
    s_add_u32 s50, s44, 66816
    buffer_load_dwordx4 v16, s[24:27], s50 offen lds
    s_waitcnt lgkmcnt(7)
    v_mfma_f32_32x32x16_bf16 v[52:67], v[112:115], v[128:131], v[52:67]
    ds_read_b128 v[112:115], v21 offset:38912
    s_waitcnt lgkmcnt(7)
    v_mfma_f32_32x32x16_bf16 v[68:83], v[116:119], v[128:131], v[68:83]
    ds_read_b128 v[116:119], v21 offset:43008
    s_add_u32 m0, s47, 72704
    s_add_u32 s50, s44, 99584
    buffer_load_dwordx4 v17, s[24:27], s50 offen lds
    s_waitcnt lgkmcnt(7)
    v_mfma_f32_32x32x16_bf16 v[84:99], v[120:123], v[128:131], v[84:99]
    ds_read_b128 v[120:123], v21 offset:47104
    ds_read_b128 v[128:131], v26 offset:34816
    s_waitcnt lgkmcnt(4)
    v_mfma_f32_32x32x16_bf16 v[36:51], v[108:111], v[124:127], v[36:51]
    ds_read_b128 v[108:111], v22 offset:34816
    s_add_u32 m0, s49, 69632
    s_add_u32 s50, s46, 1280
    buffer_load_dwordx4 v16, s[16:19], s50 offen lds
    s_waitcnt lgkmcnt(4)
    v_mfma_f32_32x32x16_bf16 v[52:67], v[112:115], v[124:127], v[52:67]
    ds_read_b128 v[112:115], v22 offset:38912
    s_waitcnt lgkmcnt(4)
    v_mfma_f32_32x32x16_bf16 v[68:83], v[116:119], v[124:127], v[68:83]
    ds_read_b128 v[116:119], v22 offset:43008
    s_add_u32 m0, s49, 70656
    s_add_u32 s50, s46, 34048
    buffer_load_dwordx4 v17, s[16:19], s50 offen lds
    s_waitcnt lgkmcnt(4)
    v_mfma_f32_32x32x16_bf16 v[84:99], v[120:123], v[124:127], v[84:99]
    ds_read_b128 v[120:123], v22 offset:47104
    s_waitcnt lgkmcnt(10)
    v_mfma_f32_16x16x32_bf16 v[100:103], v[132:135], v[136:139], v[100:103]
    v_mfma_f32_16x16x32_bf16 v[104:107], v[132:135], v[140:143], v[104:107]
    v_add_u32 v19, 4294897664, v19
    v_add_u32 v20, 4294897664, v20
    v_add_u32 v21, 4294897664, v21
    v_add_u32 v22, 4294897664, v22
    v_add_u32 v23, 4294897664, v23
    v_add_u32 v24, 4294897664, v24
    v_add_u32 v25, 4294897664, v25
    v_add_u32 v26, 4294897664, v26
    v_add_u32 v27, 4294897664, v27
    v_add_u32 v28, 4294897664, v28
    v_add_u32 v29, 4294897664, v29
    v_add_u32 v30, 4294897664, v30
    ds_read_b128 v[132:135], v27 offset:0
    ds_read_b128 v[136:139], v29 offset:0
    ds_read_b128 v[140:143], v29 offset:2048
    ds_read_b128 v[124:127], v23 offset:0
    s_waitcnt lgkmcnt(7)
    v_mfma_f32_32x32x16_bf16 v[36:51], v[108:111], v[128:131], v[36:51]
    ds_read_b128 v[108:111], v19 offset:0
    s_add_u32 m0, s49, 71680
    s_add_u32 s50, s46, 66816
    buffer_load_dwordx4 v16, s[16:19], s50 offen lds
    s_waitcnt lgkmcnt(7)
    v_mfma_f32_32x32x16_bf16 v[52:67], v[112:115], v[128:131], v[52:67]
    ds_read_b128 v[112:115], v19 offset:4096
    s_waitcnt lgkmcnt(7)
    v_mfma_f32_32x32x16_bf16 v[68:83], v[116:119], v[128:131], v[68:83]
    ds_read_b128 v[116:119], v19 offset:8192
    s_add_u32 m0, s49, 72704
    s_add_u32 s50, s46, 99584
    buffer_load_dwordx4 v17, s[16:19], s50 offen lds
    s_waitcnt lgkmcnt(7)
    v_mfma_f32_32x32x16_bf16 v[84:99], v[120:123], v[128:131], v[84:99]
    ds_read_b128 v[120:123], v19 offset:12288
    s_cmp_ge_u32 s29, 2
    s_cbranch_scc1 kfd_34
    s_add_u32 m0, s48, 69632
    s_add_u32 s50, s45, 1280
    buffer_load_dwordx4 v18, s[24:27], s50 offen lds
kfd_34:
    s_waitcnt vmcnt(8)
    s_barrier
    ds_read_b128 v[128:131], v24 offset:0
    s_waitcnt lgkmcnt(4)
    v_mfma_f32_32x32x16_bf16 v[36:51], v[108:111], v[124:127], v[36:51]
    ds_read_b128 v[108:111], v20 offset:0
    s_add_u32 m0, s47, 104448
    s_add_u32 s50, s44, 1408
    buffer_load_dwordx4 v16, s[24:27], s50 offen lds
    s_waitcnt lgkmcnt(4)
    v_mfma_f32_32x32x16_bf16 v[52:67], v[112:115], v[124:127], v[52:67]
    ds_read_b128 v[112:115], v20 offset:4096
    s_waitcnt lgkmcnt(4)
    v_mfma_f32_32x32x16_bf16 v[68:83], v[116:119], v[124:127], v[68:83]
    ds_read_b128 v[116:119], v20 offset:8192
    s_add_u32 m0, s47, 105472
    s_add_u32 s50, s44, 34176
    buffer_load_dwordx4 v17, s[24:27], s50 offen lds
    s_waitcnt lgkmcnt(4)
    v_mfma_f32_32x32x16_bf16 v[84:99], v[120:123], v[124:127], v[84:99]
    ds_read_b128 v[120:123], v20 offset:12288
    s_waitcnt lgkmcnt(10)
    v_mfma_f32_16x16x32_bf16 v[100:103], v[132:135], v[136:139], v[100:103]
    v_mfma_f32_16x16x32_bf16 v[104:107], v[132:135], v[140:143], v[104:107]
    ds_read_b128 v[132:135], v28 offset:0
    ds_read_b128 v[136:139], v30 offset:0
    ds_read_b128 v[140:143], v30 offset:2048
    ds_read_b128 v[124:127], v25 offset:0
    s_waitcnt lgkmcnt(7)
    v_mfma_f32_32x32x16_bf16 v[36:51], v[108:111], v[128:131], v[36:51]
    ds_read_b128 v[108:111], v21 offset:0
    s_add_u32 m0, s47, 106496
    s_add_u32 s50, s44, 66944
    buffer_load_dwordx4 v16, s[24:27], s50 offen lds
    s_waitcnt lgkmcnt(7)
    v_mfma_f32_32x32x16_bf16 v[52:67], v[112:115], v[128:131], v[52:67]
    ds_read_b128 v[112:115], v21 offset:4096
    s_waitcnt lgkmcnt(7)
    v_mfma_f32_32x32x16_bf16 v[68:83], v[116:119], v[128:131], v[68:83]
    ds_read_b128 v[116:119], v21 offset:8192
    s_add_u32 m0, s47, 107520
    s_add_u32 s50, s44, 99712
    buffer_load_dwordx4 v17, s[24:27], s50 offen lds
    s_waitcnt lgkmcnt(7)
    v_mfma_f32_32x32x16_bf16 v[84:99], v[120:123], v[128:131], v[84:99]
    ds_read_b128 v[120:123], v21 offset:12288
    ds_read_b128 v[128:131], v26 offset:0
    s_waitcnt lgkmcnt(4)
    v_mfma_f32_32x32x16_bf16 v[36:51], v[108:111], v[124:127], v[36:51]
    ds_read_b128 v[108:111], v22 offset:0
    s_add_u32 m0, s49, 104448
    s_add_u32 s50, s46, 1408
    buffer_load_dwordx4 v16, s[16:19], s50 offen lds
    s_waitcnt lgkmcnt(4)
    v_mfma_f32_32x32x16_bf16 v[52:67], v[112:115], v[124:127], v[52:67]
    ds_read_b128 v[112:115], v22 offset:4096
    s_waitcnt lgkmcnt(4)
    v_mfma_f32_32x32x16_bf16 v[68:83], v[116:119], v[124:127], v[68:83]
    ds_read_b128 v[116:119], v22 offset:8192
    s_add_u32 m0, s49, 105472
    s_add_u32 s50, s46, 34176
    buffer_load_dwordx4 v17, s[16:19], s50 offen lds
    s_waitcnt lgkmcnt(4)
    v_mfma_f32_32x32x16_bf16 v[84:99], v[120:123], v[124:127], v[84:99]
    ds_read_b128 v[120:123], v22 offset:12288
    s_waitcnt lgkmcnt(10)
    v_mfma_f32_16x16x32_bf16 v[100:103], v[132:135], v[136:139], v[100:103]
    v_mfma_f32_16x16x32_bf16 v[104:107], v[132:135], v[140:143], v[104:107]
    ds_read_b128 v[132:135], v27 offset:34816
    ds_read_b128 v[136:139], v29 offset:34816
    ds_read_b128 v[140:143], v29 offset:36864
    ds_read_b128 v[124:127], v23 offset:34816
    s_waitcnt lgkmcnt(7)
    v_mfma_f32_32x32x16_bf16 v[36:51], v[108:111], v[128:131], v[36:51]
    ds_read_b128 v[108:111], v19 offset:34816
    s_add_u32 m0, s49, 106496
    s_add_u32 s50, s46, 66944
    buffer_load_dwordx4 v16, s[16:19], s50 offen lds
    s_waitcnt lgkmcnt(7)
    v_mfma_f32_32x32x16_bf16 v[52:67], v[112:115], v[128:131], v[52:67]
    ds_read_b128 v[112:115], v19 offset:38912
    s_waitcnt lgkmcnt(7)
    v_mfma_f32_32x32x16_bf16 v[68:83], v[116:119], v[128:131], v[68:83]
    ds_read_b128 v[116:119], v19 offset:43008
    s_add_u32 m0, s49, 107520
    s_add_u32 s50, s46, 99712
    buffer_load_dwordx4 v17, s[16:19], s50 offen lds
    s_waitcnt lgkmcnt(7)
    v_mfma_f32_32x32x16_bf16 v[84:99], v[120:123], v[128:131], v[84:99]
    ds_read_b128 v[120:123], v19 offset:47104
    s_cmp_ge_u32 s29, 2
    s_cbranch_scc1 kfd_35
    s_add_u32 m0, s48, 104448
    s_add_u32 s50, s45, 1408
    buffer_load_dwordx4 v18, s[24:27], s50 offen lds
kfd_35:
    s_waitcnt vmcnt(8)
    s_barrier
    ds_read_b128 v[128:131], v24 offset:34816
    s_waitcnt lgkmcnt(4)
    v_mfma_f32_32x32x16_bf16 v[36:51], v[108:111], v[124:127], v[36:51]
    ds_read_b128 v[108:111], v20 offset:34816
    s_add_u32 m0, s47, 0
    s_add_u32 s50, s44, 1536
    buffer_load_dwordx4 v16, s[24:27], s50 offen lds
    s_waitcnt lgkmcnt(4)
    v_mfma_f32_32x32x16_bf16 v[52:67], v[112:115], v[124:127], v[52:67]
    ds_read_b128 v[112:115], v20 offset:38912
    s_waitcnt lgkmcnt(4)
    v_mfma_f32_32x32x16_bf16 v[68:83], v[116:119], v[124:127], v[68:83]
    ds_read_b128 v[116:119], v20 offset:43008
    s_add_u32 m0, s47, 1024
    s_add_u32 s50, s44, 34304
    buffer_load_dwordx4 v17, s[24:27], s50 offen lds
    s_waitcnt lgkmcnt(4)
    v_mfma_f32_32x32x16_bf16 v[84:99], v[120:123], v[124:127], v[84:99]
    ds_read_b128 v[120:123], v20 offset:47104
    s_waitcnt lgkmcnt(10)
    v_mfma_f32_16x16x32_bf16 v[100:103], v[132:135], v[136:139], v[100:103]
    v_mfma_f32_16x16x32_bf16 v[104:107], v[132:135], v[140:143], v[104:107]
    ds_read_b128 v[132:135], v28 offset:34816
    ds_read_b128 v[136:139], v30 offset:34816
    ds_read_b128 v[140:143], v30 offset:36864
    ds_read_b128 v[124:127], v25 offset:34816
    s_waitcnt lgkmcnt(7)
    v_mfma_f32_32x32x16_bf16 v[36:51], v[108:111], v[128:131], v[36:51]
    ds_read_b128 v[108:111], v21 offset:34816
    s_add_u32 m0, s47, 2048
    s_add_u32 s50, s44, 67072
    buffer_load_dwordx4 v16, s[24:27], s50 offen lds
    s_waitcnt lgkmcnt(7)
    v_mfma_f32_32x32x16_bf16 v[52:67], v[112:115], v[128:131], v[52:67]
    ds_read_b128 v[112:115], v21 offset:38912
    s_waitcnt lgkmcnt(7)
    v_mfma_f32_32x32x16_bf16 v[68:83], v[116:119], v[128:131], v[68:83]
    ds_read_b128 v[116:119], v21 offset:43008
    s_add_u32 m0, s47, 3072
    s_add_u32 s50, s44, 99840
    buffer_load_dwordx4 v17, s[24:27], s50 offen lds
    s_waitcnt lgkmcnt(7)
    v_mfma_f32_32x32x16_bf16 v[84:99], v[120:123], v[128:131], v[84:99]
    ds_read_b128 v[120:123], v21 offset:47104
    ds_read_b128 v[128:131], v26 offset:34816
    s_waitcnt lgkmcnt(4)
    v_mfma_f32_32x32x16_bf16 v[36:51], v[108:111], v[124:127], v[36:51]
    ds_read_b128 v[108:111], v22 offset:34816
    s_add_u32 m0, s49, 0
    s_add_u32 s50, s46, 1536
    buffer_load_dwordx4 v16, s[16:19], s50 offen lds
    s_waitcnt lgkmcnt(4)
    v_mfma_f32_32x32x16_bf16 v[52:67], v[112:115], v[124:127], v[52:67]
    ds_read_b128 v[112:115], v22 offset:38912
    s_waitcnt lgkmcnt(4)
    v_mfma_f32_32x32x16_bf16 v[68:83], v[116:119], v[124:127], v[68:83]
    ds_read_b128 v[116:119], v22 offset:43008
    s_add_u32 m0, s49, 1024
    s_add_u32 s50, s46, 34304
    buffer_load_dwordx4 v17, s[16:19], s50 offen lds
    s_waitcnt lgkmcnt(4)
    v_mfma_f32_32x32x16_bf16 v[84:99], v[120:123], v[124:127], v[84:99]
    ds_read_b128 v[120:123], v22 offset:47104
    s_waitcnt lgkmcnt(10)
    v_mfma_f32_16x16x32_bf16 v[100:103], v[132:135], v[136:139], v[100:103]
    v_mfma_f32_16x16x32_bf16 v[104:107], v[132:135], v[140:143], v[104:107]
    v_add_u32 v19, 69632, v19
    v_add_u32 v20, 69632, v20
    v_add_u32 v21, 69632, v21
    v_add_u32 v22, 69632, v22
    v_add_u32 v23, 69632, v23
    v_add_u32 v24, 69632, v24
    v_add_u32 v25, 69632, v25
    v_add_u32 v26, 69632, v26
    v_add_u32 v27, 69632, v27
    v_add_u32 v28, 69632, v28
    v_add_u32 v29, 69632, v29
    v_add_u32 v30, 69632, v30
    ds_read_b128 v[132:135], v27 offset:0
    ds_read_b128 v[136:139], v29 offset:0
    ds_read_b128 v[140:143], v29 offset:2048
    ds_read_b128 v[124:127], v23 offset:0
    s_waitcnt lgkmcnt(7)
    v_mfma_f32_32x32x16_bf16 v[36:51], v[108:111], v[128:131], v[36:51]
    ds_read_b128 v[108:111], v19 offset:0
    s_add_u32 m0, s49, 2048
    s_add_u32 s50, s46, 67072
    buffer_load_dwordx4 v16, s[16:19], s50 offen lds
    s_waitcnt lgkmcnt(7)
    v_mfma_f32_32x32x16_bf16 v[52:67], v[112:115], v[128:131], v[52:67]
    ds_read_b128 v[112:115], v19 offset:4096
    s_waitcnt lgkmcnt(7)
    v_mfma_f32_32x32x16_bf16 v[68:83], v[116:119], v[128:131], v[68:83]
    ds_read_b128 v[116:119], v19 offset:8192
    s_add_u32 m0, s49, 3072
    s_add_u32 s50, s46, 99840
    buffer_load_dwordx4 v17, s[16:19], s50 offen lds
    s_waitcnt lgkmcnt(7)
    v_mfma_f32_32x32x16_bf16 v[84:99], v[120:123], v[128:131], v[84:99]
    ds_read_b128 v[120:123], v19 offset:12288
    s_cmp_ge_u32 s29, 2
    s_cbranch_scc1 kfd_36
    s_add_u32 m0, s48, 0
    s_add_u32 s50, s45, 1536
    buffer_load_dwordx4 v18, s[24:27], s50 offen lds
kfd_36:
    s_waitcnt vmcnt(8)
    s_barrier
    ds_read_b128 v[128:131], v24 offset:0
    s_waitcnt lgkmcnt(4)
    v_mfma_f32_32x32x16_bf16 v[36:51], v[108:111], v[124:127], v[36:51]
    ds_read_b128 v[108:111], v20 offset:0
    s_add_u32 m0, s47, 34816
    s_add_u32 s50, s44, 1664
    buffer_load_dwordx4 v16, s[24:27], s50 offen lds
    s_waitcnt lgkmcnt(4)
    v_mfma_f32_32x32x16_bf16 v[52:67], v[112:115], v[124:127], v[52:67]
    ds_read_b128 v[112:115], v20 offset:4096
    s_waitcnt lgkmcnt(4)
    v_mfma_f32_32x32x16_bf16 v[68:83], v[116:119], v[124:127], v[68:83]
    ds_read_b128 v[116:119], v20 offset:8192
    s_add_u32 m0, s47, 35840
    s_add_u32 s50, s44, 34432
    buffer_load_dwordx4 v17, s[24:27], s50 offen lds
    s_waitcnt lgkmcnt(4)
    v_mfma_f32_32x32x16_bf16 v[84:99], v[120:123], v[124:127], v[84:99]
    ds_read_b128 v[120:123], v20 offset:12288
    s_waitcnt lgkmcnt(10)
    v_mfma_f32_16x16x32_bf16 v[100:103], v[132:135], v[136:139], v[100:103]
    v_mfma_f32_16x16x32_bf16 v[104:107], v[132:135], v[140:143], v[104:107]
    ds_read_b128 v[132:135], v28 offset:0
    ds_read_b128 v[136:139], v30 offset:0
    ds_read_b128 v[140:143], v30 offset:2048
    ds_read_b128 v[124:127], v25 offset:0
    s_waitcnt lgkmcnt(7)
    v_mfma_f32_32x32x16_bf16 v[36:51], v[108:111], v[128:131], v[36:51]
    ds_read_b128 v[108:111], v21 offset:0
    s_add_u32 m0, s47, 36864
    s_add_u32 s50, s44, 67200
    buffer_load_dwordx4 v16, s[24:27], s50 offen lds
    s_waitcnt lgkmcnt(7)
    v_mfma_f32_32x32x16_bf16 v[52:67], v[112:115], v[128:131], v[52:67]
    ds_read_b128 v[112:115], v21 offset:4096
    s_waitcnt lgkmcnt(7)
    v_mfma_f32_32x32x16_bf16 v[68:83], v[116:119], v[128:131], v[68:83]
    ds_read_b128 v[116:119], v21 offset:8192
    s_add_u32 m0, s47, 37888
    s_add_u32 s50, s44, 99968
    buffer_load_dwordx4 v17, s[24:27], s50 offen lds
    s_waitcnt lgkmcnt(7)
    v_mfma_f32_32x32x16_bf16 v[84:99], v[120:123], v[128:131], v[84:99]
    ds_read_b128 v[120:123], v21 offset:12288
    ds_read_b128 v[128:131], v26 offset:0
    s_waitcnt lgkmcnt(4)
    v_mfma_f32_32x32x16_bf16 v[36:51], v[108:111], v[124:127], v[36:51]
    ds_read_b128 v[108:111], v22 offset:0
    s_add_u32 m0, s49, 34816
    s_add_u32 s50, s46, 1664
    buffer_load_dwordx4 v16, s[16:19], s50 offen lds
    s_waitcnt lgkmcnt(4)
    v_mfma_f32_32x32x16_bf16 v[52:67], v[112:115], v[124:127], v[52:67]
    ds_read_b128 v[112:115], v22 offset:4096
    s_waitcnt lgkmcnt(4)
    v_mfma_f32_32x32x16_bf16 v[68:83], v[116:119], v[124:127], v[68:83]
    ds_read_b128 v[116:119], v22 offset:8192
    s_add_u32 m0, s49, 35840
    s_add_u32 s50, s46, 34432
    buffer_load_dwordx4 v17, s[16:19], s50 offen lds
    s_waitcnt lgkmcnt(4)
    v_mfma_f32_32x32x16_bf16 v[84:99], v[120:123], v[124:127], v[84:99]
    ds_read_b128 v[120:123], v22 offset:12288
    s_waitcnt lgkmcnt(10)
    v_mfma_f32_16x16x32_bf16 v[100:103], v[132:135], v[136:139], v[100:103]
    v_mfma_f32_16x16x32_bf16 v[104:107], v[132:135], v[140:143], v[104:107]
    ds_read_b128 v[132:135], v27 offset:34816
    ds_read_b128 v[136:139], v29 offset:34816
    ds_read_b128 v[140:143], v29 offset:36864
    ds_read_b128 v[124:127], v23 offset:34816
    s_waitcnt lgkmcnt(7)
    v_mfma_f32_32x32x16_bf16 v[36:51], v[108:111], v[128:131], v[36:51]
    ds_read_b128 v[108:111], v19 offset:34816
    s_add_u32 m0, s49, 36864
    s_add_u32 s50, s46, 67200
    buffer_load_dwordx4 v16, s[16:19], s50 offen lds
    s_waitcnt lgkmcnt(7)
    v_mfma_f32_32x32x16_bf16 v[52:67], v[112:115], v[128:131], v[52:67]
    ds_read_b128 v[112:115], v19 offset:38912
    s_waitcnt lgkmcnt(7)
    v_mfma_f32_32x32x16_bf16 v[68:83], v[116:119], v[128:131], v[68:83]
    ds_read_b128 v[116:119], v19 offset:43008
    s_add_u32 m0, s49, 37888
    s_add_u32 s50, s46, 99968
    buffer_load_dwordx4 v17, s[16:19], s50 offen lds
    s_waitcnt lgkmcnt(7)
    v_mfma_f32_32x32x16_bf16 v[84:99], v[120:123], v[128:131], v[84:99]
    ds_read_b128 v[120:123], v19 offset:47104
    s_cmp_ge_u32 s29, 2
    s_cbranch_scc1 kfd_37
    s_add_u32 m0, s48, 34816
    s_add_u32 s50, s45, 1664
    buffer_load_dwordx4 v18, s[24:27], s50 offen lds
kfd_37:
    s_waitcnt vmcnt(8)
    s_barrier
    ds_read_b128 v[128:131], v24 offset:34816
    s_waitcnt lgkmcnt(4)
    v_mfma_f32_32x32x16_bf16 v[36:51], v[108:111], v[124:127], v[36:51]
    ds_read_b128 v[108:111], v20 offset:34816
    s_add_u32 m0, s47, 69632
    s_add_u32 s50, s44, 1792
    buffer_load_dwordx4 v16, s[24:27], s50 offen lds
    s_waitcnt lgkmcnt(4)
    v_mfma_f32_32x32x16_bf16 v[52:67], v[112:115], v[124:127], v[52:67]
    ds_read_b128 v[112:115], v20 offset:38912
    s_waitcnt lgkmcnt(4)
    v_mfma_f32_32x32x16_bf16 v[68:83], v[116:119], v[124:127], v[68:83]
    ds_read_b128 v[116:119], v20 offset:43008
    s_add_u32 m0, s47, 70656
    s_add_u32 s50, s44, 34560
    buffer_load_dwordx4 v17, s[24:27], s50 offen lds
    s_waitcnt lgkmcnt(4)
    v_mfma_f32_32x32x16_bf16 v[84:99], v[120:123], v[124:127], v[84:99]
    ds_read_b128 v[120:123], v20 offset:47104
    s_waitcnt lgkmcnt(10)
    v_mfma_f32_16x16x32_bf16 v[100:103], v[132:135], v[136:139], v[100:103]
    v_mfma_f32_16x16x32_bf16 v[104:107], v[132:135], v[140:143], v[104:107]
    ds_read_b128 v[132:135], v28 offset:34816
    ds_read_b128 v[136:139], v30 offset:34816
    ds_read_b128 v[140:143], v30 offset:36864
    ds_read_b128 v[124:127], v25 offset:34816
    s_waitcnt lgkmcnt(7)
    v_mfma_f32_32x32x16_bf16 v[36:51], v[108:111], v[128:131], v[36:51]
    ds_read_b128 v[108:111], v21 offset:34816
    s_add_u32 m0, s47, 71680
    s_add_u32 s50, s44, 67328
    buffer_load_dwordx4 v16, s[24:27], s50 offen lds
    s_waitcnt lgkmcnt(7)
    v_mfma_f32_32x32x16_bf16 v[52:67], v[112:115], v[128:131], v[52:67]
    ds_read_b128 v[112:115], v21 offset:38912
    s_waitcnt lgkmcnt(7)
    v_mfma_f32_32x32x16_bf16 v[68:83], v[116:119], v[128:131], v[68:83]
    ds_read_b128 v[116:119], v21 offset:43008
    s_add_u32 m0, s47, 72704
    s_add_u32 s50, s44, 100096
    buffer_load_dwordx4 v17, s[24:27], s50 offen lds
    s_waitcnt lgkmcnt(7)
    v_mfma_f32_32x32x16_bf16 v[84:99], v[120:123], v[128:131], v[84:99]
    ds_read_b128 v[120:123], v21 offset:47104
    ds_read_b128 v[128:131], v26 offset:34816
    s_waitcnt lgkmcnt(4)
    v_mfma_f32_32x32x16_bf16 v[36:51], v[108:111], v[124:127], v[36:51]
    ds_read_b128 v[108:111], v22 offset:34816
    s_add_u32 m0, s49, 69632
    s_add_u32 s50, s46, 1792
    buffer_load_dwordx4 v16, s[16:19], s50 offen lds
    s_waitcnt lgkmcnt(4)
    v_mfma_f32_32x32x16_bf16 v[52:67], v[112:115], v[124:127], v[52:67]
    ds_read_b128 v[112:115], v22 offset:38912
    s_waitcnt lgkmcnt(4)
    v_mfma_f32_32x32x16_bf16 v[68:83], v[116:119], v[124:127], v[68:83]
    ds_read_b128 v[116:119], v22 offset:43008
    s_add_u32 m0, s49, 70656
    s_add_u32 s50, s46, 34560
    buffer_load_dwordx4 v17, s[16:19], s50 offen lds
    s_waitcnt lgkmcnt(4)
    v_mfma_f32_32x32x16_bf16 v[84:99], v[120:123], v[124:127], v[84:99]
    ds_read_b128 v[120:123], v22 offset:47104
    s_waitcnt lgkmcnt(10)
    v_mfma_f32_16x16x32_bf16 v[100:103], v[132:135], v[136:139], v[100:103]
    v_mfma_f32_16x16x32_bf16 v[104:107], v[132:135], v[140:143], v[104:107]
    v_add_u32 v19, 4294897664, v19
    v_add_u32 v20, 4294897664, v20
    v_add_u32 v21, 4294897664, v21
    v_add_u32 v22, 4294897664, v22
    v_add_u32 v23, 4294897664, v23
    v_add_u32 v24, 4294897664, v24
    v_add_u32 v25, 4294897664, v25
    v_add_u32 v26, 4294897664, v26
    v_add_u32 v27, 4294897664, v27
    v_add_u32 v28, 4294897664, v28
    v_add_u32 v29, 4294897664, v29
    v_add_u32 v30, 4294897664, v30
    ds_read_b128 v[132:135], v27 offset:0
    ds_read_b128 v[136:139], v29 offset:0
    ds_read_b128 v[140:143], v29 offset:2048
    ds_read_b128 v[124:127], v23 offset:0
    s_waitcnt lgkmcnt(7)
    v_mfma_f32_32x32x16_bf16 v[36:51], v[108:111], v[128:131], v[36:51]
    ds_read_b128 v[108:111], v19 offset:0
    s_add_u32 m0, s49, 71680
    s_add_u32 s50, s46, 67328
    buffer_load_dwordx4 v16, s[16:19], s50 offen lds
    s_waitcnt lgkmcnt(7)
    v_mfma_f32_32x32x16_bf16 v[52:67], v[112:115], v[128:131], v[52:67]
    ds_read_b128 v[112:115], v19 offset:4096
    s_waitcnt lgkmcnt(7)
    v_mfma_f32_32x32x16_bf16 v[68:83], v[116:119], v[128:131], v[68:83]
    ds_read_b128 v[116:119], v19 offset:8192
    s_add_u32 m0, s49, 72704
    s_add_u32 s50, s46, 100096
    buffer_load_dwordx4 v17, s[16:19], s50 offen lds
    s_waitcnt lgkmcnt(7)
    v_mfma_f32_32x32x16_bf16 v[84:99], v[120:123], v[128:131], v[84:99]
    ds_read_b128 v[120:123], v19 offset:12288
    s_cmp_ge_u32 s29, 2
    s_cbranch_scc1 kfd_38
    s_add_u32 m0, s48, 69632
    s_add_u32 s50, s45, 1792
    buffer_load_dwordx4 v18, s[24:27], s50 offen lds
kfd_38:
    s_waitcnt vmcnt(8)
    s_barrier
    ds_read_b128 v[128:131], v24 offset:0
    s_waitcnt lgkmcnt(4)
    v_mfma_f32_32x32x16_bf16 v[36:51], v[108:111], v[124:127], v[36:51]
    ds_read_b128 v[108:111], v20 offset:0
    s_add_u32 m0, s47, 104448
    s_add_u32 s50, s44, 1920
    buffer_load_dwordx4 v16, s[24:27], s50 offen lds
    s_waitcnt lgkmcnt(4)
    v_mfma_f32_32x32x16_bf16 v[52:67], v[112:115], v[124:127], v[52:67]
    ds_read_b128 v[112:115], v20 offset:4096
    s_waitcnt lgkmcnt(4)
    v_mfma_f32_32x32x16_bf16 v[68:83], v[116:119], v[124:127], v[68:83]
    ds_read_b128 v[116:119], v20 offset:8192
    s_add_u32 m0, s47, 105472
    s_add_u32 s50, s44, 34688
    buffer_load_dwordx4 v17, s[24:27], s50 offen lds
    s_waitcnt lgkmcnt(4)
    v_mfma_f32_32x32x16_bf16 v[84:99], v[120:123], v[124:127], v[84:99]
    ds_read_b128 v[120:123], v20 offset:12288
    s_waitcnt lgkmcnt(10)
    v_mfma_f32_16x16x32_bf16 v[100:103], v[132:135], v[136:139], v[100:103]
    v_mfma_f32_16x16x32_bf16 v[104:107], v[132:135], v[140:143], v[104:107]
    ds_read_b128 v[132:135], v28 offset:0
    ds_read_b128 v[136:139], v30 offset:0
    ds_read_b128 v[140:143], v30 offset:2048
    ds_read_b128 v[124:127], v25 offset:0
    s_waitcnt lgkmcnt(7)
    v_mfma_f32_32x32x16_bf16 v[36:51], v[108:111], v[128:131], v[36:51]
    ds_read_b128 v[108:111], v21 offset:0
    s_add_u32 m0, s47, 106496
    s_add_u32 s50, s44, 67456
    buffer_load_dwordx4 v16, s[24:27], s50 offen lds
    s_waitcnt lgkmcnt(7)
    v_mfma_f32_32x32x16_bf16 v[52:67], v[112:115], v[128:131], v[52:67]
    ds_read_b128 v[112:115], v21 offset:4096
    s_waitcnt lgkmcnt(7)
    v_mfma_f32_32x32x16_bf16 v[68:83], v[116:119], v[128:131], v[68:83]
    ds_read_b128 v[116:119], v21 offset:8192
    s_add_u32 m0, s47, 107520
    s_add_u32 s50, s44, 100224
    buffer_load_dwordx4 v17, s[24:27], s50 offen lds
    s_waitcnt lgkmcnt(7)
    v_mfma_f32_32x32x16_bf16 v[84:99], v[120:123], v[128:131], v[84:99]
    ds_read_b128 v[120:123], v21 offset:12288
    ds_read_b128 v[128:131], v26 offset:0
    s_waitcnt lgkmcnt(4)
    v_mfma_f32_32x32x16_bf16 v[36:51], v[108:111], v[124:127], v[36:51]
    ds_read_b128 v[108:111], v22 offset:0
    s_add_u32 m0, s49, 104448
    s_add_u32 s50, s46, 1920
    buffer_load_dwordx4 v16, s[16:19], s50 offen lds
    s_waitcnt lgkmcnt(4)
    v_mfma_f32_32x32x16_bf16 v[52:67], v[112:115], v[124:127], v[52:67]
    ds_read_b128 v[112:115], v22 offset:4096
    s_waitcnt lgkmcnt(4)
    v_mfma_f32_32x32x16_bf16 v[68:83], v[116:119], v[124:127], v[68:83]
    ds_read_b128 v[116:119], v22 offset:8192
    s_add_u32 m0, s49, 105472
    s_add_u32 s50, s46, 34688
    buffer_load_dwordx4 v17, s[16:19], s50 offen lds
    s_waitcnt lgkmcnt(4)
    v_mfma_f32_32x32x16_bf16 v[84:99], v[120:123], v[124:127], v[84:99]
    ds_read_b128 v[120:123], v22 offset:12288
    s_waitcnt lgkmcnt(10)
    v_mfma_f32_16x16x32_bf16 v[100:103], v[132:135], v[136:139], v[100:103]
    v_mfma_f32_16x16x32_bf16 v[104:107], v[132:135], v[140:143], v[104:107]
    ds_read_b128 v[132:135], v27 offset:34816
    ds_read_b128 v[136:139], v29 offset:34816
    ds_read_b128 v[140:143], v29 offset:36864
    ds_read_b128 v[124:127], v23 offset:34816
    s_waitcnt lgkmcnt(7)
    v_mfma_f32_32x32x16_bf16 v[36:51], v[108:111], v[128:131], v[36:51]
    ds_read_b128 v[108:111], v19 offset:34816
    s_add_u32 m0, s49, 106496
    s_add_u32 s50, s46, 67456
    buffer_load_dwordx4 v16, s[16:19], s50 offen lds
    s_waitcnt lgkmcnt(7)
    v_mfma_f32_32x32x16_bf16 v[52:67], v[112:115], v[128:131], v[52:67]
    ds_read_b128 v[112:115], v19 offset:38912
    s_waitcnt lgkmcnt(7)
    v_mfma_f32_32x32x16_bf16 v[68:83], v[116:119], v[128:131], v[68:83]
    ds_read_b128 v[116:119], v19 offset:43008
    s_add_u32 m0, s49, 107520
    s_add_u32 s50, s46, 100224
    buffer_load_dwordx4 v17, s[16:19], s50 offen lds
    s_waitcnt lgkmcnt(7)
    v_mfma_f32_32x32x16_bf16 v[84:99], v[120:123], v[128:131], v[84:99]
    ds_read_b128 v[120:123], v19 offset:47104
    s_cmp_ge_u32 s29, 2
    s_cbranch_scc1 kfd_39
    s_add_u32 m0, s48, 104448
    s_add_u32 s50, s45, 1920
    buffer_load_dwordx4 v18, s[24:27], s50 offen lds
kfd_39:
    s_waitcnt vmcnt(8)
    s_barrier
    ds_read_b128 v[128:131], v24 offset:34816
    s_waitcnt lgkmcnt(4)
    v_mfma_f32_32x32x16_bf16 v[36:51], v[108:111], v[124:127], v[36:51]
    ds_read_b128 v[108:111], v20 offset:34816
    s_add_u32 m0, s47, 0
    s_add_u32 s50, s44, 2048
    buffer_load_dwordx4 v16, s[24:27], s50 offen lds
    s_waitcnt lgkmcnt(4)
    v_mfma_f32_32x32x16_bf16 v[52:67], v[112:115], v[124:127], v[52:67]
    ds_read_b128 v[112:115], v20 offset:38912
    s_waitcnt lgkmcnt(4)
    v_mfma_f32_32x32x16_bf16 v[68:83], v[116:119], v[124:127], v[68:83]
    ds_read_b128 v[116:119], v20 offset:43008
    s_add_u32 m0, s47, 1024
    s_add_u32 s50, s44, 34816
    buffer_load_dwordx4 v17, s[24:27], s50 offen lds
    s_waitcnt lgkmcnt(4)
    v_mfma_f32_32x32x16_bf16 v[84:99], v[120:123], v[124:127], v[84:99]
    ds_read_b128 v[120:123], v20 offset:47104
    s_waitcnt lgkmcnt(10)
    v_mfma_f32_16x16x32_bf16 v[100:103], v[132:135], v[136:139], v[100:103]
    v_mfma_f32_16x16x32_bf16 v[104:107], v[132:135], v[140:143], v[104:107]
    ds_read_b128 v[132:135], v28 offset:34816
    ds_read_b128 v[136:139], v30 offset:34816
    ds_read_b128 v[140:143], v30 offset:36864
    ds_read_b128 v[124:127], v25 offset:34816
    s_waitcnt lgkmcnt(7)
    v_mfma_f32_32x32x16_bf16 v[36:51], v[108:111], v[128:131], v[36:51]
    ds_read_b128 v[108:111], v21 offset:34816
    s_add_u32 m0, s47, 2048
    s_add_u32 s50, s44, 67584
    buffer_load_dwordx4 v16, s[24:27], s50 offen lds
    s_waitcnt lgkmcnt(7)
    v_mfma_f32_32x32x16_bf16 v[52:67], v[112:115], v[128:131], v[52:67]
    ds_read_b128 v[112:115], v21 offset:38912
    s_waitcnt lgkmcnt(7)
    v_mfma_f32_32x32x16_bf16 v[68:83], v[116:119], v[128:131], v[68:83]
    ds_read_b128 v[116:119], v21 offset:43008
    s_add_u32 m0, s47, 3072
    s_add_u32 s50, s44, 100352
    buffer_load_dwordx4 v17, s[24:27], s50 offen lds
    s_waitcnt lgkmcnt(7)
    v_mfma_f32_32x32x16_bf16 v[84:99], v[120:123], v[128:131], v[84:99]
    ds_read_b128 v[120:123], v21 offset:47104
    ds_read_b128 v[128:131], v26 offset:34816
    s_waitcnt lgkmcnt(4)
    v_mfma_f32_32x32x16_bf16 v[36:51], v[108:111], v[124:127], v[36:51]
    ds_read_b128 v[108:111], v22 offset:34816
    s_add_u32 m0, s49, 0
    s_add_u32 s50, s46, 2048
    buffer_load_dwordx4 v16, s[16:19], s50 offen lds
    s_waitcnt lgkmcnt(4)
    v_mfma_f32_32x32x16_bf16 v[52:67], v[112:115], v[124:127], v[52:67]
    ds_read_b128 v[112:115], v22 offset:38912
    s_waitcnt lgkmcnt(4)
    v_mfma_f32_32x32x16_bf16 v[68:83], v[116:119], v[124:127], v[68:83]
    ds_read_b128 v[116:119], v22 offset:43008
    s_add_u32 m0, s49, 1024
    s_add_u32 s50, s46, 34816
    buffer_load_dwordx4 v17, s[16:19], s50 offen lds
    s_waitcnt lgkmcnt(4)
    v_mfma_f32_32x32x16_bf16 v[84:99], v[120:123], v[124:127], v[84:99]
    ds_read_b128 v[120:123], v22 offset:47104
    s_waitcnt lgkmcnt(10)
    v_mfma_f32_16x16x32_bf16 v[100:103], v[132:135], v[136:139], v[100:103]
    v_mfma_f32_16x16x32_bf16 v[104:107], v[132:135], v[140:143], v[104:107]
    v_add_u32 v19, 69632, v19
    v_add_u32 v20, 69632, v20
    v_add_u32 v21, 69632, v21
    v_add_u32 v22, 69632, v22
    v_add_u32 v23, 69632, v23
    v_add_u32 v24, 69632, v24
    v_add_u32 v25, 69632, v25
    v_add_u32 v26, 69632, v26
    v_add_u32 v27, 69632, v27
    v_add_u32 v28, 69632, v28
    v_add_u32 v29, 69632, v29
    v_add_u32 v30, 69632, v30
    ds_read_b128 v[132:135], v27 offset:0
    ds_read_b128 v[136:139], v29 offset:0
    ds_read_b128 v[140:143], v29 offset:2048
    ds_read_b128 v[124:127], v23 offset:0
    s_waitcnt lgkmcnt(7)
    v_mfma_f32_32x32x16_bf16 v[36:51], v[108:111], v[128:131], v[36:51]
    ds_read_b128 v[108:111], v19 offset:0
    s_add_u32 m0, s49, 2048
    s_add_u32 s50, s46, 67584
    buffer_load_dwordx4 v16, s[16:19], s50 offen lds
    s_waitcnt lgkmcnt(7)
    v_mfma_f32_32x32x16_bf16 v[52:67], v[112:115], v[128:131], v[52:67]
    ds_read_b128 v[112:115], v19 offset:4096
    s_waitcnt lgkmcnt(7)
    v_mfma_f32_32x32x16_bf16 v[68:83], v[116:119], v[128:131], v[68:83]
    ds_read_b128 v[116:119], v19 offset:8192
    s_add_u32 m0, s49, 3072
    s_add_u32 s50, s46, 100352
    buffer_load_dwordx4 v17, s[16:19], s50 offen lds
    s_waitcnt lgkmcnt(7)
    v_mfma_f32_32x32x16_bf16 v[84:99], v[120:123], v[128:131], v[84:99]
    ds_read_b128 v[120:123], v19 offset:12288
    s_cmp_ge_u32 s29, 2
    s_cbranch_scc1 kfd_40
    s_add_u32 m0, s48, 0
    s_add_u32 s50, s45, 2048
    buffer_load_dwordx4 v18, s[24:27], s50 offen lds
kfd_40:
    s_waitcnt vmcnt(8)
    s_barrier
    ds_read_b128 v[128:131], v24 offset:0
    s_waitcnt lgkmcnt(4)
    v_mfma_f32_32x32x16_bf16 v[36:51], v[108:111], v[124:127], v[36:51]
    ds_read_b128 v[108:111], v20 offset:0
    s_add_u32 m0, s47, 34816
    s_add_u32 s50, s44, 2176
    buffer_load_dwordx4 v16, s[24:27], s50 offen lds
    s_waitcnt lgkmcnt(4)
    v_mfma_f32_32x32x16_bf16 v[52:67], v[112:115], v[124:127], v[52:67]
    ds_read_b128 v[112:115], v20 offset:4096
    s_waitcnt lgkmcnt(4)
    v_mfma_f32_32x32x16_bf16 v[68:83], v[116:119], v[124:127], v[68:83]
    ds_read_b128 v[116:119], v20 offset:8192
    s_add_u32 m0, s47, 35840
    s_add_u32 s50, s44, 34944
    buffer_load_dwordx4 v17, s[24:27], s50 offen lds
    s_waitcnt lgkmcnt(4)
    v_mfma_f32_32x32x16_bf16 v[84:99], v[120:123], v[124:127], v[84:99]
    ds_read_b128 v[120:123], v20 offset:12288
    s_waitcnt lgkmcnt(10)
    v_mfma_f32_16x16x32_bf16 v[100:103], v[132:135], v[136:139], v[100:103]
    v_mfma_f32_16x16x32_bf16 v[104:107], v[132:135], v[140:143], v[104:107]
    ds_read_b128 v[132:135], v28 offset:0
    ds_read_b128 v[136:139], v30 offset:0
    ds_read_b128 v[140:143], v30 offset:2048
    ds_read_b128 v[124:127], v25 offset:0
    s_waitcnt lgkmcnt(7)
    v_mfma_f32_32x32x16_bf16 v[36:51], v[108:111], v[128:131], v[36:51]
    ds_read_b128 v[108:111], v21 offset:0
    s_add_u32 m0, s47, 36864
    s_add_u32 s50, s44, 67712
    buffer_load_dwordx4 v16, s[24:27], s50 offen lds
    s_waitcnt lgkmcnt(7)
    v_mfma_f32_32x32x16_bf16 v[52:67], v[112:115], v[128:131], v[52:67]
    ds_read_b128 v[112:115], v21 offset:4096
    s_waitcnt lgkmcnt(7)
    v_mfma_f32_32x32x16_bf16 v[68:83], v[116:119], v[128:131], v[68:83]
    ds_read_b128 v[116:119], v21 offset:8192
    s_add_u32 m0, s47, 37888
    s_add_u32 s50, s44, 100480
    buffer_load_dwordx4 v17, s[24:27], s50 offen lds
    s_waitcnt lgkmcnt(7)
    v_mfma_f32_32x32x16_bf16 v[84:99], v[120:123], v[128:131], v[84:99]
    ds_read_b128 v[120:123], v21 offset:12288
    ds_read_b128 v[128:131], v26 offset:0
    s_waitcnt lgkmcnt(4)
    v_mfma_f32_32x32x16_bf16 v[36:51], v[108:111], v[124:127], v[36:51]
    ds_read_b128 v[108:111], v22 offset:0
    s_add_u32 m0, s49, 34816
    s_add_u32 s50, s46, 2176
    buffer_load_dwordx4 v16, s[16:19], s50 offen lds
    s_waitcnt lgkmcnt(4)
    v_mfma_f32_32x32x16_bf16 v[52:67], v[112:115], v[124:127], v[52:67]
    ds_read_b128 v[112:115], v22 offset:4096
    s_waitcnt lgkmcnt(4)
    v_mfma_f32_32x32x16_bf16 v[68:83], v[116:119], v[124:127], v[68:83]
    ds_read_b128 v[116:119], v22 offset:8192
    s_add_u32 m0, s49, 35840
    s_add_u32 s50, s46, 34944
    buffer_load_dwordx4 v17, s[16:19], s50 offen lds
    s_waitcnt lgkmcnt(4)
    v_mfma_f32_32x32x16_bf16 v[84:99], v[120:123], v[124:127], v[84:99]
    ds_read_b128 v[120:123], v22 offset:12288
    s_waitcnt lgkmcnt(10)
    v_mfma_f32_16x16x32_bf16 v[100:103], v[132:135], v[136:139], v[100:103]
    v_mfma_f32_16x16x32_bf16 v[104:107], v[132:135], v[140:143], v[104:107]
    ds_read_b128 v[132:135], v27 offset:34816
    ds_read_b128 v[136:139], v29 offset:34816
    ds_read_b128 v[140:143], v29 offset:36864
    ds_read_b128 v[124:127], v23 offset:34816
    s_waitcnt lgkmcnt(7)
    v_mfma_f32_32x32x16_bf16 v[36:51], v[108:111], v[128:131], v[36:51]
    ds_read_b128 v[108:111], v19 offset:34816
    s_add_u32 m0, s49, 36864
    s_add_u32 s50, s46, 67712
    buffer_load_dwordx4 v16, s[16:19], s50 offen lds
    s_waitcnt lgkmcnt(7)
    v_mfma_f32_32x32x16_bf16 v[52:67], v[112:115], v[128:131], v[52:67]
    ds_read_b128 v[112:115], v19 offset:38912
    s_waitcnt lgkmcnt(7)
    v_mfma_f32_32x32x16_bf16 v[68:83], v[116:119], v[128:131], v[68:83]
    ds_read_b128 v[116:119], v19 offset:43008
    s_add_u32 m0, s49, 37888
    s_add_u32 s50, s46, 100480
    buffer_load_dwordx4 v17, s[16:19], s50 offen lds
    s_waitcnt lgkmcnt(7)
    v_mfma_f32_32x32x16_bf16 v[84:99], v[120:123], v[128:131], v[84:99]
    ds_read_b128 v[120:123], v19 offset:47104
    s_cmp_ge_u32 s29, 2
    s_cbranch_scc1 kfd_41
    s_add_u32 m0, s48, 34816
    s_add_u32 s50, s45, 2176
    buffer_load_dwordx4 v18, s[24:27], s50 offen lds
kfd_41:
    s_waitcnt vmcnt(8)
    s_barrier
    ds_read_b128 v[128:131], v24 offset:34816
    s_waitcnt lgkmcnt(4)
    v_mfma_f32_32x32x16_bf16 v[36:51], v[108:111], v[124:127], v[36:51]
    ds_read_b128 v[108:111], v20 offset:34816
    s_add_u32 m0, s47, 69632
    s_add_u32 s50, s44, 2304
    buffer_load_dwordx4 v16, s[24:27], s50 offen lds
    s_waitcnt lgkmcnt(4)
    v_mfma_f32_32x32x16_bf16 v[52:67], v[112:115], v[124:127], v[52:67]
    ds_read_b128 v[112:115], v20 offset:38912
    s_waitcnt lgkmcnt(4)
    v_mfma_f32_32x32x16_bf16 v[68:83], v[116:119], v[124:127], v[68:83]
    ds_read_b128 v[116:119], v20 offset:43008
    s_add_u32 m0, s47, 70656
    s_add_u32 s50, s44, 35072
    buffer_load_dwordx4 v17, s[24:27], s50 offen lds
    s_waitcnt lgkmcnt(4)
    v_mfma_f32_32x32x16_bf16 v[84:99], v[120:123], v[124:127], v[84:99]
    ds_read_b128 v[120:123], v20 offset:47104
    s_waitcnt lgkmcnt(10)
    v_mfma_f32_16x16x32_bf16 v[100:103], v[132:135], v[136:139], v[100:103]
    v_mfma_f32_16x16x32_bf16 v[104:107], v[132:135], v[140:143], v[104:107]
    ds_read_b128 v[132:135], v28 offset:34816
    ds_read_b128 v[136:139], v30 offset:34816
    ds_read_b128 v[140:143], v30 offset:36864
    ds_read_b128 v[124:127], v25 offset:34816
    s_waitcnt lgkmcnt(7)
    v_mfma_f32_32x32x16_bf16 v[36:51], v[108:111], v[128:131], v[36:51]
    ds_read_b128 v[108:111], v21 offset:34816
    s_add_u32 m0, s47, 71680
    s_add_u32 s50, s44, 67840
    buffer_load_dwordx4 v16, s[24:27], s50 offen lds
    s_waitcnt lgkmcnt(7)
    v_mfma_f32_32x32x16_bf16 v[52:67], v[112:115], v[128:131], v[52:67]
    ds_read_b128 v[112:115], v21 offset:38912
    s_waitcnt lgkmcnt(7)
    v_mfma_f32_32x32x16_bf16 v[68:83], v[116:119], v[128:131], v[68:83]
    ds_read_b128 v[116:119], v21 offset:43008
    s_add_u32 m0, s47, 72704
    s_add_u32 s50, s44, 100608
    buffer_load_dwordx4 v17, s[24:27], s50 offen lds
    s_waitcnt lgkmcnt(7)
    v_mfma_f32_32x32x16_bf16 v[84:99], v[120:123], v[128:131], v[84:99]
    ds_read_b128 v[120:123], v21 offset:47104
    ds_read_b128 v[128:131], v26 offset:34816
    s_waitcnt lgkmcnt(4)
    v_mfma_f32_32x32x16_bf16 v[36:51], v[108:111], v[124:127], v[36:51]
    ds_read_b128 v[108:111], v22 offset:34816
    s_add_u32 m0, s49, 69632
    s_add_u32 s50, s46, 2304
    buffer_load_dwordx4 v16, s[16:19], s50 offen lds
    s_waitcnt lgkmcnt(4)
    v_mfma_f32_32x32x16_bf16 v[52:67], v[112:115], v[124:127], v[52:67]
    ds_read_b128 v[112:115], v22 offset:38912
    s_waitcnt lgkmcnt(4)
    v_mfma_f32_32x32x16_bf16 v[68:83], v[116:119], v[124:127], v[68:83]
    ds_read_b128 v[116:119], v22 offset:43008
    s_add_u32 m0, s49, 70656
    s_add_u32 s50, s46, 35072
    buffer_load_dwordx4 v17, s[16:19], s50 offen lds
    s_waitcnt lgkmcnt(4)
    v_mfma_f32_32x32x16_bf16 v[84:99], v[120:123], v[124:127], v[84:99]
    ds_read_b128 v[120:123], v22 offset:47104
    s_waitcnt lgkmcnt(10)
    v_mfma_f32_16x16x32_bf16 v[100:103], v[132:135], v[136:139], v[100:103]
    v_mfma_f32_16x16x32_bf16 v[104:107], v[132:135], v[140:143], v[104:107]
    v_add_u32 v19, 4294897664, v19
    v_add_u32 v20, 4294897664, v20
    v_add_u32 v21, 4294897664, v21
    v_add_u32 v22, 4294897664, v22
    v_add_u32 v23, 4294897664, v23
    v_add_u32 v24, 4294897664, v24
    v_add_u32 v25, 4294897664, v25
    v_add_u32 v26, 4294897664, v26
    v_add_u32 v27, 4294897664, v27
    v_add_u32 v28, 4294897664, v28
    v_add_u32 v29, 4294897664, v29
    v_add_u32 v30, 4294897664, v30
    ds_read_b128 v[132:135], v27 offset:0
    ds_read_b128 v[136:139], v29 offset:0
    ds_read_b128 v[140:143], v29 offset:2048
    ds_read_b128 v[124:127], v23 offset:0
    s_waitcnt lgkmcnt(7)
    v_mfma_f32_32x32x16_bf16 v[36:51], v[108:111], v[128:131], v[36:51]
    ds_read_b128 v[108:111], v19 offset:0
    s_add_u32 m0, s49, 71680
    s_add_u32 s50, s46, 67840
    buffer_load_dwordx4 v16, s[16:19], s50 offen lds
    s_waitcnt lgkmcnt(7)
    v_mfma_f32_32x32x16_bf16 v[52:67], v[112:115], v[128:131], v[52:67]
    ds_read_b128 v[112:115], v19 offset:4096
    s_waitcnt lgkmcnt(7)
    v_mfma_f32_32x32x16_bf16 v[68:83], v[116:119], v[128:131], v[68:83]
    ds_read_b128 v[116:119], v19 offset:8192
    s_add_u32 m0, s49, 72704
    s_add_u32 s50, s46, 100608
    buffer_load_dwordx4 v17, s[16:19], s50 offen lds
    s_waitcnt lgkmcnt(7)
    v_mfma_f32_32x32x16_bf16 v[84:99], v[120:123], v[128:131], v[84:99]
    ds_read_b128 v[120:123], v19 offset:12288
    s_cmp_ge_u32 s29, 2
    s_cbranch_scc1 kfd_42
    s_add_u32 m0, s48, 69632
    s_add_u32 s50, s45, 2304
    buffer_load_dwordx4 v18, s[24:27], s50 offen lds
kfd_42:
    s_waitcnt vmcnt(8)
    s_barrier
    ds_read_b128 v[128:131], v24 offset:0
    s_waitcnt lgkmcnt(4)
    v_mfma_f32_32x32x16_bf16 v[36:51], v[108:111], v[124:127], v[36:51]
    ds_read_b128 v[108:111], v20 offset:0
    s_add_u32 m0, s47, 104448
    s_add_u32 s50, s44, 2432
    buffer_load_dwordx4 v16, s[24:27], s50 offen lds
    s_waitcnt lgkmcnt(4)
    v_mfma_f32_32x32x16_bf16 v[52:67], v[112:115], v[124:127], v[52:67]
    ds_read_b128 v[112:115], v20 offset:4096
    s_waitcnt lgkmcnt(4)
    v_mfma_f32_32x32x16_bf16 v[68:83], v[116:119], v[124:127], v[68:83]
    ds_read_b128 v[116:119], v20 offset:8192
    s_add_u32 m0, s47, 105472
    s_add_u32 s50, s44, 35200
    buffer_load_dwordx4 v17, s[24:27], s50 offen lds
    s_waitcnt lgkmcnt(4)
    v_mfma_f32_32x32x16_bf16 v[84:99], v[120:123], v[124:127], v[84:99]
    ds_read_b128 v[120:123], v20 offset:12288
    s_waitcnt lgkmcnt(10)
    v_mfma_f32_16x16x32_bf16 v[100:103], v[132:135], v[136:139], v[100:103]
    v_mfma_f32_16x16x32_bf16 v[104:107], v[132:135], v[140:143], v[104:107]
    ds_read_b128 v[132:135], v28 offset:0
    ds_read_b128 v[136:139], v30 offset:0
    ds_read_b128 v[140:143], v30 offset:2048
    ds_read_b128 v[124:127], v25 offset:0
    s_waitcnt lgkmcnt(7)
    v_mfma_f32_32x32x16_bf16 v[36:51], v[108:111], v[128:131], v[36:51]
    ds_read_b128 v[108:111], v21 offset:0
    s_add_u32 m0, s47, 106496
    s_add_u32 s50, s44, 67968
    buffer_load_dwordx4 v16, s[24:27], s50 offen lds
    s_waitcnt lgkmcnt(7)
    v_mfma_f32_32x32x16_bf16 v[52:67], v[112:115], v[128:131], v[52:67]
    ds_read_b128 v[112:115], v21 offset:4096
    s_waitcnt lgkmcnt(7)
    v_mfma_f32_32x32x16_bf16 v[68:83], v[116:119], v[128:131], v[68:83]
    ds_read_b128 v[116:119], v21 offset:8192
    s_add_u32 m0, s47, 107520
    s_add_u32 s50, s44, 100736
    buffer_load_dwordx4 v17, s[24:27], s50 offen lds
    s_waitcnt lgkmcnt(7)
    v_mfma_f32_32x32x16_bf16 v[84:99], v[120:123], v[128:131], v[84:99]
    ds_read_b128 v[120:123], v21 offset:12288
    ds_read_b128 v[128:131], v26 offset:0
    s_waitcnt lgkmcnt(4)
    v_mfma_f32_32x32x16_bf16 v[36:51], v[108:111], v[124:127], v[36:51]
    ds_read_b128 v[108:111], v22 offset:0
    s_add_u32 m0, s49, 104448
    s_add_u32 s50, s46, 2432
    buffer_load_dwordx4 v16, s[16:19], s50 offen lds
    s_waitcnt lgkmcnt(4)
    v_mfma_f32_32x32x16_bf16 v[52:67], v[112:115], v[124:127], v[52:67]
    ds_read_b128 v[112:115], v22 offset:4096
    s_waitcnt lgkmcnt(4)
    v_mfma_f32_32x32x16_bf16 v[68:83], v[116:119], v[124:127], v[68:83]
    ds_read_b128 v[116:119], v22 offset:8192
    s_add_u32 m0, s49, 105472
    s_add_u32 s50, s46, 35200
    buffer_load_dwordx4 v17, s[16:19], s50 offen lds
    s_waitcnt lgkmcnt(4)
    v_mfma_f32_32x32x16_bf16 v[84:99], v[120:123], v[124:127], v[84:99]
    ds_read_b128 v[120:123], v22 offset:12288
    s_waitcnt lgkmcnt(10)
    v_mfma_f32_16x16x32_bf16 v[100:103], v[132:135], v[136:139], v[100:103]
    v_mfma_f32_16x16x32_bf16 v[104:107], v[132:135], v[140:143], v[104:107]
    ds_read_b128 v[132:135], v27 offset:34816
    ds_read_b128 v[136:139], v29 offset:34816
    ds_read_b128 v[140:143], v29 offset:36864
    ds_read_b128 v[124:127], v23 offset:34816
    s_waitcnt lgkmcnt(7)
    v_mfma_f32_32x32x16_bf16 v[36:51], v[108:111], v[128:131], v[36:51]
    ds_read_b128 v[108:111], v19 offset:34816
    s_add_u32 m0, s49, 106496
    s_add_u32 s50, s46, 67968
    buffer_load_dwordx4 v16, s[16:19], s50 offen lds
    s_waitcnt lgkmcnt(7)
    v_mfma_f32_32x32x16_bf16 v[52:67], v[112:115], v[128:131], v[52:67]
    ds_read_b128 v[112:115], v19 offset:38912
    s_waitcnt lgkmcnt(7)
    v_mfma_f32_32x32x16_bf16 v[68:83], v[116:119], v[128:131], v[68:83]
    ds_read_b128 v[116:119], v19 offset:43008
    s_add_u32 m0, s49, 107520
    s_add_u32 s50, s46, 100736
    buffer_load_dwordx4 v17, s[16:19], s50 offen lds
    s_waitcnt lgkmcnt(7)
    v_mfma_f32_32x32x16_bf16 v[84:99], v[120:123], v[128:131], v[84:99]
    ds_read_b128 v[120:123], v19 offset:47104
    s_cmp_ge_u32 s29, 2
    s_cbranch_scc1 kfd_43
    s_add_u32 m0, s48, 104448
    s_add_u32 s50, s45, 2432
    buffer_load_dwordx4 v18, s[24:27], s50 offen lds
kfd_43:
    s_waitcnt vmcnt(8)
    s_barrier
    ds_read_b128 v[128:131], v24 offset:34816
    s_waitcnt lgkmcnt(4)
    v_mfma_f32_32x32x16_bf16 v[36:51], v[108:111], v[124:127], v[36:51]
    ds_read_b128 v[108:111], v20 offset:34816
    s_add_u32 m0, s47, 0
    s_add_u32 s50, s44, 2560
    buffer_load_dwordx4 v16, s[24:27], s50 offen lds
    s_waitcnt lgkmcnt(4)
    v_mfma_f32_32x32x16_bf16 v[52:67], v[112:115], v[124:127], v[52:67]
    ds_read_b128 v[112:115], v20 offset:38912
    s_waitcnt lgkmcnt(4)
    v_mfma_f32_32x32x16_bf16 v[68:83], v[116:119], v[124:127], v[68:83]
    ds_read_b128 v[116:119], v20 offset:43008
    s_add_u32 m0, s47, 1024
    s_add_u32 s50, s44, 35328
    buffer_load_dwordx4 v17, s[24:27], s50 offen lds
    s_waitcnt lgkmcnt(4)
    v_mfma_f32_32x32x16_bf16 v[84:99], v[120:123], v[124:127], v[84:99]
    ds_read_b128 v[120:123], v20 offset:47104
    s_waitcnt lgkmcnt(10)
    v_mfma_f32_16x16x32_bf16 v[100:103], v[132:135], v[136:139], v[100:103]
    v_mfma_f32_16x16x32_bf16 v[104:107], v[132:135], v[140:143], v[104:107]
    ds_read_b128 v[132:135], v28 offset:34816
    ds_read_b128 v[136:139], v30 offset:34816
    ds_read_b128 v[140:143], v30 offset:36864
    ds_read_b128 v[124:127], v25 offset:34816
    s_waitcnt lgkmcnt(7)
    v_mfma_f32_32x32x16_bf16 v[36:51], v[108:111], v[128:131], v[36:51]
    ds_read_b128 v[108:111], v21 offset:34816
    s_add_u32 m0, s47, 2048
    s_add_u32 s50, s44, 68096
    buffer_load_dwordx4 v16, s[24:27], s50 offen lds
    s_waitcnt lgkmcnt(7)
    v_mfma_f32_32x32x16_bf16 v[52:67], v[112:115], v[128:131], v[52:67]
    ds_read_b128 v[112:115], v21 offset:38912
    s_waitcnt lgkmcnt(7)
    v_mfma_f32_32x32x16_bf16 v[68:83], v[116:119], v[128:131], v[68:83]
    ds_read_b128 v[116:119], v21 offset:43008
    s_add_u32 m0, s47, 3072
    s_add_u32 s50, s44, 100864
    buffer_load_dwordx4 v17, s[24:27], s50 offen lds
    s_waitcnt lgkmcnt(7)
    v_mfma_f32_32x32x16_bf16 v[84:99], v[120:123], v[128:131], v[84:99]
    ds_read_b128 v[120:123], v21 offset:47104
    ds_read_b128 v[128:131], v26 offset:34816
    s_waitcnt lgkmcnt(4)
    v_mfma_f32_32x32x16_bf16 v[36:51], v[108:111], v[124:127], v[36:51]
    ds_read_b128 v[108:111], v22 offset:34816
    s_add_u32 m0, s49, 0
    s_add_u32 s50, s46, 2560
    buffer_load_dwordx4 v16, s[16:19], s50 offen lds
    s_waitcnt lgkmcnt(4)
    v_mfma_f32_32x32x16_bf16 v[52:67], v[112:115], v[124:127], v[52:67]
    ds_read_b128 v[112:115], v22 offset:38912
    s_waitcnt lgkmcnt(4)
    v_mfma_f32_32x32x16_bf16 v[68:83], v[116:119], v[124:127], v[68:83]
    ds_read_b128 v[116:119], v22 offset:43008
    s_add_u32 m0, s49, 1024
    s_add_u32 s50, s46, 35328
    buffer_load_dwordx4 v17, s[16:19], s50 offen lds
    s_waitcnt lgkmcnt(4)
    v_mfma_f32_32x32x16_bf16 v[84:99], v[120:123], v[124:127], v[84:99]
    ds_read_b128 v[120:123], v22 offset:47104
    s_waitcnt lgkmcnt(10)
    v_mfma_f32_16x16x32_bf16 v[100:103], v[132:135], v[136:139], v[100:103]
    v_mfma_f32_16x16x32_bf16 v[104:107], v[132:135], v[140:143], v[104:107]
    v_add_u32 v19, 69632, v19
    v_add_u32 v20, 69632, v20
    v_add_u32 v21, 69632, v21
    v_add_u32 v22, 69632, v22
    v_add_u32 v23, 69632, v23
    v_add_u32 v24, 69632, v24
    v_add_u32 v25, 69632, v25
    v_add_u32 v26, 69632, v26
    v_add_u32 v27, 69632, v27
    v_add_u32 v28, 69632, v28
    v_add_u32 v29, 69632, v29
    v_add_u32 v30, 69632, v30
    ds_read_b128 v[132:135], v27 offset:0
    ds_read_b128 v[136:139], v29 offset:0
    ds_read_b128 v[140:143], v29 offset:2048
    ds_read_b128 v[124:127], v23 offset:0
    s_waitcnt lgkmcnt(7)
    v_mfma_f32_32x32x16_bf16 v[36:51], v[108:111], v[128:131], v[36:51]
    ds_read_b128 v[108:111], v19 offset:0
    s_add_u32 m0, s49, 2048
    s_add_u32 s50, s46, 68096
    buffer_load_dwordx4 v16, s[16:19], s50 offen lds
    s_waitcnt lgkmcnt(7)
    v_mfma_f32_32x32x16_bf16 v[52:67], v[112:115], v[128:131], v[52:67]
    ds_read_b128 v[112:115], v19 offset:4096
    s_waitcnt lgkmcnt(7)
    v_mfma_f32_32x32x16_bf16 v[68:83], v[116:119], v[128:131], v[68:83]
    ds_read_b128 v[116:119], v19 offset:8192
    s_add_u32 m0, s49, 3072
    s_add_u32 s50, s46, 100864
    buffer_load_dwordx4 v17, s[16:19], s50 offen lds
    s_waitcnt lgkmcnt(7)
    v_mfma_f32_32x32x16_bf16 v[84:99], v[120:123], v[128:131], v[84:99]
    ds_read_b128 v[120:123], v19 offset:12288
    s_cmp_ge_u32 s29, 2
    s_cbranch_scc1 kfd_44
    s_add_u32 m0, s48, 0
    s_add_u32 s50, s45, 2560
    buffer_load_dwordx4 v18, s[24:27], s50 offen lds
kfd_44:
    s_waitcnt vmcnt(8)
    s_barrier
    ds_read_b128 v[128:131], v24 offset:0
    s_waitcnt lgkmcnt(4)
    v_mfma_f32_32x32x16_bf16 v[36:51], v[108:111], v[124:127], v[36:51]
    ds_read_b128 v[108:111], v20 offset:0
    s_add_u32 m0, s47, 34816
    s_add_u32 s50, s44, 2688
    buffer_load_dwordx4 v16, s[24:27], s50 offen lds
    s_waitcnt lgkmcnt(4)
    v_mfma_f32_32x32x16_bf16 v[52:67], v[112:115], v[124:127], v[52:67]
    ds_read_b128 v[112:115], v20 offset:4096
    s_waitcnt lgkmcnt(4)
    v_mfma_f32_32x32x16_bf16 v[68:83], v[116:119], v[124:127], v[68:83]
    ds_read_b128 v[116:119], v20 offset:8192
    s_add_u32 m0, s47, 35840
    s_add_u32 s50, s44, 35456
    buffer_load_dwordx4 v17, s[24:27], s50 offen lds
    s_waitcnt lgkmcnt(4)
    v_mfma_f32_32x32x16_bf16 v[84:99], v[120:123], v[124:127], v[84:99]
    ds_read_b128 v[120:123], v20 offset:12288
    s_waitcnt lgkmcnt(10)
    v_mfma_f32_16x16x32_bf16 v[100:103], v[132:135], v[136:139], v[100:103]
    v_mfma_f32_16x16x32_bf16 v[104:107], v[132:135], v[140:143], v[104:107]
    ds_read_b128 v[132:135], v28 offset:0
    ds_read_b128 v[136:139], v30 offset:0
    ds_read_b128 v[140:143], v30 offset:2048
    ds_read_b128 v[124:127], v25 offset:0
    s_waitcnt lgkmcnt(7)
    v_mfma_f32_32x32x16_bf16 v[36:51], v[108:111], v[128:131], v[36:51]
    ds_read_b128 v[108:111], v21 offset:0
    s_add_u32 m0, s47, 36864
    s_add_u32 s50, s44, 68224
    buffer_load_dwordx4 v16, s[24:27], s50 offen lds
    s_waitcnt lgkmcnt(7)
    v_mfma_f32_32x32x16_bf16 v[52:67], v[112:115], v[128:131], v[52:67]
    ds_read_b128 v[112:115], v21 offset:4096
    s_waitcnt lgkmcnt(7)
    v_mfma_f32_32x32x16_bf16 v[68:83], v[116:119], v[128:131], v[68:83]
    ds_read_b128 v[116:119], v21 offset:8192
    s_add_u32 m0, s47, 37888
    s_add_u32 s50, s44, 100992
    buffer_load_dwordx4 v17, s[24:27], s50 offen lds
    s_waitcnt lgkmcnt(7)
    v_mfma_f32_32x32x16_bf16 v[84:99], v[120:123], v[128:131], v[84:99]
    ds_read_b128 v[120:123], v21 offset:12288
    ds_read_b128 v[128:131], v26 offset:0
    s_waitcnt lgkmcnt(4)
    v_mfma_f32_32x32x16_bf16 v[36:51], v[108:111], v[124:127], v[36:51]
    ds_read_b128 v[108:111], v22 offset:0
    s_add_u32 m0, s49, 34816
    s_add_u32 s50, s46, 2688
    buffer_load_dwordx4 v16, s[16:19], s50 offen lds
    s_waitcnt lgkmcnt(4)
    v_mfma_f32_32x32x16_bf16 v[52:67], v[112:115], v[124:127], v[52:67]
    ds_read_b128 v[112:115], v22 offset:4096
    s_waitcnt lgkmcnt(4)
    v_mfma_f32_32x32x16_bf16 v[68:83], v[116:119], v[124:127], v[68:83]
    ds_read_b128 v[116:119], v22 offset:8192
    s_add_u32 m0, s49, 35840
    s_add_u32 s50, s46, 35456
    buffer_load_dwordx4 v17, s[16:19], s50 offen lds
    s_waitcnt lgkmcnt(4)
    v_mfma_f32_32x32x16_bf16 v[84:99], v[120:123], v[124:127], v[84:99]
    ds_read_b128 v[120:123], v22 offset:12288
    s_waitcnt lgkmcnt(10)
    v_mfma_f32_16x16x32_bf16 v[100:103], v[132:135], v[136:139], v[100:103]
    v_mfma_f32_16x16x32_bf16 v[104:107], v[132:135], v[140:143], v[104:107]
    ds_read_b128 v[132:135], v27 offset:34816
    ds_read_b128 v[136:139], v29 offset:34816
    ds_read_b128 v[140:143], v29 offset:36864
    ds_read_b128 v[124:127], v23 offset:34816
    s_waitcnt lgkmcnt(7)
    v_mfma_f32_32x32x16_bf16 v[36:51], v[108:111], v[128:131], v[36:51]
    ds_read_b128 v[108:111], v19 offset:34816
    s_add_u32 m0, s49, 36864
    s_add_u32 s50, s46, 68224
    buffer_load_dwordx4 v16, s[16:19], s50 offen lds
    s_waitcnt lgkmcnt(7)
    v_mfma_f32_32x32x16_bf16 v[52:67], v[112:115], v[128:131], v[52:67]
    ds_read_b128 v[112:115], v19 offset:38912
    s_waitcnt lgkmcnt(7)
    v_mfma_f32_32x32x16_bf16 v[68:83], v[116:119], v[128:131], v[68:83]
    ds_read_b128 v[116:119], v19 offset:43008
    s_add_u32 m0, s49, 37888
    s_add_u32 s50, s46, 100992
    buffer_load_dwordx4 v17, s[16:19], s50 offen lds
    s_waitcnt lgkmcnt(7)
    v_mfma_f32_32x32x16_bf16 v[84:99], v[120:123], v[128:131], v[84:99]
    ds_read_b128 v[120:123], v19 offset:47104
    s_cmp_ge_u32 s29, 2
    s_cbranch_scc1 kfd_45
    s_add_u32 m0, s48, 34816
    s_add_u32 s50, s45, 2688
    buffer_load_dwordx4 v18, s[24:27], s50 offen lds
kfd_45:
    s_waitcnt vmcnt(8)
    s_barrier
    ds_read_b128 v[128:131], v24 offset:34816
    s_waitcnt lgkmcnt(4)
    v_mfma_f32_32x32x16_bf16 v[36:51], v[108:111], v[124:127], v[36:51]
    ds_read_b128 v[108:111], v20 offset:34816
    s_add_u32 m0, s47, 69632
    s_add_u32 s50, s44, 2816
    buffer_load_dwordx4 v16, s[24:27], s50 offen lds
    s_waitcnt lgkmcnt(4)
    v_mfma_f32_32x32x16_bf16 v[52:67], v[112:115], v[124:127], v[52:67]
    ds_read_b128 v[112:115], v20 offset:38912
    s_waitcnt lgkmcnt(4)
    v_mfma_f32_32x32x16_bf16 v[68:83], v[116:119], v[124:127], v[68:83]
    ds_read_b128 v[116:119], v20 offset:43008
    s_add_u32 m0, s47, 70656
    s_add_u32 s50, s44, 35584
    buffer_load_dwordx4 v17, s[24:27], s50 offen lds
    s_waitcnt lgkmcnt(4)
    v_mfma_f32_32x32x16_bf16 v[84:99], v[120:123], v[124:127], v[84:99]
    ds_read_b128 v[120:123], v20 offset:47104
    s_waitcnt lgkmcnt(10)
    v_mfma_f32_16x16x32_bf16 v[100:103], v[132:135], v[136:139], v[100:103]
    v_mfma_f32_16x16x32_bf16 v[104:107], v[132:135], v[140:143], v[104:107]
    ds_read_b128 v[132:135], v28 offset:34816
    ds_read_b128 v[136:139], v30 offset:34816
    ds_read_b128 v[140:143], v30 offset:36864
    ds_read_b128 v[124:127], v25 offset:34816
    s_waitcnt lgkmcnt(7)
    v_mfma_f32_32x32x16_bf16 v[36:51], v[108:111], v[128:131], v[36:51]
    ds_read_b128 v[108:111], v21 offset:34816
    s_add_u32 m0, s47, 71680
    s_add_u32 s50, s44, 68352
    buffer_load_dwordx4 v16, s[24:27], s50 offen lds
    s_waitcnt lgkmcnt(7)
    v_mfma_f32_32x32x16_bf16 v[52:67], v[112:115], v[128:131], v[52:67]
    ds_read_b128 v[112:115], v21 offset:38912
    s_waitcnt lgkmcnt(7)
    v_mfma_f32_32x32x16_bf16 v[68:83], v[116:119], v[128:131], v[68:83]
    ds_read_b128 v[116:119], v21 offset:43008
    s_add_u32 m0, s47, 72704
    s_add_u32 s50, s44, 101120
    buffer_load_dwordx4 v17, s[24:27], s50 offen lds
    s_waitcnt lgkmcnt(7)
    v_mfma_f32_32x32x16_bf16 v[84:99], v[120:123], v[128:131], v[84:99]
    ds_read_b128 v[120:123], v21 offset:47104
    ds_read_b128 v[128:131], v26 offset:34816
    s_waitcnt lgkmcnt(4)
    v_mfma_f32_32x32x16_bf16 v[36:51], v[108:111], v[124:127], v[36:51]
    ds_read_b128 v[108:111], v22 offset:34816
    s_add_u32 m0, s49, 69632
    s_add_u32 s50, s46, 2816
    buffer_load_dwordx4 v16, s[16:19], s50 offen lds
    s_waitcnt lgkmcnt(4)
    v_mfma_f32_32x32x16_bf16 v[52:67], v[112:115], v[124:127], v[52:67]
    ds_read_b128 v[112:115], v22 offset:38912
    s_waitcnt lgkmcnt(4)
    v_mfma_f32_32x32x16_bf16 v[68:83], v[116:119], v[124:127], v[68:83]
    ds_read_b128 v[116:119], v22 offset:43008
    s_add_u32 m0, s49, 70656
    s_add_u32 s50, s46, 35584
    buffer_load_dwordx4 v17, s[16:19], s50 offen lds
    s_waitcnt lgkmcnt(4)
    v_mfma_f32_32x32x16_bf16 v[84:99], v[120:123], v[124:127], v[84:99]
    ds_read_b128 v[120:123], v22 offset:47104
    s_waitcnt lgkmcnt(10)
    v_mfma_f32_16x16x32_bf16 v[100:103], v[132:135], v[136:139], v[100:103]
    v_mfma_f32_16x16x32_bf16 v[104:107], v[132:135], v[140:143], v[104:107]
    v_add_u32 v19, 4294897664, v19
    v_add_u32 v20, 4294897664, v20
    v_add_u32 v21, 4294897664, v21
    v_add_u32 v22, 4294897664, v22
    v_add_u32 v23, 4294897664, v23
    v_add_u32 v24, 4294897664, v24
    v_add_u32 v25, 4294897664, v25
    v_add_u32 v26, 4294897664, v26
    v_add_u32 v27, 4294897664, v27
    v_add_u32 v28, 4294897664, v28
    v_add_u32 v29, 4294897664, v29
    v_add_u32 v30, 4294897664, v30
    ds_read_b128 v[132:135], v27 offset:0
    ds_read_b128 v[136:139], v29 offset:0
    ds_read_b128 v[140:143], v29 offset:2048
    ds_read_b128 v[124:127], v23 offset:0
    s_waitcnt lgkmcnt(7)
    v_mfma_f32_32x32x16_bf16 v[36:51], v[108:111], v[128:131], v[36:51]
    ds_read_b128 v[108:111], v19 offset:0
    s_add_u32 m0, s49, 71680
    s_add_u32 s50, s46, 68352
    buffer_load_dwordx4 v16, s[16:19], s50 offen lds
    s_waitcnt lgkmcnt(7)
    v_mfma_f32_32x32x16_bf16 v[52:67], v[112:115], v[128:131], v[52:67]
    ds_read_b128 v[112:115], v19 offset:4096
    s_waitcnt lgkmcnt(7)
    v_mfma_f32_32x32x16_bf16 v[68:83], v[116:119], v[128:131], v[68:83]
    ds_read_b128 v[116:119], v19 offset:8192
    s_add_u32 m0, s49, 72704
    s_add_u32 s50, s46, 101120
    buffer_load_dwordx4 v17, s[16:19], s50 offen lds
    s_waitcnt lgkmcnt(7)
    v_mfma_f32_32x32x16_bf16 v[84:99], v[120:123], v[128:131], v[84:99]
    ds_read_b128 v[120:123], v19 offset:12288
    s_cmp_ge_u32 s29, 2
    s_cbranch_scc1 kfd_46
    s_add_u32 m0, s48, 69632
    s_add_u32 s50, s45, 2816
    buffer_load_dwordx4 v18, s[24:27], s50 offen lds
kfd_46:
    s_waitcnt vmcnt(8)
    s_barrier
    ds_read_b128 v[128:131], v24 offset:0
    s_waitcnt lgkmcnt(4)
    v_mfma_f32_32x32x16_bf16 v[36:51], v[108:111], v[124:127], v[36:51]
    ds_read_b128 v[108:111], v20 offset:0
    s_add_u32 m0, s47, 104448
    s_add_u32 s50, s44, 2944
    buffer_load_dwordx4 v16, s[24:27], s50 offen lds
    s_waitcnt lgkmcnt(4)
    v_mfma_f32_32x32x16_bf16 v[52:67], v[112:115], v[124:127], v[52:67]
    ds_read_b128 v[112:115], v20 offset:4096
    s_waitcnt lgkmcnt(4)
    v_mfma_f32_32x32x16_bf16 v[68:83], v[116:119], v[124:127], v[68:83]
    ds_read_b128 v[116:119], v20 offset:8192
    s_add_u32 m0, s47, 105472
    s_add_u32 s50, s44, 35712
    buffer_load_dwordx4 v17, s[24:27], s50 offen lds
    s_waitcnt lgkmcnt(4)
    v_mfma_f32_32x32x16_bf16 v[84:99], v[120:123], v[124:127], v[84:99]
    ds_read_b128 v[120:123], v20 offset:12288
    s_waitcnt lgkmcnt(10)
    v_mfma_f32_16x16x32_bf16 v[100:103], v[132:135], v[136:139], v[100:103]
    v_mfma_f32_16x16x32_bf16 v[104:107], v[132:135], v[140:143], v[104:107]
    ds_read_b128 v[132:135], v28 offset:0
    ds_read_b128 v[136:139], v30 offset:0
    ds_read_b128 v[140:143], v30 offset:2048
    ds_read_b128 v[124:127], v25 offset:0
    s_waitcnt lgkmcnt(7)
    v_mfma_f32_32x32x16_bf16 v[36:51], v[108:111], v[128:131], v[36:51]
    ds_read_b128 v[108:111], v21 offset:0
    s_add_u32 m0, s47, 106496
    s_add_u32 s50, s44, 68480
    buffer_load_dwordx4 v16, s[24:27], s50 offen lds
    s_waitcnt lgkmcnt(7)
    v_mfma_f32_32x32x16_bf16 v[52:67], v[112:115], v[128:131], v[52:67]
    ds_read_b128 v[112:115], v21 offset:4096
    s_waitcnt lgkmcnt(7)
    v_mfma_f32_32x32x16_bf16 v[68:83], v[116:119], v[128:131], v[68:83]
    ds_read_b128 v[116:119], v21 offset:8192
    s_add_u32 m0, s47, 107520
    s_add_u32 s50, s44, 101248
    buffer_load_dwordx4 v17, s[24:27], s50 offen lds
    s_waitcnt lgkmcnt(7)
    v_mfma_f32_32x32x16_bf16 v[84:99], v[120:123], v[128:131], v[84:99]
    ds_read_b128 v[120:123], v21 offset:12288
    ds_read_b128 v[128:131], v26 offset:0
    s_waitcnt lgkmcnt(4)
    v_mfma_f32_32x32x16_bf16 v[36:51], v[108:111], v[124:127], v[36:51]
    ds_read_b128 v[108:111], v22 offset:0
    s_add_u32 m0, s49, 104448
    s_add_u32 s50, s46, 2944
    buffer_load_dwordx4 v16, s[16:19], s50 offen lds
    s_waitcnt lgkmcnt(4)
    v_mfma_f32_32x32x16_bf16 v[52:67], v[112:115], v[124:127], v[52:67]
    ds_read_b128 v[112:115], v22 offset:4096
    s_waitcnt lgkmcnt(4)
    v_mfma_f32_32x32x16_bf16 v[68:83], v[116:119], v[124:127], v[68:83]
    ds_read_b128 v[116:119], v22 offset:8192
    s_add_u32 m0, s49, 105472
    s_add_u32 s50, s46, 35712
    buffer_load_dwordx4 v17, s[16:19], s50 offen lds
    s_waitcnt lgkmcnt(4)
    v_mfma_f32_32x32x16_bf16 v[84:99], v[120:123], v[124:127], v[84:99]
    ds_read_b128 v[120:123], v22 offset:12288
    s_waitcnt lgkmcnt(10)
    v_mfma_f32_16x16x32_bf16 v[100:103], v[132:135], v[136:139], v[100:103]
    v_mfma_f32_16x16x32_bf16 v[104:107], v[132:135], v[140:143], v[104:107]
    ds_read_b128 v[132:135], v27 offset:34816
    ds_read_b128 v[136:139], v29 offset:34816
    ds_read_b128 v[140:143], v29 offset:36864
    ds_read_b128 v[124:127], v23 offset:34816
    s_waitcnt lgkmcnt(7)
    v_mfma_f32_32x32x16_bf16 v[36:51], v[108:111], v[128:131], v[36:51]
    ds_read_b128 v[108:111], v19 offset:34816
    s_add_u32 m0, s49, 106496
    s_add_u32 s50, s46, 68480
    buffer_load_dwordx4 v16, s[16:19], s50 offen lds
    s_waitcnt lgkmcnt(7)
    v_mfma_f32_32x32x16_bf16 v[52:67], v[112:115], v[128:131], v[52:67]
    ds_read_b128 v[112:115], v19 offset:38912
    s_waitcnt lgkmcnt(7)
    v_mfma_f32_32x32x16_bf16 v[68:83], v[116:119], v[128:131], v[68:83]
    ds_read_b128 v[116:119], v19 offset:43008
    s_add_u32 m0, s49, 107520
    s_add_u32 s50, s46, 101248
    buffer_load_dwordx4 v17, s[16:19], s50 offen lds
    s_waitcnt lgkmcnt(7)
    v_mfma_f32_32x32x16_bf16 v[84:99], v[120:123], v[128:131], v[84:99]
    ds_read_b128 v[120:123], v19 offset:47104
    s_cmp_ge_u32 s29, 2
    s_cbranch_scc1 kfd_47
    s_add_u32 m0, s48, 104448
    s_add_u32 s50, s45, 2944
    buffer_load_dwordx4 v18, s[24:27], s50 offen lds
kfd_47:
    s_waitcnt vmcnt(8)
    s_barrier
    ds_read_b128 v[128:131], v24 offset:34816
    s_waitcnt lgkmcnt(4)
    v_mfma_f32_32x32x16_bf16 v[36:51], v[108:111], v[124:127], v[36:51]
    ds_read_b128 v[108:111], v20 offset:34816
    s_add_u32 m0, s47, 0
    s_add_u32 s50, s44, 3072
    buffer_load_dwordx4 v16, s[24:27], s50 offen lds
    s_waitcnt lgkmcnt(4)
    v_mfma_f32_32x32x16_bf16 v[52:67], v[112:115], v[124:127], v[52:67]
    ds_read_b128 v[112:115], v20 offset:38912
    s_waitcnt lgkmcnt(4)
    v_mfma_f32_32x32x16_bf16 v[68:83], v[116:119], v[124:127], v[68:83]
    ds_read_b128 v[116:119], v20 offset:43008
    s_add_u32 m0, s47, 1024
    s_add_u32 s50, s44, 35840
    buffer_load_dwordx4 v17, s[24:27], s50 offen lds
    s_waitcnt lgkmcnt(4)
    v_mfma_f32_32x32x16_bf16 v[84:99], v[120:123], v[124:127], v[84:99]
    ds_read_b128 v[120:123], v20 offset:47104
    s_waitcnt lgkmcnt(10)
    v_mfma_f32_16x16x32_bf16 v[100:103], v[132:135], v[136:139], v[100:103]
    v_mfma_f32_16x16x32_bf16 v[104:107], v[132:135], v[140:143], v[104:107]
    ds_read_b128 v[132:135], v28 offset:34816
    ds_read_b128 v[136:139], v30 offset:34816
    ds_read_b128 v[140:143], v30 offset:36864
    ds_read_b128 v[124:127], v25 offset:34816
    s_waitcnt lgkmcnt(7)
    v_mfma_f32_32x32x16_bf16 v[36:51], v[108:111], v[128:131], v[36:51]
    ds_read_b128 v[108:111], v21 offset:34816
    s_add_u32 m0, s47, 2048
    s_add_u32 s50, s44, 68608
    buffer_load_dwordx4 v16, s[24:27], s50 offen lds
    s_waitcnt lgkmcnt(7)
    v_mfma_f32_32x32x16_bf16 v[52:67], v[112:115], v[128:131], v[52:67]
    ds_read_b128 v[112:115], v21 offset:38912
    s_waitcnt lgkmcnt(7)
    v_mfma_f32_32x32x16_bf16 v[68:83], v[116:119], v[128:131], v[68:83]
    ds_read_b128 v[116:119], v21 offset:43008
    s_add_u32 m0, s47, 3072
    s_add_u32 s50, s44, 101376
    buffer_load_dwordx4 v17, s[24:27], s50 offen lds
    s_waitcnt lgkmcnt(7)
    v_mfma_f32_32x32x16_bf16 v[84:99], v[120:123], v[128:131], v[84:99]
    ds_read_b128 v[120:123], v21 offset:47104
    ds_read_b128 v[128:131], v26 offset:34816
    s_waitcnt lgkmcnt(4)
    v_mfma_f32_32x32x16_bf16 v[36:51], v[108:111], v[124:127], v[36:51]
    ds_read_b128 v[108:111], v22 offset:34816
    s_add_u32 m0, s49, 0
    s_add_u32 s50, s46, 3072
    buffer_load_dwordx4 v16, s[16:19], s50 offen lds
    s_waitcnt lgkmcnt(4)
    v_mfma_f32_32x32x16_bf16 v[52:67], v[112:115], v[124:127], v[52:67]
    ds_read_b128 v[112:115], v22 offset:38912
    s_waitcnt lgkmcnt(4)
    v_mfma_f32_32x32x16_bf16 v[68:83], v[116:119], v[124:127], v[68:83]
    ds_read_b128 v[116:119], v22 offset:43008
    s_add_u32 m0, s49, 1024
    s_add_u32 s50, s46, 35840
    buffer_load_dwordx4 v17, s[16:19], s50 offen lds
    s_waitcnt lgkmcnt(4)
    v_mfma_f32_32x32x16_bf16 v[84:99], v[120:123], v[124:127], v[84:99]
    ds_read_b128 v[120:123], v22 offset:47104
    s_waitcnt lgkmcnt(10)
    v_mfma_f32_16x16x32_bf16 v[100:103], v[132:135], v[136:139], v[100:103]
    v_mfma_f32_16x16x32_bf16 v[104:107], v[132:135], v[140:143], v[104:107]
    v_add_u32 v19, 69632, v19
    v_add_u32 v20, 69632, v20
    v_add_u32 v21, 69632, v21
    v_add_u32 v22, 69632, v22
    v_add_u32 v23, 69632, v23
    v_add_u32 v24, 69632, v24
    v_add_u32 v25, 69632, v25
    v_add_u32 v26, 69632, v26
    v_add_u32 v27, 69632, v27
    v_add_u32 v28, 69632, v28
    v_add_u32 v29, 69632, v29
    v_add_u32 v30, 69632, v30
    ds_read_b128 v[132:135], v27 offset:0
    ds_read_b128 v[136:139], v29 offset:0
    ds_read_b128 v[140:143], v29 offset:2048
    ds_read_b128 v[124:127], v23 offset:0
    s_waitcnt lgkmcnt(7)
    v_mfma_f32_32x32x16_bf16 v[36:51], v[108:111], v[128:131], v[36:51]
    ds_read_b128 v[108:111], v19 offset:0
    s_add_u32 m0, s49, 2048
    s_add_u32 s50, s46, 68608
    buffer_load_dwordx4 v16, s[16:19], s50 offen lds
    s_waitcnt lgkmcnt(7)
    v_mfma_f32_32x32x16_bf16 v[52:67], v[112:115], v[128:131], v[52:67]
    ds_read_b128 v[112:115], v19 offset:4096
    s_waitcnt lgkmcnt(7)
    v_mfma_f32_32x32x16_bf16 v[68:83], v[116:119], v[128:131], v[68:83]
    ds_read_b128 v[116:119], v19 offset:8192
    s_add_u32 m0, s49, 3072
    s_add_u32 s50, s46, 101376
    buffer_load_dwordx4 v17, s[16:19], s50 offen lds
    s_waitcnt lgkmcnt(7)
    v_mfma_f32_32x32x16_bf16 v[84:99], v[120:123], v[128:131], v[84:99]
    ds_read_b128 v[120:123], v19 offset:12288
    s_cmp_ge_u32 s29, 2
    s_cbranch_scc1 kfd_48
    s_add_u32 m0, s48, 0
    s_add_u32 s50, s45, 3072
    buffer_load_dwordx4 v18, s[24:27], s50 offen lds
kfd_48:
    s_waitcnt vmcnt(8)
    s_barrier
    ds_read_b128 v[128:131], v24 offset:0
    s_waitcnt lgkmcnt(4)
    v_mfma_f32_32x32x16_bf16 v[36:51], v[108:111], v[124:127], v[36:51]
    ds_read_b128 v[108:111], v20 offset:0
    s_add_u32 m0, s47, 34816
    s_add_u32 s50, s44, 3200
    buffer_load_dwordx4 v16, s[24:27], s50 offen lds
    s_waitcnt lgkmcnt(4)
    v_mfma_f32_32x32x16_bf16 v[52:67], v[112:115], v[124:127], v[52:67]
    ds_read_b128 v[112:115], v20 offset:4096
    s_waitcnt lgkmcnt(4)
    v_mfma_f32_32x32x16_bf16 v[68:83], v[116:119], v[124:127], v[68:83]
    ds_read_b128 v[116:119], v20 offset:8192
    s_add_u32 m0, s47, 35840
    s_add_u32 s50, s44, 35968
    buffer_load_dwordx4 v17, s[24:27], s50 offen lds
    s_waitcnt lgkmcnt(4)
    v_mfma_f32_32x32x16_bf16 v[84:99], v[120:123], v[124:127], v[84:99]
    ds_read_b128 v[120:123], v20 offset:12288
    s_waitcnt lgkmcnt(10)
    v_mfma_f32_16x16x32_bf16 v[100:103], v[132:135], v[136:139], v[100:103]
    v_mfma_f32_16x16x32_bf16 v[104:107], v[132:135], v[140:143], v[104:107]
    ds_read_b128 v[132:135], v28 offset:0
    ds_read_b128 v[136:139], v30 offset:0
    ds_read_b128 v[140:143], v30 offset:2048
    ds_read_b128 v[124:127], v25 offset:0
    s_waitcnt lgkmcnt(7)
    v_mfma_f32_32x32x16_bf16 v[36:51], v[108:111], v[128:131], v[36:51]
    ds_read_b128 v[108:111], v21 offset:0
    s_add_u32 m0, s47, 36864
    s_add_u32 s50, s44, 68736
    buffer_load_dwordx4 v16, s[24:27], s50 offen lds
    s_waitcnt lgkmcnt(7)
    v_mfma_f32_32x32x16_bf16 v[52:67], v[112:115], v[128:131], v[52:67]
    ds_read_b128 v[112:115], v21 offset:4096
    s_waitcnt lgkmcnt(7)
    v_mfma_f32_32x32x16_bf16 v[68:83], v[116:119], v[128:131], v[68:83]
    ds_read_b128 v[116:119], v21 offset:8192
    s_add_u32 m0, s47, 37888
    s_add_u32 s50, s44, 101504
    buffer_load_dwordx4 v17, s[24:27], s50 offen lds
    s_waitcnt lgkmcnt(7)
    v_mfma_f32_32x32x16_bf16 v[84:99], v[120:123], v[128:131], v[84:99]
    ds_read_b128 v[120:123], v21 offset:12288
    ds_read_b128 v[128:131], v26 offset:0
    s_waitcnt lgkmcnt(4)
    v_mfma_f32_32x32x16_bf16 v[36:51], v[108:111], v[124:127], v[36:51]
    ds_read_b128 v[108:111], v22 offset:0
    s_add_u32 m0, s49, 34816
    s_add_u32 s50, s46, 3200
    buffer_load_dwordx4 v16, s[16:19], s50 offen lds
    s_waitcnt lgkmcnt(4)
    v_mfma_f32_32x32x16_bf16 v[52:67], v[112:115], v[124:127], v[52:67]
    ds_read_b128 v[112:115], v22 offset:4096
    s_waitcnt lgkmcnt(4)
    v_mfma_f32_32x32x16_bf16 v[68:83], v[116:119], v[124:127], v[68:83]
    ds_read_b128 v[116:119], v22 offset:8192
    s_add_u32 m0, s49, 35840
    s_add_u32 s50, s46, 35968
    buffer_load_dwordx4 v17, s[16:19], s50 offen lds
    s_waitcnt lgkmcnt(4)
    v_mfma_f32_32x32x16_bf16 v[84:99], v[120:123], v[124:127], v[84:99]
    ds_read_b128 v[120:123], v22 offset:12288
    s_waitcnt lgkmcnt(10)
    v_mfma_f32_16x16x32_bf16 v[100:103], v[132:135], v[136:139], v[100:103]
    v_mfma_f32_16x16x32_bf16 v[104:107], v[132:135], v[140:143], v[104:107]
    ds_read_b128 v[132:135], v27 offset:34816
    ds_read_b128 v[136:139], v29 offset:34816
    ds_read_b128 v[140:143], v29 offset:36864
    ds_read_b128 v[124:127], v23 offset:34816
    s_waitcnt lgkmcnt(7)
    v_mfma_f32_32x32x16_bf16 v[36:51], v[108:111], v[128:131], v[36:51]
    ds_read_b128 v[108:111], v19 offset:34816
    s_add_u32 m0, s49, 36864
    s_add_u32 s50, s46, 68736
    buffer_load_dwordx4 v16, s[16:19], s50 offen lds
    s_waitcnt lgkmcnt(7)
    v_mfma_f32_32x32x16_bf16 v[52:67], v[112:115], v[128:131], v[52:67]
    ds_read_b128 v[112:115], v19 offset:38912
    s_waitcnt lgkmcnt(7)
    v_mfma_f32_32x32x16_bf16 v[68:83], v[116:119], v[128:131], v[68:83]
    ds_read_b128 v[116:119], v19 offset:43008
    s_add_u32 m0, s49, 37888
    s_add_u32 s50, s46, 101504
    buffer_load_dwordx4 v17, s[16:19], s50 offen lds
    s_waitcnt lgkmcnt(7)
    v_mfma_f32_32x32x16_bf16 v[84:99], v[120:123], v[128:131], v[84:99]
    ds_read_b128 v[120:123], v19 offset:47104
    s_cmp_ge_u32 s29, 2
    s_cbranch_scc1 kfd_49
    s_add_u32 m0, s48, 34816
    s_add_u32 s50, s45, 3200
    buffer_load_dwordx4 v18, s[24:27], s50 offen lds
kfd_49:
    s_waitcnt vmcnt(8)
    s_barrier
    ds_read_b128 v[128:131], v24 offset:34816
    s_waitcnt lgkmcnt(4)
    v_mfma_f32_32x32x16_bf16 v[36:51], v[108:111], v[124:127], v[36:51]
    ds_read_b128 v[108:111], v20 offset:34816
    s_add_u32 m0, s47, 69632
    s_add_u32 s50, s44, 3328
    buffer_load_dwordx4 v16, s[24:27], s50 offen lds
    s_waitcnt lgkmcnt(4)
    v_mfma_f32_32x32x16_bf16 v[52:67], v[112:115], v[124:127], v[52:67]
    ds_read_b128 v[112:115], v20 offset:38912
    s_waitcnt lgkmcnt(4)
    v_mfma_f32_32x32x16_bf16 v[68:83], v[116:119], v[124:127], v[68:83]
    ds_read_b128 v[116:119], v20 offset:43008
    s_add_u32 m0, s47, 70656
    s_add_u32 s50, s44, 36096
    buffer_load_dwordx4 v17, s[24:27], s50 offen lds
    s_waitcnt lgkmcnt(4)
    v_mfma_f32_32x32x16_bf16 v[84:99], v[120:123], v[124:127], v[84:99]
    ds_read_b128 v[120:123], v20 offset:47104
    s_waitcnt lgkmcnt(10)
    v_mfma_f32_16x16x32_bf16 v[100:103], v[132:135], v[136:139], v[100:103]
    v_mfma_f32_16x16x32_bf16 v[104:107], v[132:135], v[140:143], v[104:107]
    ds_read_b128 v[132:135], v28 offset:34816
    ds_read_b128 v[136:139], v30 offset:34816
    ds_read_b128 v[140:143], v30 offset:36864
    ds_read_b128 v[124:127], v25 offset:34816
    s_waitcnt lgkmcnt(7)
    v_mfma_f32_32x32x16_bf16 v[36:51], v[108:111], v[128:131], v[36:51]
    ds_read_b128 v[108:111], v21 offset:34816
    s_add_u32 m0, s47, 71680
    s_add_u32 s50, s44, 68864
    buffer_load_dwordx4 v16, s[24:27], s50 offen lds
    s_waitcnt lgkmcnt(7)
    v_mfma_f32_32x32x16_bf16 v[52:67], v[112:115], v[128:131], v[52:67]
    ds_read_b128 v[112:115], v21 offset:38912
    s_waitcnt lgkmcnt(7)
    v_mfma_f32_32x32x16_bf16 v[68:83], v[116:119], v[128:131], v[68:83]
    ds_read_b128 v[116:119], v21 offset:43008
    s_add_u32 m0, s47, 72704
    s_add_u32 s50, s44, 101632
    buffer_load_dwordx4 v17, s[24:27], s50 offen lds
    s_waitcnt lgkmcnt(7)
    v_mfma_f32_32x32x16_bf16 v[84:99], v[120:123], v[128:131], v[84:99]
    ds_read_b128 v[120:123], v21 offset:47104
    ds_read_b128 v[128:131], v26 offset:34816
    s_waitcnt lgkmcnt(4)
    v_mfma_f32_32x32x16_bf16 v[36:51], v[108:111], v[124:127], v[36:51]
    ds_read_b128 v[108:111], v22 offset:34816
    s_add_u32 m0, s49, 69632
    s_add_u32 s50, s46, 3328
    buffer_load_dwordx4 v16, s[16:19], s50 offen lds
    s_waitcnt lgkmcnt(4)
    v_mfma_f32_32x32x16_bf16 v[52:67], v[112:115], v[124:127], v[52:67]
    ds_read_b128 v[112:115], v22 offset:38912
    s_waitcnt lgkmcnt(4)
    v_mfma_f32_32x32x16_bf16 v[68:83], v[116:119], v[124:127], v[68:83]
    ds_read_b128 v[116:119], v22 offset:43008
    s_add_u32 m0, s49, 70656
    s_add_u32 s50, s46, 36096
    buffer_load_dwordx4 v17, s[16:19], s50 offen lds
    s_waitcnt lgkmcnt(4)
    v_mfma_f32_32x32x16_bf16 v[84:99], v[120:123], v[124:127], v[84:99]
    ds_read_b128 v[120:123], v22 offset:47104
    s_waitcnt lgkmcnt(10)
    v_mfma_f32_16x16x32_bf16 v[100:103], v[132:135], v[136:139], v[100:103]
    v_mfma_f32_16x16x32_bf16 v[104:107], v[132:135], v[140:143], v[104:107]
    v_add_u32 v19, 4294897664, v19
    v_add_u32 v20, 4294897664, v20
    v_add_u32 v21, 4294897664, v21
    v_add_u32 v22, 4294897664, v22
    v_add_u32 v23, 4294897664, v23
    v_add_u32 v24, 4294897664, v24
    v_add_u32 v25, 4294897664, v25
    v_add_u32 v26, 4294897664, v26
    v_add_u32 v27, 4294897664, v27
    v_add_u32 v28, 4294897664, v28
    v_add_u32 v29, 4294897664, v29
    v_add_u32 v30, 4294897664, v30
    ds_read_b128 v[132:135], v27 offset:0
    ds_read_b128 v[136:139], v29 offset:0
    ds_read_b128 v[140:143], v29 offset:2048
    ds_read_b128 v[124:127], v23 offset:0
    s_waitcnt lgkmcnt(7)
    v_mfma_f32_32x32x16_bf16 v[36:51], v[108:111], v[128:131], v[36:51]
    ds_read_b128 v[108:111], v19 offset:0
    s_add_u32 m0, s49, 71680
    s_add_u32 s50, s46, 68864
    buffer_load_dwordx4 v16, s[16:19], s50 offen lds
    s_waitcnt lgkmcnt(7)
    v_mfma_f32_32x32x16_bf16 v[52:67], v[112:115], v[128:131], v[52:67]
    ds_read_b128 v[112:115], v19 offset:4096
    s_waitcnt lgkmcnt(7)
    v_mfma_f32_32x32x16_bf16 v[68:83], v[116:119], v[128:131], v[68:83]
    ds_read_b128 v[116:119], v19 offset:8192
    s_add_u32 m0, s49, 72704
    s_add_u32 s50, s46, 101632
    buffer_load_dwordx4 v17, s[16:19], s50 offen lds
    s_waitcnt lgkmcnt(7)
    v_mfma_f32_32x32x16_bf16 v[84:99], v[120:123], v[128:131], v[84:99]
    ds_read_b128 v[120:123], v19 offset:12288
    s_cmp_ge_u32 s29, 2
    s_cbranch_scc1 kfd_50
    s_add_u32 m0, s48, 69632
    s_add_u32 s50, s45, 3328
    buffer_load_dwordx4 v18, s[24:27], s50 offen lds
kfd_50:
    s_waitcnt vmcnt(8)
    s_barrier
    ds_read_b128 v[128:131], v24 offset:0
    s_waitcnt lgkmcnt(4)
    v_mfma_f32_32x32x16_bf16 v[36:51], v[108:111], v[124:127], v[36:51]
    ds_read_b128 v[108:111], v20 offset:0
    s_add_u32 m0, s47, 104448
    s_add_u32 s50, s44, 3456
    buffer_load_dwordx4 v16, s[24:27], s50 offen lds
    s_waitcnt lgkmcnt(4)
    v_mfma_f32_32x32x16_bf16 v[52:67], v[112:115], v[124:127], v[52:67]
    ds_read_b128 v[112:115], v20 offset:4096
    s_waitcnt lgkmcnt(4)
    v_mfma_f32_32x32x16_bf16 v[68:83], v[116:119], v[124:127], v[68:83]
    ds_read_b128 v[116:119], v20 offset:8192
    s_add_u32 m0, s47, 105472
    s_add_u32 s50, s44, 36224
    buffer_load_dwordx4 v17, s[24:27], s50 offen lds
    s_waitcnt lgkmcnt(4)
    v_mfma_f32_32x32x16_bf16 v[84:99], v[120:123], v[124:127], v[84:99]
    ds_read_b128 v[120:123], v20 offset:12288
    s_waitcnt lgkmcnt(10)
    v_mfma_f32_16x16x32_bf16 v[100:103], v[132:135], v[136:139], v[100:103]
    v_mfma_f32_16x16x32_bf16 v[104:107], v[132:135], v[140:143], v[104:107]
    ds_read_b128 v[132:135], v28 offset:0
    ds_read_b128 v[136:139], v30 offset:0
    ds_read_b128 v[140:143], v30 offset:2048
    ds_read_b128 v[124:127], v25 offset:0
    s_waitcnt lgkmcnt(7)
    v_mfma_f32_32x32x16_bf16 v[36:51], v[108:111], v[128:131], v[36:51]
    ds_read_b128 v[108:111], v21 offset:0
    s_add_u32 m0, s47, 106496
    s_add_u32 s50, s44, 68992
    buffer_load_dwordx4 v16, s[24:27], s50 offen lds
    s_waitcnt lgkmcnt(7)
    v_mfma_f32_32x32x16_bf16 v[52:67], v[112:115], v[128:131], v[52:67]
    ds_read_b128 v[112:115], v21 offset:4096
    s_waitcnt lgkmcnt(7)
    v_mfma_f32_32x32x16_bf16 v[68:83], v[116:119], v[128:131], v[68:83]
    ds_read_b128 v[116:119], v21 offset:8192
    s_add_u32 m0, s47, 107520
    s_add_u32 s50, s44, 101760
    buffer_load_dwordx4 v17, s[24:27], s50 offen lds
    s_waitcnt lgkmcnt(7)
    v_mfma_f32_32x32x16_bf16 v[84:99], v[120:123], v[128:131], v[84:99]
    ds_read_b128 v[120:123], v21 offset:12288
    ds_read_b128 v[128:131], v26 offset:0
    s_waitcnt lgkmcnt(4)
    v_mfma_f32_32x32x16_bf16 v[36:51], v[108:111], v[124:127], v[36:51]
    ds_read_b128 v[108:111], v22 offset:0
    s_add_u32 m0, s49, 104448
    s_add_u32 s50, s46, 3456
    buffer_load_dwordx4 v16, s[16:19], s50 offen lds
    s_waitcnt lgkmcnt(4)
    v_mfma_f32_32x32x16_bf16 v[52:67], v[112:115], v[124:127], v[52:67]
    ds_read_b128 v[112:115], v22 offset:4096
    s_waitcnt lgkmcnt(4)
    v_mfma_f32_32x32x16_bf16 v[68:83], v[116:119], v[124:127], v[68:83]
    ds_read_b128 v[116:119], v22 offset:8192
    s_add_u32 m0, s49, 105472
    s_add_u32 s50, s46, 36224
    buffer_load_dwordx4 v17, s[16:19], s50 offen lds
    s_waitcnt lgkmcnt(4)
    v_mfma_f32_32x32x16_bf16 v[84:99], v[120:123], v[124:127], v[84:99]
    ds_read_b128 v[120:123], v22 offset:12288
    s_waitcnt lgkmcnt(10)
    v_mfma_f32_16x16x32_bf16 v[100:103], v[132:135], v[136:139], v[100:103]
    v_mfma_f32_16x16x32_bf16 v[104:107], v[132:135], v[140:143], v[104:107]
    ds_read_b128 v[132:135], v27 offset:34816
    ds_read_b128 v[136:139], v29 offset:34816
    ds_read_b128 v[140:143], v29 offset:36864
    ds_read_b128 v[124:127], v23 offset:34816
    s_waitcnt lgkmcnt(7)
    v_mfma_f32_32x32x16_bf16 v[36:51], v[108:111], v[128:131], v[36:51]
    ds_read_b128 v[108:111], v19 offset:34816
    s_add_u32 m0, s49, 106496
    s_add_u32 s50, s46, 68992
    buffer_load_dwordx4 v16, s[16:19], s50 offen lds
    s_waitcnt lgkmcnt(7)
    v_mfma_f32_32x32x16_bf16 v[52:67], v[112:115], v[128:131], v[52:67]
    ds_read_b128 v[112:115], v19 offset:38912
    s_waitcnt lgkmcnt(7)
    v_mfma_f32_32x32x16_bf16 v[68:83], v[116:119], v[128:131], v[68:83]
    ds_read_b128 v[116:119], v19 offset:43008
    s_add_u32 m0, s49, 107520
    s_add_u32 s50, s46, 101760
    buffer_load_dwordx4 v17, s[16:19], s50 offen lds
    s_waitcnt lgkmcnt(7)
    v_mfma_f32_32x32x16_bf16 v[84:99], v[120:123], v[128:131], v[84:99]
    ds_read_b128 v[120:123], v19 offset:47104
    s_cmp_ge_u32 s29, 2
    s_cbranch_scc1 kfd_51
    s_add_u32 m0, s48, 104448
    s_add_u32 s50, s45, 3456
    buffer_load_dwordx4 v18, s[24:27], s50 offen lds
kfd_51:
    s_waitcnt vmcnt(8)
    s_barrier
    ds_read_b128 v[128:131], v24 offset:34816
    s_waitcnt lgkmcnt(4)
    v_mfma_f32_32x32x16_bf16 v[36:51], v[108:111], v[124:127], v[36:51]
    ds_read_b128 v[108:111], v20 offset:34816
    s_add_u32 m0, s47, 0
    s_add_u32 s50, s44, 3584
    buffer_load_dwordx4 v16, s[24:27], s50 offen lds
    s_waitcnt lgkmcnt(4)
    v_mfma_f32_32x32x16_bf16 v[52:67], v[112:115], v[124:127], v[52:67]
    ds_read_b128 v[112:115], v20 offset:38912
    s_waitcnt lgkmcnt(4)
    v_mfma_f32_32x32x16_bf16 v[68:83], v[116:119], v[124:127], v[68:83]
    ds_read_b128 v[116:119], v20 offset:43008
    s_add_u32 m0, s47, 1024
    s_add_u32 s50, s44, 36352
    buffer_load_dwordx4 v17, s[24:27], s50 offen lds
    s_waitcnt lgkmcnt(4)
    v_mfma_f32_32x32x16_bf16 v[84:99], v[120:123], v[124:127], v[84:99]
    ds_read_b128 v[120:123], v20 offset:47104
    s_waitcnt lgkmcnt(10)
    v_mfma_f32_16x16x32_bf16 v[100:103], v[132:135], v[136:139], v[100:103]
    v_mfma_f32_16x16x32_bf16 v[104:107], v[132:135], v[140:143], v[104:107]
    ds_read_b128 v[132:135], v28 offset:34816
    ds_read_b128 v[136:139], v30 offset:34816
    ds_read_b128 v[140:143], v30 offset:36864
    ds_read_b128 v[124:127], v25 offset:34816
    s_waitcnt lgkmcnt(7)
    v_mfma_f32_32x32x16_bf16 v[36:51], v[108:111], v[128:131], v[36:51]
    ds_read_b128 v[108:111], v21 offset:34816
    s_add_u32 m0, s47, 2048
    s_add_u32 s50, s44, 69120
    buffer_load_dwordx4 v16, s[24:27], s50 offen lds
    s_waitcnt lgkmcnt(7)
    v_mfma_f32_32x32x16_bf16 v[52:67], v[112:115], v[128:131], v[52:67]
    ds_read_b128 v[112:115], v21 offset:38912
    s_waitcnt lgkmcnt(7)
    v_mfma_f32_32x32x16_bf16 v[68:83], v[116:119], v[128:131], v[68:83]
    ds_read_b128 v[116:119], v21 offset:43008
    s_add_u32 m0, s47, 3072
    s_add_u32 s50, s44, 101888
    buffer_load_dwordx4 v17, s[24:27], s50 offen lds
    s_waitcnt lgkmcnt(7)
    v_mfma_f32_32x32x16_bf16 v[84:99], v[120:123], v[128:131], v[84:99]
    ds_read_b128 v[120:123], v21 offset:47104
    ds_read_b128 v[128:131], v26 offset:34816
    s_waitcnt lgkmcnt(4)
    v_mfma_f32_32x32x16_bf16 v[36:51], v[108:111], v[124:127], v[36:51]
    ds_read_b128 v[108:111], v22 offset:34816
    s_add_u32 m0, s49, 0
    s_add_u32 s50, s46, 3584
    buffer_load_dwordx4 v16, s[16:19], s50 offen lds
    s_waitcnt lgkmcnt(4)
    v_mfma_f32_32x32x16_bf16 v[52:67], v[112:115], v[124:127], v[52:67]
    ds_read_b128 v[112:115], v22 offset:38912
    s_waitcnt lgkmcnt(4)
    v_mfma_f32_32x32x16_bf16 v[68:83], v[116:119], v[124:127], v[68:83]
    ds_read_b128 v[116:119], v22 offset:43008
    s_add_u32 m0, s49, 1024
    s_add_u32 s50, s46, 36352
    buffer_load_dwordx4 v17, s[16:19], s50 offen lds
    s_waitcnt lgkmcnt(4)
    v_mfma_f32_32x32x16_bf16 v[84:99], v[120:123], v[124:127], v[84:99]
    ds_read_b128 v[120:123], v22 offset:47104
    s_waitcnt lgkmcnt(10)
    v_mfma_f32_16x16x32_bf16 v[100:103], v[132:135], v[136:139], v[100:103]
    v_mfma_f32_16x16x32_bf16 v[104:107], v[132:135], v[140:143], v[104:107]
    v_add_u32 v19, 69632, v19
    v_add_u32 v20, 69632, v20
    v_add_u32 v21, 69632, v21
    v_add_u32 v22, 69632, v22
    v_add_u32 v23, 69632, v23
    v_add_u32 v24, 69632, v24
    v_add_u32 v25, 69632, v25
    v_add_u32 v26, 69632, v26
    v_add_u32 v27, 69632, v27
    v_add_u32 v28, 69632, v28
    v_add_u32 v29, 69632, v29
    v_add_u32 v30, 69632, v30
    ds_read_b128 v[132:135], v27 offset:0
    ds_read_b128 v[136:139], v29 offset:0
    ds_read_b128 v[140:143], v29 offset:2048
    ds_read_b128 v[124:127], v23 offset:0
    s_waitcnt lgkmcnt(7)
    v_mfma_f32_32x32x16_bf16 v[36:51], v[108:111], v[128:131], v[36:51]
    ds_read_b128 v[108:111], v19 offset:0
    s_add_u32 m0, s49, 2048
    s_add_u32 s50, s46, 69120
    buffer_load_dwordx4 v16, s[16:19], s50 offen lds
    s_waitcnt lgkmcnt(7)
    v_mfma_f32_32x32x16_bf16 v[52:67], v[112:115], v[128:131], v[52:67]
    ds_read_b128 v[112:115], v19 offset:4096
    s_waitcnt lgkmcnt(7)
    v_mfma_f32_32x32x16_bf16 v[68:83], v[116:119], v[128:131], v[68:83]
    ds_read_b128 v[116:119], v19 offset:8192
    s_add_u32 m0, s49, 3072
    s_add_u32 s50, s46, 101888
    buffer_load_dwordx4 v17, s[16:19], s50 offen lds
    s_waitcnt lgkmcnt(7)
    v_mfma_f32_32x32x16_bf16 v[84:99], v[120:123], v[128:131], v[84:99]
    ds_read_b128 v[120:123], v19 offset:12288
    s_cmp_ge_u32 s29, 2
    s_cbranch_scc1 kfd_52
    s_add_u32 m0, s48, 0
    s_add_u32 s50, s45, 3584
    buffer_load_dwordx4 v18, s[24:27], s50 offen lds
kfd_52:
    s_waitcnt vmcnt(8)
    s_barrier
    ds_read_b128 v[128:131], v24 offset:0
    s_waitcnt lgkmcnt(4)
    v_mfma_f32_32x32x16_bf16 v[36:51], v[108:111], v[124:127], v[36:51]
    ds_read_b128 v[108:111], v20 offset:0
    s_add_u32 m0, s47, 34816
    s_add_u32 s50, s44, 3712
    buffer_load_dwordx4 v16, s[24:27], s50 offen lds
    s_waitcnt lgkmcnt(4)
    v_mfma_f32_32x32x16_bf16 v[52:67], v[112:115], v[124:127], v[52:67]
    ds_read_b128 v[112:115], v20 offset:4096
    s_waitcnt lgkmcnt(4)
    v_mfma_f32_32x32x16_bf16 v[68:83], v[116:119], v[124:127], v[68:83]
    ds_read_b128 v[116:119], v20 offset:8192
    s_add_u32 m0, s47, 35840
    s_add_u32 s50, s44, 36480
    buffer_load_dwordx4 v17, s[24:27], s50 offen lds
    s_waitcnt lgkmcnt(4)
    v_mfma_f32_32x32x16_bf16 v[84:99], v[120:123], v[124:127], v[84:99]
    ds_read_b128 v[120:123], v20 offset:12288
    s_waitcnt lgkmcnt(10)
    v_mfma_f32_16x16x32_bf16 v[100:103], v[132:135], v[136:139], v[100:103]
    v_mfma_f32_16x16x32_bf16 v[104:107], v[132:135], v[140:143], v[104:107]
    ds_read_b128 v[132:135], v28 offset:0
    ds_read_b128 v[136:139], v30 offset:0
    ds_read_b128 v[140:143], v30 offset:2048
    ds_read_b128 v[124:127], v25 offset:0
    s_waitcnt lgkmcnt(7)
    v_mfma_f32_32x32x16_bf16 v[36:51], v[108:111], v[128:131], v[36:51]
    ds_read_b128 v[108:111], v21 offset:0
    s_add_u32 m0, s47, 36864
    s_add_u32 s50, s44, 69248
    buffer_load_dwordx4 v16, s[24:27], s50 offen lds
    s_waitcnt lgkmcnt(7)
    v_mfma_f32_32x32x16_bf16 v[52:67], v[112:115], v[128:131], v[52:67]
    ds_read_b128 v[112:115], v21 offset:4096
    s_waitcnt lgkmcnt(7)
    v_mfma_f32_32x32x16_bf16 v[68:83], v[116:119], v[128:131], v[68:83]
    ds_read_b128 v[116:119], v21 offset:8192
    s_add_u32 m0, s47, 37888
    s_add_u32 s50, s44, 102016
    buffer_load_dwordx4 v17, s[24:27], s50 offen lds
    s_waitcnt lgkmcnt(7)
    v_mfma_f32_32x32x16_bf16 v[84:99], v[120:123], v[128:131], v[84:99]
    ds_read_b128 v[120:123], v21 offset:12288
    ds_read_b128 v[128:131], v26 offset:0
    s_waitcnt lgkmcnt(4)
    v_mfma_f32_32x32x16_bf16 v[36:51], v[108:111], v[124:127], v[36:51]
    ds_read_b128 v[108:111], v22 offset:0
    s_add_u32 m0, s49, 34816
    s_add_u32 s50, s46, 3712
    buffer_load_dwordx4 v16, s[16:19], s50 offen lds
    s_waitcnt lgkmcnt(4)
    v_mfma_f32_32x32x16_bf16 v[52:67], v[112:115], v[124:127], v[52:67]
    ds_read_b128 v[112:115], v22 offset:4096
    s_waitcnt lgkmcnt(4)
    v_mfma_f32_32x32x16_bf16 v[68:83], v[116:119], v[124:127], v[68:83]
    ds_read_b128 v[116:119], v22 offset:8192
    s_add_u32 m0, s49, 35840
    s_add_u32 s50, s46, 36480
    buffer_load_dwordx4 v17, s[16:19], s50 offen lds
    s_waitcnt lgkmcnt(4)
    v_mfma_f32_32x32x16_bf16 v[84:99], v[120:123], v[124:127], v[84:99]
    ds_read_b128 v[120:123], v22 offset:12288
    s_waitcnt lgkmcnt(10)
    v_mfma_f32_16x16x32_bf16 v[100:103], v[132:135], v[136:139], v[100:103]
    v_mfma_f32_16x16x32_bf16 v[104:107], v[132:135], v[140:143], v[104:107]
    ds_read_b128 v[132:135], v27 offset:34816
    ds_read_b128 v[136:139], v29 offset:34816
    ds_read_b128 v[140:143], v29 offset:36864
    ds_read_b128 v[124:127], v23 offset:34816
    s_waitcnt lgkmcnt(7)
    v_mfma_f32_32x32x16_bf16 v[36:51], v[108:111], v[128:131], v[36:51]
    ds_read_b128 v[108:111], v19 offset:34816
    s_add_u32 m0, s49, 36864
    s_add_u32 s50, s46, 69248
    buffer_load_dwordx4 v16, s[16:19], s50 offen lds
    s_waitcnt lgkmcnt(7)
    v_mfma_f32_32x32x16_bf16 v[52:67], v[112:115], v[128:131], v[52:67]
    ds_read_b128 v[112:115], v19 offset:38912
    s_waitcnt lgkmcnt(7)
    v_mfma_f32_32x32x16_bf16 v[68:83], v[116:119], v[128:131], v[68:83]
    ds_read_b128 v[116:119], v19 offset:43008
    s_add_u32 m0, s49, 37888
    s_add_u32 s50, s46, 102016
    buffer_load_dwordx4 v17, s[16:19], s50 offen lds
    s_waitcnt lgkmcnt(7)
    v_mfma_f32_32x32x16_bf16 v[84:99], v[120:123], v[128:131], v[84:99]
    ds_read_b128 v[120:123], v19 offset:47104
    s_cmp_ge_u32 s29, 2
    s_cbranch_scc1 kfd_53
    s_add_u32 m0, s48, 34816
    s_add_u32 s50, s45, 3712
    buffer_load_dwordx4 v18, s[24:27], s50 offen lds
kfd_53:
    s_waitcnt vmcnt(8)
    s_barrier
    ds_read_b128 v[128:131], v24 offset:34816
    s_waitcnt lgkmcnt(4)
    v_mfma_f32_32x32x16_bf16 v[36:51], v[108:111], v[124:127], v[36:51]
    ds_read_b128 v[108:111], v20 offset:34816
    s_add_u32 m0, s47, 69632
    s_add_u32 s50, s44, 3840
    buffer_load_dwordx4 v16, s[24:27], s50 offen lds
    s_waitcnt lgkmcnt(4)
    v_mfma_f32_32x32x16_bf16 v[52:67], v[112:115], v[124:127], v[52:67]
    ds_read_b128 v[112:115], v20 offset:38912
    s_waitcnt lgkmcnt(4)
    v_mfma_f32_32x32x16_bf16 v[68:83], v[116:119], v[124:127], v[68:83]
    ds_read_b128 v[116:119], v20 offset:43008
    s_add_u32 m0, s47, 70656
    s_add_u32 s50, s44, 36608
    buffer_load_dwordx4 v17, s[24:27], s50 offen lds
    s_waitcnt lgkmcnt(4)
    v_mfma_f32_32x32x16_bf16 v[84:99], v[120:123], v[124:127], v[84:99]
    ds_read_b128 v[120:123], v20 offset:47104
    s_waitcnt lgkmcnt(10)
    v_mfma_f32_16x16x32_bf16 v[100:103], v[132:135], v[136:139], v[100:103]
    v_mfma_f32_16x16x32_bf16 v[104:107], v[132:135], v[140:143], v[104:107]
    ds_read_b128 v[132:135], v28 offset:34816
    ds_read_b128 v[136:139], v30 offset:34816
    ds_read_b128 v[140:143], v30 offset:36864
    ds_read_b128 v[124:127], v25 offset:34816
    s_waitcnt lgkmcnt(7)
    v_mfma_f32_32x32x16_bf16 v[36:51], v[108:111], v[128:131], v[36:51]
    ds_read_b128 v[108:111], v21 offset:34816
    s_add_u32 m0, s47, 71680
    s_add_u32 s50, s44, 69376
    buffer_load_dwordx4 v16, s[24:27], s50 offen lds
    s_waitcnt lgkmcnt(7)
    v_mfma_f32_32x32x16_bf16 v[52:67], v[112:115], v[128:131], v[52:67]
    ds_read_b128 v[112:115], v21 offset:38912
    s_waitcnt lgkmcnt(7)
    v_mfma_f32_32x32x16_bf16 v[68:83], v[116:119], v[128:131], v[68:83]
    ds_read_b128 v[116:119], v21 offset:43008
    s_add_u32 m0, s47, 72704
    s_add_u32 s50, s44, 102144
    buffer_load_dwordx4 v17, s[24:27], s50 offen lds
    s_waitcnt lgkmcnt(7)
    v_mfma_f32_32x32x16_bf16 v[84:99], v[120:123], v[128:131], v[84:99]
    ds_read_b128 v[120:123], v21 offset:47104
    ds_read_b128 v[128:131], v26 offset:34816
    s_waitcnt lgkmcnt(4)
    v_mfma_f32_32x32x16_bf16 v[36:51], v[108:111], v[124:127], v[36:51]
    ds_read_b128 v[108:111], v22 offset:34816
    s_add_u32 m0, s49, 69632
    s_add_u32 s50, s46, 3840
    buffer_load_dwordx4 v16, s[16:19], s50 offen lds
    s_waitcnt lgkmcnt(4)
    v_mfma_f32_32x32x16_bf16 v[52:67], v[112:115], v[124:127], v[52:67]
    ds_read_b128 v[112:115], v22 offset:38912
    s_waitcnt lgkmcnt(4)
    v_mfma_f32_32x32x16_bf16 v[68:83], v[116:119], v[124:127], v[68:83]
    ds_read_b128 v[116:119], v22 offset:43008
    s_add_u32 m0, s49, 70656
    s_add_u32 s50, s46, 36608
    buffer_load_dwordx4 v17, s[16:19], s50 offen lds
    s_waitcnt lgkmcnt(4)
    v_mfma_f32_32x32x16_bf16 v[84:99], v[120:123], v[124:127], v[84:99]
    ds_read_b128 v[120:123], v22 offset:47104
    s_waitcnt lgkmcnt(10)
    v_mfma_f32_16x16x32_bf16 v[100:103], v[132:135], v[136:139], v[100:103]
    v_mfma_f32_16x16x32_bf16 v[104:107], v[132:135], v[140:143], v[104:107]
    v_add_u32 v19, 4294897664, v19
    v_add_u32 v20, 4294897664, v20
    v_add_u32 v21, 4294897664, v21
    v_add_u32 v22, 4294897664, v22
    v_add_u32 v23, 4294897664, v23
    v_add_u32 v24, 4294897664, v24
    v_add_u32 v25, 4294897664, v25
    v_add_u32 v26, 4294897664, v26
    v_add_u32 v27, 4294897664, v27
    v_add_u32 v28, 4294897664, v28
    v_add_u32 v29, 4294897664, v29
    v_add_u32 v30, 4294897664, v30
    ds_read_b128 v[132:135], v27 offset:0
    ds_read_b128 v[136:139], v29 offset:0
    ds_read_b128 v[140:143], v29 offset:2048
    ds_read_b128 v[124:127], v23 offset:0
    s_waitcnt lgkmcnt(7)
    v_mfma_f32_32x32x16_bf16 v[36:51], v[108:111], v[128:131], v[36:51]
    ds_read_b128 v[108:111], v19 offset:0
    s_add_u32 m0, s49, 71680
    s_add_u32 s50, s46, 69376
    buffer_load_dwordx4 v16, s[16:19], s50 offen lds
    s_waitcnt lgkmcnt(7)
    v_mfma_f32_32x32x16_bf16 v[52:67], v[112:115], v[128:131], v[52:67]
    ds_read_b128 v[112:115], v19 offset:4096
    s_waitcnt lgkmcnt(7)
    v_mfma_f32_32x32x16_bf16 v[68:83], v[116:119], v[128:131], v[68:83]
    ds_read_b128 v[116:119], v19 offset:8192
    s_add_u32 m0, s49, 72704
    s_add_u32 s50, s46, 102144
    buffer_load_dwordx4 v17, s[16:19], s50 offen lds
    s_waitcnt lgkmcnt(7)
    v_mfma_f32_32x32x16_bf16 v[84:99], v[120:123], v[128:131], v[84:99]
    ds_read_b128 v[120:123], v19 offset:12288
    s_cmp_ge_u32 s29, 2
    s_cbranch_scc1 kfd_54
    s_add_u32 m0, s48, 69632
    s_add_u32 s50, s45, 3840
    buffer_load_dwordx4 v18, s[24:27], s50 offen lds
kfd_54:
    s_waitcnt vmcnt(8)
    s_barrier
    ds_read_b128 v[128:131], v24 offset:0
    s_waitcnt lgkmcnt(4)
    v_mfma_f32_32x32x16_bf16 v[36:51], v[108:111], v[124:127], v[36:51]
    ds_read_b128 v[108:111], v20 offset:0
    s_add_u32 m0, s47, 104448
    s_add_u32 s50, s44, 3968
    buffer_load_dwordx4 v16, s[24:27], s50 offen lds
    s_waitcnt lgkmcnt(4)
    v_mfma_f32_32x32x16_bf16 v[52:67], v[112:115], v[124:127], v[52:67]
    ds_read_b128 v[112:115], v20 offset:4096
    s_waitcnt lgkmcnt(4)
    v_mfma_f32_32x32x16_bf16 v[68:83], v[116:119], v[124:127], v[68:83]
    ds_read_b128 v[116:119], v20 offset:8192
    s_add_u32 m0, s47, 105472
    s_add_u32 s50, s44, 36736
    buffer_load_dwordx4 v17, s[24:27], s50 offen lds
    s_waitcnt lgkmcnt(4)
    v_mfma_f32_32x32x16_bf16 v[84:99], v[120:123], v[124:127], v[84:99]
    ds_read_b128 v[120:123], v20 offset:12288
    s_waitcnt lgkmcnt(10)
    v_mfma_f32_16x16x32_bf16 v[100:103], v[132:135], v[136:139], v[100:103]
    v_mfma_f32_16x16x32_bf16 v[104:107], v[132:135], v[140:143], v[104:107]
    ds_read_b128 v[132:135], v28 offset:0
    ds_read_b128 v[136:139], v30 offset:0
    ds_read_b128 v[140:143], v30 offset:2048
    ds_read_b128 v[124:127], v25 offset:0
    s_waitcnt lgkmcnt(7)
    v_mfma_f32_32x32x16_bf16 v[36:51], v[108:111], v[128:131], v[36:51]
    ds_read_b128 v[108:111], v21 offset:0
    s_add_u32 m0, s47, 106496
    s_add_u32 s50, s44, 69504
    buffer_load_dwordx4 v16, s[24:27], s50 offen lds
    s_waitcnt lgkmcnt(7)
    v_mfma_f32_32x32x16_bf16 v[52:67], v[112:115], v[128:131], v[52:67]
    ds_read_b128 v[112:115], v21 offset:4096
    s_waitcnt lgkmcnt(7)
    v_mfma_f32_32x32x16_bf16 v[68:83], v[116:119], v[128:131], v[68:83]
    ds_read_b128 v[116:119], v21 offset:8192
    s_add_u32 m0, s47, 107520
    s_add_u32 s50, s44, 102272
    buffer_load_dwordx4 v17, s[24:27], s50 offen lds
    s_waitcnt lgkmcnt(7)
    v_mfma_f32_32x32x16_bf16 v[84:99], v[120:123], v[128:131], v[84:99]
    ds_read_b128 v[120:123], v21 offset:12288
    ds_read_b128 v[128:131], v26 offset:0
    s_waitcnt lgkmcnt(4)
    v_mfma_f32_32x32x16_bf16 v[36:51], v[108:111], v[124:127], v[36:51]
    ds_read_b128 v[108:111], v22 offset:0
    s_add_u32 m0, s49, 104448
    s_add_u32 s50, s46, 3968
    buffer_load_dwordx4 v16, s[16:19], s50 offen lds
    s_waitcnt lgkmcnt(4)
    v_mfma_f32_32x32x16_bf16 v[52:67], v[112:115], v[124:127], v[52:67]
    ds_read_b128 v[112:115], v22 offset:4096
    s_waitcnt lgkmcnt(4)
    v_mfma_f32_32x32x16_bf16 v[68:83], v[116:119], v[124:127], v[68:83]
    ds_read_b128 v[116:119], v22 offset:8192
    s_add_u32 m0, s49, 105472
    s_add_u32 s50, s46, 36736
    buffer_load_dwordx4 v17, s[16:19], s50 offen lds
    s_waitcnt lgkmcnt(4)
    v_mfma_f32_32x32x16_bf16 v[84:99], v[120:123], v[124:127], v[84:99]
    ds_read_b128 v[120:123], v22 offset:12288
    s_waitcnt lgkmcnt(10)
    v_mfma_f32_16x16x32_bf16 v[100:103], v[132:135], v[136:139], v[100:103]
    v_mfma_f32_16x16x32_bf16 v[104:107], v[132:135], v[140:143], v[104:107]
    ds_read_b128 v[132:135], v27 offset:34816
    ds_read_b128 v[136:139], v29 offset:34816
    ds_read_b128 v[140:143], v29 offset:36864
    ds_read_b128 v[124:127], v23 offset:34816
    s_waitcnt lgkmcnt(7)
    v_mfma_f32_32x32x16_bf16 v[36:51], v[108:111], v[128:131], v[36:51]
    ds_read_b128 v[108:111], v19 offset:34816
    s_add_u32 m0, s49, 106496
    s_add_u32 s50, s46, 69504
    buffer_load_dwordx4 v16, s[16:19], s50 offen lds
    s_waitcnt lgkmcnt(7)
    v_mfma_f32_32x32x16_bf16 v[52:67], v[112:115], v[128:131], v[52:67]
    ds_read_b128 v[112:115], v19 offset:38912
    s_waitcnt lgkmcnt(7)
    v_mfma_f32_32x32x16_bf16 v[68:83], v[116:119], v[128:131], v[68:83]
    ds_read_b128 v[116:119], v19 offset:43008
    s_add_u32 m0, s49, 107520
    s_add_u32 s50, s46, 102272
    buffer_load_dwordx4 v17, s[16:19], s50 offen lds
    s_waitcnt lgkmcnt(7)
    v_mfma_f32_32x32x16_bf16 v[84:99], v[120:123], v[128:131], v[84:99]
    ds_read_b128 v[120:123], v19 offset:47104
    s_cmp_ge_u32 s29, 2
    s_cbranch_scc1 kfd_55
    s_add_u32 m0, s48, 104448
    s_add_u32 s50, s45, 3968
    buffer_load_dwordx4 v18, s[24:27], s50 offen lds
kfd_55:
    s_waitcnt vmcnt(8)
    s_barrier
    s_lshl_b32 s39, s29, 5
    s_add_u32 s39, s39, s34
    v_add_u32 v8, s39, v3
    v_lshlrev_b32 v8, 1, v8
    v_add_u32 v9, s39, v5
    v_lshlrev_b32 v9, 1, v9
    buffer_load_ushort v31, v8, s[20:23], 0 offen
    buffer_load_ushort v32, v8, s[20:23], 0 offen offset:32
    buffer_load_ushort v33, v9, s[20:23], 0 offen
    ds_read_b128 v[128:131], v24 offset:34816
    s_waitcnt lgkmcnt(4)
    v_mfma_f32_32x32x16_bf16 v[36:51], v[108:111], v[124:127], v[36:51]
    ds_read_b128 v[108:111], v20 offset:34816
    s_waitcnt lgkmcnt(4)
    v_mfma_f32_32x32x16_bf16 v[52:67], v[112:115], v[124:127], v[52:67]
    ds_read_b128 v[112:115], v20 offset:38912
    s_waitcnt lgkmcnt(4)
    v_mfma_f32_32x32x16_bf16 v[68:83], v[116:119], v[124:127], v[68:83]
    ds_read_b128 v[116:119], v20 offset:43008
    s_waitcnt lgkmcnt(4)
    v_mfma_f32_32x32x16_bf16 v[84:99], v[120:123], v[124:127], v[84:99]
    ds_read_b128 v[120:123], v20 offset:47104
    s_waitcnt lgkmcnt(10)
    v_mfma_f32_16x16x32_bf16 v[100:103], v[132:135], v[136:139], v[100:103]
    v_mfma_f32_16x16x32_bf16 v[104:107], v[132:135], v[140:143], v[104:107]
    ds_read_b128 v[132:135], v28 offset:34816
    ds_read_b128 v[136:139], v30 offset:34816
    ds_read_b128 v[140:143], v30 offset:36864
    ds_read_b128 v[124:127], v25 offset:34816
    s_waitcnt lgkmcnt(7)
    v_mfma_f32_32x32x16_bf16 v[36:51], v[108:111], v[128:131], v[36:51]
    ds_read_b128 v[108:111], v21 offset:34816
    s_waitcnt lgkmcnt(7)
    v_mfma_f32_32x32x16_bf16 v[52:67], v[112:115], v[128:131], v[52:67]
    ds_read_b128 v[112:115], v21 offset:38912
    s_waitcnt lgkmcnt(7)
    v_mfma_f32_32x32x16_bf16 v[68:83], v[116:119], v[128:131], v[68:83]
    ds_read_b128 v[116:119], v21 offset:43008
    s_waitcnt lgkmcnt(7)
    v_mfma_f32_32x32x16_bf16 v[84:99], v[120:123], v[128:131], v[84:99]
    ds_read_b128 v[120:123], v21 offset:47104
    ds_read_b128 v[128:131], v26 offset:34816
    s_waitcnt lgkmcnt(4)
    v_mfma_f32_32x32x16_bf16 v[36:51], v[108:111], v[124:127], v[36:51]
    ds_read_b128 v[108:111], v22 offset:34816
    s_waitcnt lgkmcnt(4)
    v_mfma_f32_32x32x16_bf16 v[52:67], v[112:115], v[124:127], v[52:67]
    ds_read_b128 v[112:115], v22 offset:38912
    s_waitcnt lgkmcnt(4)
    v_mfma_f32_32x32x16_bf16 v[68:83], v[116:119], v[124:127], v[68:83]
    ds_read_b128 v[116:119], v22 offset:43008
    s_waitcnt lgkmcnt(4)
    v_mfma_f32_32x32x16_bf16 v[84:99], v[120:123], v[124:127], v[84:99]
    ds_read_b128 v[120:123], v22 offset:47104
    s_waitcnt lgkmcnt(10)
    v_mfma_f32_16x16x32_bf16 v[100:103], v[132:135], v[136:139], v[100:103]
    v_mfma_f32_16x16x32_bf16 v[104:107], v[132:135], v[140:143], v[104:107]
    v_add_u32 v19, 69632, v19
    v_add_u32 v20, 69632, v20
    v_add_u32 v21, 69632, v21
    v_add_u32 v22, 69632, v22
    v_add_u32 v23, 69632, v23
    v_add_u32 v24, 69632, v24
    v_add_u32 v25, 69632, v25
    v_add_u32 v26, 69632, v26
    v_add_u32 v27, 69632, v27
    v_add_u32 v28, 69632, v28
    v_add_u32 v29, 69632, v29
    v_add_u32 v30, 69632, v30
    ds_read_b128 v[132:135], v27 offset:0
    ds_read_b128 v[136:139], v29 offset:0
    ds_read_b128 v[140:143], v29 offset:2048
    ds_read_b128 v[124:127], v23 offset:0
    s_waitcnt lgkmcnt(7)
    v_mfma_f32_32x32x16_bf16 v[36:51], v[108:111], v[128:131], v[36:51]
    ds_read_b128 v[108:111], v19 offset:0
    s_waitcnt lgkmcnt(7)
    v_mfma_f32_32x32x16_bf16 v[52:67], v[112:115], v[128:131], v[52:67]
    ds_read_b128 v[112:115], v19 offset:4096
    s_waitcnt lgkmcnt(7)
    v_mfma_f32_32x32x16_bf16 v[68:83], v[116:119], v[128:131], v[68:83]
    ds_read_b128 v[116:119], v19 offset:8192
    s_waitcnt lgkmcnt(7)
    v_mfma_f32_32x32x16_bf16 v[84:99], v[120:123], v[128:131], v[84:99]
    ds_read_b128 v[120:123], v19 offset:12288
    s_waitcnt vmcnt(0)
    s_barrier
    ds_read_b128 v[128:131], v24 offset:0
    s_waitcnt lgkmcnt(4)
    v_mfma_f32_32x32x16_bf16 v[36:51], v[108:111], v[124:127], v[36:51]
    ds_read_b128 v[108:111], v20 offset:0
    s_waitcnt lgkmcnt(4)
    v_mfma_f32_32x32x16_bf16 v[52:67], v[112:115], v[124:127], v[52:67]
    ds_read_b128 v[112:115], v20 offset:4096
    s_waitcnt lgkmcnt(4)
    v_mfma_f32_32x32x16_bf16 v[68:83], v[116:119], v[124:127], v[68:83]
    ds_read_b128 v[116:119], v20 offset:8192
    s_waitcnt lgkmcnt(4)
    v_mfma_f32_32x32x16_bf16 v[84:99], v[120:123], v[124:127], v[84:99]
    ds_read_b128 v[120:123], v20 offset:12288
    s_waitcnt lgkmcnt(10)
    v_mfma_f32_16x16x32_bf16 v[100:103], v[132:135], v[136:139], v[100:103]
    v_mfma_f32_16x16x32_bf16 v[104:107], v[132:135], v[140:143], v[104:107]
    ds_read_b128 v[132:135], v28 offset:0
    ds_read_b128 v[136:139], v30 offset:0
    ds_read_b128 v[140:143], v30 offset:2048
    ds_read_b128 v[124:127], v25 offset:0
    s_waitcnt lgkmcnt(7)
    v_mfma_f32_32x32x16_bf16 v[36:51], v[108:111], v[128:131], v[36:51]
    ds_read_b128 v[108:111], v21 offset:0
    s_waitcnt lgkmcnt(7)
    v_mfma_f32_32x32x16_bf16 v[52:67], v[112:115], v[128:131], v[52:67]
    ds_read_b128 v[112:115], v21 offset:4096
    s_waitcnt lgkmcnt(7)
    v_mfma_f32_32x32x16_bf16 v[68:83], v[116:119], v[128:131], v[68:83]
    ds_read_b128 v[116:119], v21 offset:8192
    s_waitcnt lgkmcnt(7)
    v_mfma_f32_32x32x16_bf16 v[84:99], v[120:123], v[128:131], v[84:99]
    ds_read_b128 v[120:123], v21 offset:12288
    ds_read_b128 v[128:131], v26 offset:0
    s_waitcnt lgkmcnt(4)
    v_mfma_f32_32x32x16_bf16 v[36:51], v[108:111], v[124:127], v[36:51]
    ds_read_b128 v[108:111], v22 offset:0
    s_waitcnt lgkmcnt(4)
    v_mfma_f32_32x32x16_bf16 v[52:67], v[112:115], v[124:127], v[52:67]
    ds_read_b128 v[112:115], v22 offset:4096
    s_waitcnt lgkmcnt(4)
    v_mfma_f32_32x32x16_bf16 v[68:83], v[116:119], v[124:127], v[68:83]
    ds_read_b128 v[116:119], v22 offset:8192
    s_waitcnt lgkmcnt(4)
    v_mfma_f32_32x32x16_bf16 v[84:99], v[120:123], v[124:127], v[84:99]
    ds_read_b128 v[120:123], v22 offset:12288
    s_waitcnt lgkmcnt(10)
    v_mfma_f32_16x16x32_bf16 v[100:103], v[132:135], v[136:139], v[100:103]
    v_mfma_f32_16x16x32_bf16 v[104:107], v[132:135], v[140:143], v[104:107]
    ds_read_b128 v[132:135], v27 offset:34816
    ds_read_b128 v[136:139], v29 offset:34816
    ds_read_b128 v[140:143], v29 offset:36864
    ds_read_b128 v[124:127], v23 offset:34816
    s_waitcnt lgkmcnt(7)
    v_mfma_f32_32x32x16_bf16 v[36:51], v[108:111], v[128:131], v[36:51]
    ds_read_b128 v[108:111], v19 offset:34816
    s_waitcnt lgkmcnt(7)
    v_mfma_f32_32x32x16_bf16 v[52:67], v[112:115], v[128:131], v[52:67]
    ds_read_b128 v[112:115], v19 offset:38912
    s_waitcnt lgkmcnt(7)
    v_mfma_f32_32x32x16_bf16 v[68:83], v[116:119], v[128:131], v[68:83]
    ds_read_b128 v[116:119], v19 offset:43008
    s_waitcnt lgkmcnt(7)
    v_mfma_f32_32x32x16_bf16 v[84:99], v[120:123], v[128:131], v[84:99]
    ds_read_b128 v[120:123], v19 offset:47104
    s_barrier
    ds_read_b128 v[128:131], v24 offset:34816
    s_waitcnt lgkmcnt(4)
    v_mfma_f32_32x32x16_bf16 v[36:51], v[108:111], v[124:127], v[36:51]
    ds_read_b128 v[108:111], v20 offset:34816
    s_waitcnt lgkmcnt(4)
    v_mfma_f32_32x32x16_bf16 v[52:67], v[112:115], v[124:127], v[52:67]
    ds_read_b128 v[112:115], v20 offset:38912
    s_waitcnt lgkmcnt(4)
    v_mfma_f32_32x32x16_bf16 v[68:83], v[116:119], v[124:127], v[68:83]
    ds_read_b128 v[116:119], v20 offset:43008
    s_waitcnt lgkmcnt(4)
    v_mfma_f32_32x32x16_bf16 v[84:99], v[120:123], v[124:127], v[84:99]
    ds_read_b128 v[120:123], v20 offset:47104
    s_waitcnt lgkmcnt(10)
    v_mfma_f32_16x16x32_bf16 v[100:103], v[132:135], v[136:139], v[100:103]
    v_mfma_f32_16x16x32_bf16 v[104:107], v[132:135], v[140:143], v[104:107]
    ds_read_b128 v[132:135], v28 offset:34816
    ds_read_b128 v[136:139], v30 offset:34816
    ds_read_b128 v[140:143], v30 offset:36864
    ds_read_b128 v[124:127], v25 offset:34816
    s_waitcnt lgkmcnt(7)
    v_mfma_f32_32x32x16_bf16 v[36:51], v[108:111], v[128:131], v[36:51]
    ds_read_b128 v[108:111], v21 offset:34816
    s_waitcnt lgkmcnt(7)
    v_mfma_f32_32x32x16_bf16 v[52:67], v[112:115], v[128:131], v[52:67]
    ds_read_b128 v[112:115], v21 offset:38912
    s_waitcnt lgkmcnt(7)
    v_mfma_f32_32x32x16_bf16 v[68:83], v[116:119], v[128:131], v[68:83]
    ds_read_b128 v[116:119], v21 offset:43008
    s_waitcnt lgkmcnt(7)
    v_mfma_f32_32x32x16_bf16 v[84:99], v[120:123], v[128:131], v[84:99]
    ds_read_b128 v[120:123], v21 offset:47104
    ds_read_b128 v[128:131], v26 offset:34816
    s_waitcnt lgkmcnt(4)
    v_mfma_f32_32x32x16_bf16 v[36:51], v[108:111], v[124:127], v[36:51]
    ds_read_b128 v[108:111], v22 offset:34816
    s_waitcnt lgkmcnt(4)
    v_mfma_f32_32x32x16_bf16 v[52:67], v[112:115], v[124:127], v[52:67]
    ds_read_b128 v[112:115], v22 offset:38912
    s_waitcnt lgkmcnt(4)
    v_mfma_f32_32x32x16_bf16 v[68:83], v[116:119], v[124:127], v[68:83]
    ds_read_b128 v[116:119], v22 offset:43008
    s_waitcnt lgkmcnt(4)
    v_mfma_f32_32x32x16_bf16 v[84:99], v[120:123], v[124:127], v[84:99]
    ds_read_b128 v[120:123], v22 offset:47104
    s_waitcnt lgkmcnt(10)
    v_mfma_f32_16x16x32_bf16 v[100:103], v[132:135], v[136:139], v[100:103]
    v_mfma_f32_16x16x32_bf16 v[104:107], v[132:135], v[140:143], v[104:107]
    s_waitcnt lgkmcnt(3)
    v_mfma_f32_32x32x16_bf16 v[36:51], v[108:111], v[128:131], v[36:51]
    s_waitcnt lgkmcnt(2)
    v_mfma_f32_32x32x16_bf16 v[52:67], v[112:115], v[128:131], v[52:67]
    s_waitcnt lgkmcnt(1)
    v_mfma_f32_32x32x16_bf16 v[68:83], v[116:119], v[128:131], v[68:83]
    s_waitcnt lgkmcnt(0)
    v_mfma_f32_32x32x16_bf16 v[84:99], v[120:123], v[128:131], v[84:99]
    s_waitcnt vmcnt(0)
    s_nop 7
    s_nop 3
    v_lshlrev_b32 v31, 16, v31
    v_lshlrev_b32 v32, 16, v32
    v_lshlrev_b32 v33, 16, v33
    s_lshl_b32 s39, s29, 5
    v_add_u32 v8, s39, v3
    v_mul_u32_u24 v8, 592, v8
    v_lshl_add_u32 v8, v4, 4, v8
    v_add_u32 v9, s39, v5
    v_mul_u32_u24 v9, 592, v9
    v_lshl_add_u32 v9, v6, 4, v9
    v_add_f32 v36, v36, v33
    v_add_f32 v37, v37, v33
    v_add_f32 v38, v38, v33
    v_add_f32 v39, v39, v33
    v_add_f32 v40, v40, v33
    v_add_f32 v41, v41, v33
    v_add_f32 v42, v42, v33
    v_add_f32 v43, v43, v33
    v_add_f32 v44, v44, v33
    v_add_f32 v45, v45, v33
    v_add_f32 v46, v46, v33
    v_add_f32 v47, v47, v33
    v_add_f32 v48, v48, v33
    v_add_f32 v49, v49, v33
    v_add_f32 v50, v50, v33
    v_add_f32 v51, v51, v33
    v_add_f32 v52, v52, v33
    v_add_f32 v53, v53, v33
    v_add_f32 v54, v54, v33
    v_add_f32 v55, v55, v33
    v_add_f32 v56, v56, v33
    v_add_f32 v57, v57, v33
    v_add_f32 v58, v58, v33
    v_add_f32 v59, v59, v33
    v_add_f32 v60, v60, v33
    v_add_f32 v61, v61, v33
    v_add_f32 v62, v62, v33
    v_add_f32 v63, v63, v33
    v_add_f32 v64, v64, v33
    v_add_f32 v65, v65, v33
    v_add_f32 v66, v66, v33
    v_add_f32 v67, v67, v33
    v_add_f32 v68, v68, v33
    v_add_f32 v69, v69, v33
    v_add_f32 v70, v70, v33
    v_add_f32 v71, v71, v33
    v_add_f32 v72, v72, v33
    v_add_f32 v73, v73, v33
    v_add_f32 v74, v74, v33
    v_add_f32 v75, v75, v33
    v_add_f32 v76, v76, v33
    v_add_f32 v77, v77, v33
    v_add_f32 v78, v78, v33
    v_add_f32 v79, v79, v33
    v_add_f32 v80, v80, v33
    v_add_f32 v81, v81, v33
    v_add_f32 v82, v82, v33
    v_add_f32 v83, v83, v33
    v_add_f32 v84, v84, v33
    v_add_f32 v85, v85, v33
    v_add_f32 v86, v86, v33
    v_add_f32 v87, v87, v33
    v_add_f32 v88, v88, v33
    v_add_f32 v89, v89, v33
    v_add_f32 v90, v90, v33
    v_add_f32 v91, v91, v33
    v_add_f32 v92, v92, v33
    v_add_f32 v93, v93, v33
    v_add_f32 v94, v94, v33
    v_add_f32 v95, v95, v33
    v_add_f32 v96, v96, v33
    v_add_f32 v97, v97, v33
    v_add_f32 v98, v98, v33
    v_add_f32 v99, v99, v33
    v_add_f32 v100, v100, v31
    v_add_f32 v101, v101, v31
    v_add_f32 v102, v102, v31
    v_add_f32 v103, v103, v31
    v_add_f32 v104, v104, v32
    v_add_f32 v105, v105, v32
    v_add_f32 v106, v106, v32
    v_add_f32 v107, v107, v32
    s_barrier
    ds_write_b128 v9, v[36:39] offset:0
    ds_write_b128 v9, v[40:43] offset:32
    ds_write_b128 v9, v[44:47] offset:64
    ds_write_b128 v9, v[48:51] offset:96
    ds_write_b128 v9, v[52:55] offset:128
    ds_write_b128 v9, v[56:59] offset:160
    ds_write_b128 v9, v[60:63] offset:192
    ds_write_b128 v9, v[64:67] offset:224
    ds_write_b128 v9, v[68:71] offset:256
    ds_write_b128 v9, v[72:75] offset:288
    ds_write_b128 v9, v[76:79] offset:320
    ds_write_b128 v9, v[80:83] offset:352
    ds_write_b128 v9, v[84:87] offset:384
    ds_write_b128 v9, v[88:91] offset:416
    ds_write_b128 v9, v[92:95] offset:448
    ds_write_b128 v9, v[96:99] offset:480
    ds_write_b128 v8, v[100:103] offset:512
    ds_write_b128 v8, v[104:107] offset:9984
    s_waitcnt lgkmcnt(0)
    s_branch kf_coop2
kf_coop:
    s_barrier
kf_coop2:
    s_and_b32 s39, s2, 7
    s_lshr_b32 s40, s2, 3
    s_and_b32 s41, s39, 3
    s_lshl_b32 s41, s41, 2
    s_and_b32 s42, s40, 3
    s_add_u32 s31, s41, s42
    s_lshr_b32 s41, s39, 2
    s_lshl_b32 s41, s41, 3
    s_lshr_b32 s42, s40, 2
    s_add_u32 s32, s41, s42
    s_mul_i32 s33, s31, 288
    s_lshl_b32 s34, s32, 7
    s_mul_i32 s42, s34, 4608
    s_add_u32 s42, s42, s33
    s_add_u32 s42, s42, 4194304
    s_mul_i32 s43, s34, 5760
    s_add_u32 s43, s43, s33
    s_add_u32 s43, s43, 35652736
    s_movk_i32 s40, 4608
    s_movk_i32 s41, 5760
    v_add_u32 v52, 0, v0
    v_mul_u32_u24 v53, 3641, v52
    v_lshrrev_b32 v53, 16, v53
    v_mul_u32_u24 v54, 18, v53
    v_sub_u32 v54, v52, v54
    v_lshlrev_b32 v55, 4, v54
    v_mad_u32_u24 v52, v53, s40, v55
    buffer_load_dwordx4 v[8:11], v52, s[24:27], s42 offen
    v_mad_u32_u24 v44, v53, s41, v55
    v_mul_u32_u24 v48, 592, v53
    v_lshl_add_u32 v48, v54, 5, v48
    v_add_u32 v52, 768, v0
    v_mul_u32_u24 v53, 3641, v52
    v_lshrrev_b32 v53, 16, v53
    v_mul_u32_u24 v54, 18, v53
    v_sub_u32 v54, v52, v54
    v_lshlrev_b32 v55, 4, v54
    v_mad_u32_u24 v52, v53, s40, v55
    buffer_load_dwordx4 v[12:15], v52, s[24:27], s42 offen
    v_mad_u32_u24 v45, v53, s41, v55
    v_mul_u32_u24 v49, 592, v53
    v_lshl_add_u32 v49, v54, 5, v49
    v_add_u32 v52, 1536, v0
    v_mul_u32_u24 v53, 3641, v52
    v_lshrrev_b32 v53, 16, v53
    v_mul_u32_u24 v54, 18, v53
    v_sub_u32 v54, v52, v54
    v_lshlrev_b32 v55, 4, v54
    v_mad_u32_u24 v52, v53, s40, v55
    buffer_load_dwordx4 v[16:19], v52, s[24:27], s42 offen
    v_mad_u32_u24 v46, v53, s41, v55
    v_mul_u32_u24 v50, 592, v53
    v_lshl_add_u32 v50, v54, 5, v50
    s_waitcnt lgkmcnt(0)
    s_barrier
    ds_read_b128 v[20:23], v48
    ds_read_b128 v[24:27], v48 offset:16
    ds_read_b128 v[28:31], v49
    ds_read_b128 v[32:35], v49 offset:16
    ds_read_b128 v[36:39], v50
    ds_read_b128 v[40:43], v50 offset:16
    s_waitcnt vmcnt(2) lgkmcnt(4)
    v_lshlrev_b32 v52, 16, v8
    v_and_b32 v53, 0xffff0000, v8
    v_mul_f32 v52, v52, v20
    v_mul_f32 v53, v53, v21
    v_cvt_pk_bf16_f32 v8, v52, v53
    v_lshlrev_b32 v52, 16, v9
    v_and_b32 v53, 0xffff0000, v9
    v_mul_f32 v52, v52, v22
    v_mul_f32 v53, v53, v23
    v_cvt_pk_bf16_f32 v9, v52, v53
    v_lshlrev_b32 v52, 16, v10
    v_and_b32 v53, 0xffff0000, v10
    v_mul_f32 v52, v52, v24
    v_mul_f32 v53, v53, v25
    v_cvt_pk_bf16_f32 v10, v52, v53
    v_lshlrev_b32 v52, 16, v11
    v_and_b32 v53, 0xffff0000, v11
    v_mul_f32 v52, v52, v26
    v_mul_f32 v53, v53, v27
    v_cvt_pk_bf16_f32 v11, v52, v53
    s_waitcnt vmcnt(1) lgkmcnt(2)
    v_lshlrev_b32 v52, 16, v12
    v_and_b32 v53, 0xffff0000, v12
    v_mul_f32 v52, v52, v28
    v_mul_f32 v53, v53, v29
    v_cvt_pk_bf16_f32 v12, v52, v53
    v_lshlrev_b32 v52, 16, v13
    v_and_b32 v53, 0xffff0000, v13
    v_mul_f32 v52, v52, v30
    v_mul_f32 v53, v53, v31
    v_cvt_pk_bf16_f32 v13, v52, v53
    v_lshlrev_b32 v52, 16, v14
    v_and_b32 v53, 0xffff0000, v14
    v_mul_f32 v52, v52, v32
    v_mul_f32 v53, v53, v33
    v_cvt_pk_bf16_f32 v14, v52, v53
    v_lshlrev_b32 v52, 16, v15
    v_and_b32 v53, 0xffff0000, v15
    v_mul_f32 v52, v52, v34
    v_mul_f32 v53, v53, v35
    v_cvt_pk_bf16_f32 v15, v52, v53
    s_waitcnt vmcnt(0) lgkmcnt(0)
    v_lshlrev_b32 v52, 16, v16
    v_and_b32 v53, 0xffff0000, v16
    v_mul_f32 v52, v52, v36
    v_mul_f32 v53, v53, v37
    v_cvt_pk_bf16_f32 v16, v52, v53
    v_lshlrev_b32 v52, 16, v17
    v_and_b32 v53, 0xffff0000, v17
    v_mul_f32 v52, v52, v38
    v_mul_f32 v53, v53, v39
    v_cvt_pk_bf16_f32 v17, v52, v53
    v_lshlrev_b32 v52, 16, v18
    v_and_b32 v53, 0xffff0000, v18
    v_mul_f32 v52, v52, v40
    v_mul_f32 v53, v53, v41
    v_cvt_pk_bf16_f32 v18, v52, v53
    v_lshlrev_b32 v52, 16, v19
    v_and_b32 v53, 0xffff0000, v19
    v_mul_f32 v52, v52, v42
    v_mul_f32 v53, v53, v43
    v_cvt_pk_bf16_f32 v19, v52, v53
    buffer_store_dwordx4 v[8:11], v44, s[24:27], s43 offen
    buffer_store_dwordx4 v[12:15], v45, s[24:27], s43 offen
    buffer_store_dwordx4 v[16:19], v46, s[24:27], s43 offen
kf_end:
    s_endpgm
.text
.globl k4_kernel
.p2align 8
.type k4_kernel,@function
k4_kernel:
    s_cmp_ge_u32 s2, 192
    s_cbranch_scc1 k4_end
    s_load_dwordx2 s[4:5], s[0:1], 0
    s_load_dwordx2 s[6:7], s[0:1], 32
    s_load_dwordx4 s[8:11], s[0:1], 72
    s_load_dwordx2 s[14:15], s[0:1], 96
    v_lshrrev_b32 v4, 6, v0
    v_and_b32 v1, 63, v0
    s_nop 0
    v_readfirstlane_b32 s28, v4
    v_and_b32 v2, 15, v1
    v_lshrrev_b32 v3, 4, v1
    s_and_b32 s29, s28, 1
    s_lshr_b32 s30, s28, 1
    s_and_b32 s39, s2, 7
    s_lshr_b32 s40, s2, 3
    s_lshl_b32 s39, s39, 2
    s_and_b32 s41, s40, 3
    s_add_u32 s31, s39, s41
    s_lshr_b32 s32, s40, 2
    s_lshl_b32 s33, s31, 6
    s_mul_i32 s34, s32, 96
    v_lshrrev_b32 v4, 3, v1
    v_and_b32 v5, 7, v1
    v_lshrrev_b32 v6, 1, v4
    v_xor_b32 v5, v5, v6
    v_mul_u32_u24 v4, 5760, v4
    v_lshl_add_u32 v12, v5, 4, v4
    v_xor_b32 v5, 4, v5
    v_lshl_add_u32 v13, v5, 4, v4
    v_add_u32 v4, 0, v1
    v_mul_u32_u24 v5, 5462, v4
    v_lshrrev_b32 v5, 16, v5
    v_mul_u32_u24 v6, 12, v5
    v_sub_u32 v6, v4, v6
    v_bfe_u32 v7, v5, 3, 1
    v_lshlrev_b32 v7, 1, v7
    v_xor_b32 v6, v6, v7
    v_mul_u32_u24 v5, 1152, v5
    v_lshl_add_u32 v14, v6, 4, v5
    v_add_u32 v4, 64, v1
    v_mul_u32_u24 v5, 5462, v4
    v_lshrrev_b32 v5, 16, v5
    v_mul_u32_u24 v6, 12, v5
    v_sub_u32 v6, v4, v6
    v_bfe_u32 v7, v5, 3, 1
    v_lshlrev_b32 v7, 1, v7
    v_xor_b32 v6, v6, v7
    v_mul_u32_u24 v5, 1152, v5
    v_lshl_add_u32 v15, v6, 4, v5
    v_add_u32 v4, 128, v1
    v_mul_u32_u24 v5, 5462, v4
    v_lshrrev_b32 v5, 16, v5
    v_mul_u32_u24 v6, 12, v5
    v_sub_u32 v6, v4, v6
    v_bfe_u32 v7, v5, 3, 1
    v_lshlrev_b32 v7, 1, v7
    v_xor_b32 v6, v6, v7
    v_mul_u32_u24 v5, 1152, v5
    v_lshl_add_u32 v16, v6, 4, v5
    v_bfe_u32 v5, v2, 1, 3
    v_xor_b32 v4, v3, v5
    s_lshl_b32 s39, s29, 5
    v_add_u32 v6, s39, v2
    v_lshlrev_b32 v6, 7, v6
    v_lshl_add_u32 v17, v4, 4, v6
    v_xor_b32 v4, 4, v4
    v_lshl_add_u32 v18, v4, 4, v6
    v_add_u32 v19, 61440, v17
    v_add_u32 v20, 61440, v18
    v_add_u32 v21, 122880, v17
    v_add_u32 v22, 122880, v18
    v_bfe_u32 v4, v1, 2, 2
    v_lshl_add_u32 v4, v3, 3, v4
    v_mul_u32_u24 v4, 192, v4
    v_and_b32 v5, 3, v1
    v_lshl_add_u32 v4, v5, 3, v4
    v_add_u32 v4, 8192, v4
    v_and_b32 v5, 1, v3
    s_mul_i32 s39, s30, 3
    s_add_u32 s40, s39, 0
    v_xor_b32 v6, s40, v5
    v_lshl_add_u32 v144, v6, 5, v4
    v_add_u32 v147, 61440, v144
    v_add_u32 v150, 122880, v144
    s_add_u32 s40, s39, 1
    v_xor_b32 v6, s40, v5
    v_lshl_add_u32 v145, v6, 5, v4
    v_add_u32 v148, 61440, v145
    v_add_u32 v151, 122880, v145
    s_add_u32 s40, s39, 2
    v_xor_b32 v6, s40, v5
    v_lshl_add_u32 v146, v6, 5, v4
    v_add_u32 v149, 61440, v146
    v_add_u32 v152, 122880, v146
    s_waitcnt lgkmcnt(0)
    s_mov_b32 s16, s4
    s_mov_b32 s17, s5
    s_mov_b32 s18, 2359296
    s_mov_b32 s19, 0x00020000
    s_mov_b32 s20, s6
    s_mov_b32 s21, s7
    s_mov_b32 s22, 663552
    s_mov_b32 s23, 0x00020000
    s_mov_b32 s24, s14
    s_mov_b32 s25, s15
    s_mov_b32 s26, 0x10000000
    s_mov_b32 s27, 0x00020000
    s_mov_b32 s52, s8
    s_mov_b32 s53, s9
    s_mov_b32 s54, 2654208
    s_mov_b32 s55, 0x00020000
    s_mov_b32 s56, s10
    s_mov_b32 s57, s11
    s_mov_b32 s58, 2359296
    s_mov_b32 s59, 0x00020000
    s_lshl_b32 s39, s28, 4
    s_add_u32 s40, s33, s39
    s_mul_i32 s44, s40, 5760
    s_add_u32 s44, s44, 35651584
    s_mul_i32 s46, s39, 1152
    s_lshl_b32 s40, s34, 1
    s_add_u32 s46, s46, s40
    s_lshl_b32 s47, s28, 11
    s_mul_i32 s49, s28, 3072
    s_add_u32 s49, s49, 8192
    s_add_u32 m0, s47, 0
    s_add_u32 s50, s44, 0
    buffer_load_dwordx4 v12, s[24:27], s50 offen lds
    s_add_u32 m0, s47, 1024
    s_add_u32 s50, s44, 46080
    buffer_load_dwordx4 v13, s[24:27], s50 offen lds
    s_add_u32 s50, s46, 0
    s_add_u32 m0, s49, 0
    s_nop 0
    buffer_load_dwordx4 v14, s[20:23], s50 offen lds
    s_add_u32 m0, s49, 1024
    s_nop 0
    buffer_load_dwordx4 v15, s[20:23], s50 offen lds
    s_add_u32 m0, s49, 2048
    s_nop 0
    buffer_load_dwordx4 v16, s[20:23], s50 offen lds
    s_add_u32 m0, s47, 20480
    s_add_u32 s50, s44, 128
    buffer_load_dwordx4 v12, s[24:27], s50 offen lds
    s_add_u32 m0, s47, 21504
    s_add_u32 s50, s44, 46208
    buffer_load_dwordx4 v13, s[24:27], s50 offen lds
    s_add_u32 s50, s46, 73728
    s_add_u32 m0, s49, 20480
    s_nop 0
    buffer_load_dwordx4 v14, s[20:23], s50 offen lds
    s_add_u32 m0, s49, 21504
    s_nop 0
    buffer_load_dwordx4 v15, s[20:23], s50 offen lds
    s_add_u32 m0, s49, 22528
    s_nop 0
    buffer_load_dwordx4 v16, s[20:23], s50 offen lds
    s_add_u32 m0, s47, 40960
    s_add_u32 s50, s44, 256
    buffer_load_dwordx4 v12, s[24:27], s50 offen lds
    s_add_u32 m0, s47, 41984
    s_add_u32 s50, s44, 46336
    buffer_load_dwordx4 v13, s[24:27], s50 offen lds
    s_add_u32 s50, s46, 147456
    s_add_u32 m0, s49, 40960
    s_nop 0
    buffer_load_dwordx4 v14, s[20:23], s50 offen lds
    s_add_u32 m0, s49, 41984
    s_nop 0
    buffer_load_dwordx4 v15, s[20:23], s50 offen lds
    s_add_u32 m0, s49, 43008
    s_nop 0
    buffer_load_dwordx4 v16, s[20:23], s50 offen lds
    s_add_u32 m0, s47, 61440
    s_add_u32 s50, s44, 384
    buffer_load_dwordx4 v12, s[24:27], s50 offen lds
    s_add_u32 m0, s47, 62464
    s_add_u32 s50, s44, 46464
    buffer_load_dwordx4 v13, s[24:27], s50 offen lds
    s_add_u32 s50, s46, 221184
    s_add_u32 m0, s49, 61440
    s_nop 0
    buffer_load_dwordx4 v14, s[20:23], s50 offen lds
    s_add_u32 m0, s49, 62464
    s_nop 0
    buffer_load_dwordx4 v15, s[20:23], s50 offen lds
    s_add_u32 m0, s49, 63488
    s_nop 0
    buffer_load_dwordx4 v16, s[20:23], s50 offen lds
    s_add_u32 m0, s47, 81920
    s_add_u32 s50, s44, 512
    buffer_load_dwordx4 v12, s[24:27], s50 offen lds
    s_add_u32 m0, s47, 82944
    s_add_u32 s50, s44, 46592
    buffer_load_dwordx4 v13, s[24:27], s50 offen lds
    s_add_u32 s50, s46, 294912
    s_add_u32 m0, s49, 81920
    s_nop 0
    buffer_load_dwordx4 v14, s[20:23], s50 offen lds
    s_add_u32 m0, s49, 82944
    s_nop 0
    buffer_load_dwordx4 v15, s[20:23], s50 offen lds
    s_add_u32 m0, s49, 83968
    s_nop 0
    buffer_load_dwordx4 v16, s[20:23], s50 offen lds
    s_add_u32 m0, s47, 102400
    s_add_u32 s50, s44, 640
    buffer_load_dwordx4 v12, s[24:27], s50 offen lds
    s_add_u32 m0, s47, 103424
    s_add_u32 s50, s44, 46720
    buffer_load_dwordx4 v13, s[24:27], s50 offen lds
    s_add_u32 s50, s46, 368640
    s_add_u32 m0, s49, 102400
    s_nop 0
    buffer_load_dwordx4 v14, s[20:23], s50 offen lds
    s_add_u32 m0, s49, 103424
    s_nop 0
    buffer_load_dwordx4 v15, s[20:23], s50 offen lds
    s_add_u32 m0, s49, 104448
    s_nop 0
    buffer_load_dwordx4 v16, s[20:23], s50 offen lds
    s_waitcnt vmcnt(25)
    s_barrier
    ds_read_b128 v[52:55], v17 offset:0
    ds_read_b128 v[56:59], v17 offset:2048
    ds_read_b64_tr_b16 v[84:85], v144 offset:0
    ds_read_b64_tr_b16 v[86:87], v144 offset:768
    ds_read_b64_tr_b16 v[88:89], v145 offset:0
    ds_read_b64_tr_b16 v[90:91], v145 offset:768
    ds_read_b64_tr_b16 v[92:93], v146 offset:0
    ds_read_b64_tr_b16 v[94:95], v146 offset:768
    ds_read_b128 v[60:63], v18 offset:0
    ds_read_b128 v[64:67], v18 offset:2048
    ds_read_b64_tr_b16 v[96:97], v144 offset:6144
    ds_read_b64_tr_b16 v[98:99], v144 offset:6912
    ds_read_b64_tr_b16 v[100:101], v145 offset:6144
    ds_read_b64_tr_b16 v[102:103], v145 offset:6912
    ds_read_b64_tr_b16 v[104:105], v146 offset:6144
    ds_read_b64_tr_b16 v[106:107], v146 offset:6912
    s_waitcnt vmcnt(20) lgkmcnt(0)
    s_barrier
    ds_read_b128 v[68:71], v17 offset:20480
    ds_read_b128 v[72:75], v17 offset:22528
    ds_read_b64_tr_b16 v[108:109], v144 offset:20480
    ds_read_b64_tr_b16 v[110:111], v144 offset:21248
    ds_read_b64_tr_b16 v[112:113], v145 offset:20480
    ds_read_b64_tr_b16 v[114:115], v145 offset:21248
    ds_read_b64_tr_b16 v[116:117], v146 offset:20480
    ds_read_b64_tr_b16 v[118:119], v146 offset:21248
    ds_read_b128 v[76:79], v18 offset:20480
    ds_read_b128 v[80:83], v18 offset:22528
    ds_read_b64_tr_b16 v[120:121], v144 offset:26624
    ds_read_b64_tr_b16 v[122:123], v144 offset:27392
    ds_read_b64_tr_b16 v[124:125], v145 offset:26624
    ds_read_b64_tr_b16 v[126:127], v145 offset:27392
    ds_read_b64_tr_b16 v[128:129], v146 offset:26624
    ds_read_b64_tr_b16 v[130:131], v146 offset:27392
    s_add_u32 m0, s47, 122880
    s_add_u32 s50, s44, 768
    buffer_load_dwordx4 v12, s[24:27], s50 offen lds
    s_add_u32 m0, s47, 123904
    s_add_u32 s50, s44, 46848
    buffer_load_dwordx4 v13, s[24:27], s50 offen lds
    s_add_u32 s50, s46, 442368
    s_add_u32 m0, s49, 122880
    s_nop 0
    buffer_load_dwordx4 v14, s[20:23], s50 offen lds
    s_add_u32 m0, s49, 123904
    s_nop 0
    buffer_load_dwordx4 v15, s[20:23], s50 offen lds
    s_add_u32 m0, s49, 124928
    s_nop 0
    buffer_load_dwordx4 v16, s[20:23], s50 offen lds
    v_mfma_f32_16x16x32_bf16 v[28:31], v[84:87], v[52:55], 0
    v_mfma_f32_16x16x32_bf16 v[32:35], v[84:87], v[56:59], 0
    v_mfma_f32_16x16x32_bf16 v[36:39], v[88:91], v[52:55], 0
    v_mfma_f32_16x16x32_bf16 v[40:43], v[88:91], v[56:59], 0
    v_mfma_f32_16x16x32_bf16 v[44:47], v[92:95], v[52:55], 0
    v_mfma_f32_16x16x32_bf16 v[48:51], v[92:95], v[56:59], 0
    v_mfma_f32_16x16x32_bf16 v[28:31], v[96:99], v[60:63], v[28:31]
    v_mfma_f32_16x16x32_bf16 v[32:35], v[96:99], v[64:67], v[32:35]
    v_mfma_f32_16x16x32_bf16 v[36:39], v[100:103], v[60:63], v[36:39]
    v_mfma_f32_16x16x32_bf16 v[40:43], v[100:103], v[64:67], v[40:43]
    v_mfma_f32_16x16x32_bf16 v[44:47], v[104:107], v[60:63], v[44:47]
    v_mfma_f32_16x16x32_bf16 v[48:51], v[104:107], v[64:67], v[48:51]
    s_waitcnt vmcnt(20) lgkmcnt(0)
    s_barrier
    ds_read_b128 v[52:55], v17 offset:40960
    ds_read_b128 v[56:59], v17 offset:43008
    ds_read_b64_tr_b16 v[84:85], v144 offset:40960
    ds_read_b64_tr_b16 v[86:87], v144 offset:41728
    ds_read_b64_tr_b16 v[88:89], v145 offset:40960
    ds_read_b64_tr_b16 v[90:91], v145 offset:41728
    ds_read_b64_tr_b16 v[92:93], v146 offset:40960
    ds_read_b64_tr_b16 v[94:95], v146 offset:41728
    ds_read_b128 v[60:63], v18 offset:40960
    ds_read_b128 v[64:67], v18 offset:43008
    ds_read_b64_tr_b16 v[96:97], v144 offset:47104
    ds_read_b64_tr_b16 v[98:99], v144 offset:47872
    ds_read_b64_tr_b16 v[100:101], v145 offset:47104
    ds_read_b64_tr_b16 v[102:103], v145 offset:47872
    ds_read_b64_tr_b16 v[104:105], v146 offset:47104
    ds_read_b64_tr_b16 v[106:107], v146 offset:47872
    s_add_u32 m0, s47, 0
    s_add_u32 s50, s44, 896
    buffer_load_dwordx4 v12, s[24:27], s50 offen lds
    s_add_u32 m0, s47, 1024
    s_add_u32 s50, s44, 46976
    buffer_load_dwordx4 v13, s[24:27], s50 offen lds
    s_add_u32 s50, s46, 516096
    s_add_u32 m0, s49, 0
    s_nop 0
    buffer_load_dwordx4 v14, s[20:23], s50 offen lds
    s_add_u32 m0, s49, 1024
    s_nop 0
    buffer_load_dwordx4 v15, s[20:23], s50 offen lds
    s_add_u32 m0, s49, 2048
    s_nop 0
    buffer_load_dwordx4 v16, s[20:23], s50 offen lds
    v_mfma_f32_16x16x32_bf16 v[28:31], v[108:111], v[68:71], v[28:31]
    v_mfma_f32_16x16x32_bf16 v[32:35], v[108:111], v[72:75], v[32:35]
    v_mfma_f32_16x16x32_bf16 v[36:39], v[112:115], v[68:71], v[36:39]
    v_mfma_f32_16x16x32_bf16 v[40:43], v[112:115], v[72:75], v[40:43]
    v_mfma_f32_16x16x32_bf16 v[44:47], v[116:119], v[68:71], v[44:47]
    v_mfma_f32_16x16x32_bf16 v[48:51], v[116:119], v[72:75], v[48:51]
    v_mfma_f32_16x16x32_bf16 v[28:31], v[120:123], v[76:79], v[28:31]
    v_mfma_f32_16x16x32_bf16 v[32:35], v[120:123], v[80:83], v[32:35]
    v_mfma_f32_16x16x32_bf16 v[36:39], v[124:127], v[76:79], v[36:39]
    v_mfma_f32_16x16x32_bf16 v[40:43], v[124:127], v[80:83], v[40:43]
    v_mfma_f32_16x16x32_bf16 v[44:47], v[128:131], v[76:79], v[44:47]
    v_mfma_f32_16x16x32_bf16 v[48:51], v[128:131], v[80:83], v[48:51]
    s_waitcnt vmcnt(20) lgkmcnt(0)
    s_barrier
    ds_read_b128 v[68:71], v19 offset:0
    ds_read_b128 v[72:75], v19 offset:2048
    ds_read_b64_tr_b16 v[108:109], v147 offset:0
    ds_read_b64_tr_b16 v[110:111], v147 offset:768
    ds_read_b64_tr_b16 v[112:113], v148 offset:0
    ds_read_b64_tr_b16 v[114:115], v148 offset:768
    ds_read_b64_tr_b16 v[116:117], v149 offset:0
    ds_read_b64_tr_b16 v[118:119], v149 offset:768
    ds_read_b128 v[76:79], v20 offset:0
    ds_read_b128 v[80:83], v20 offset:2048
    ds_read_b64_tr_b16 v[120:121], v147 offset:6144
    ds_read_b64_tr_b16 v[122:123], v147 offset:6912
    ds_read_b64_tr_b16 v[124:125], v148 offset:6144
    ds_read_b64_tr_b16 v[126:127], v148 offset:6912
    ds_read_b64_tr_b16 v[128:129], v149 offset:6144
    ds_read_b64_tr_b16 v[130:131], v149 offset:6912
    s_add_u32 m0, s47, 20480
    s_add_u32 s50, s44, 1024
    buffer_load_dwordx4 v12, s[24:27], s50 offen lds
    s_add_u32 m0, s47, 21504
    s_add_u32 s50, s44, 47104
    buffer_load_dwordx4 v13, s[24:27], s50 offen lds
    s_add_u32 s50, s46, 589824
    s_add_u32 m0, s49, 20480
    s_nop 0
    buffer_load_dwordx4 v14, s[20:23], s50 offen lds
    s_add_u32 m0, s49, 21504
    s_nop 0
    buffer_load_dwordx4 v15, s[20:23], s50 offen lds
    s_add_u32 m0, s49, 22528
    s_nop 0
    buffer_load_dwordx4 v16, s[20:23], s50 offen lds
    v_mfma_f32_16x16x32_bf16 v[28:31], v[84:87], v[52:55], v[28:31]
    v_mfma_f32_16x16x32_bf16 v[32:35], v[84:87], v[56:59], v[32:35]
    v_mfma_f32_16x16x32_bf16 v[36:39], v[88:91], v[52:55], v[36:39]
    v_mfma_f32_16x16x32_bf16 v[40:43], v[88:91], v[56:59], v[40:43]
    v_mfma_f32_16x16x32_bf16 v[44:47], v[92:95], v[52:55], v[44:47]
    v_mfma_f32_16x16x32_bf16 v[48:51], v[92:95], v[56:59], v[48:51]
    v_mfma_f32_16x16x32_bf16 v[28:31], v[96:99], v[60:63], v[28:31]
    v_mfma_f32_16x16x32_bf16 v[32:35], v[96:99], v[64:67], v[32:35]
    v_mfma_f32_16x16x32_bf16 v[36:39], v[100:103], v[60:63], v[36:39]
    v_mfma_f32_16x16x32_bf16 v[40:43], v[100:103], v[64:67], v[40:43]
    v_mfma_f32_16x16x32_bf16 v[44:47], v[104:107], v[60:63], v[44:47]
    v_mfma_f32_16x16x32_bf16 v[48:51], v[104:107], v[64:67], v[48:51]
    s_waitcnt vmcnt(20) lgkmcnt(0)
    s_barrier
    ds_read_b128 v[52:55], v19 offset:20480
    ds_read_b128 v[56:59], v19 offset:22528
    ds_read_b64_tr_b16 v[84:85], v147 offset:20480
    ds_read_b64_tr_b16 v[86:87], v147 offset:21248
    ds_read_b64_tr_b16 v[88:89], v148 offset:20480
    ds_read_b64_tr_b16 v[90:91], v148 offset:21248
    ds_read_b64_tr_b16 v[92:93], v149 offset:20480
    ds_read_b64_tr_b16 v[94:95], v149 offset:21248
    ds_read_b128 v[60:63], v20 offset:20480
    ds_read_b128 v[64:67], v20 offset:22528
    ds_read_b64_tr_b16 v[96:97], v147 offset:26624
    ds_read_b64_tr_b16 v[98:99], v147 offset:27392
    ds_read_b64_tr_b16 v[100:101], v148 offset:26624
    ds_read_b64_tr_b16 v[102:103], v148 offset:27392
    ds_read_b64_tr_b16 v[104:105], v149 offset:26624
    ds_read_b64_tr_b16 v[106:107], v149 offset:27392
    s_add_u32 m0, s47, 40960
    s_add_u32 s50, s44, 1152
    buffer_load_dwordx4 v12, s[24:27], s50 offen lds
    s_add_u32 m0, s47, 41984
    s_add_u32 s50, s44, 47232
    buffer_load_dwordx4 v13, s[24:27], s50 offen lds
    s_add_u32 s50, s46, 0
    s_add_u32 m0, s49, 40960
    s_nop 0
    buffer_load_dwordx4 v14, s[52:55], s50 offen lds
    s_add_u32 m0, s49, 41984
    s_nop 0
    buffer_load_dwordx4 v15, s[52:55], s50 offen lds
    s_add_u32 m0, s49, 43008
    s_nop 0
    buffer_load_dwordx4 v16, s[52:55], s50 offen lds
    v_mfma_f32_16x16x32_bf16 v[28:31], v[108:111], v[68:71], v[28:31]
    v_mfma_f32_16x16x32_bf16 v[32:35], v[108:111], v[72:75], v[32:35]
    v_mfma_f32_16x16x32_bf16 v[36:39], v[112:115], v[68:71], v[36:39]
    v_mfma_f32_16x16x32_bf16 v[40:43], v[112:115], v[72:75], v[40:43]
    v_mfma_f32_16x16x32_bf16 v[44:47], v[116:119], v[68:71], v[44:47]
    v_mfma_f32_16x16x32_bf16 v[48:51], v[116:119], v[72:75], v[48:51]
    v_mfma_f32_16x16x32_bf16 v[28:31], v[120:123], v[76:79], v[28:31]
    v_mfma_f32_16x16x32_bf16 v[32:35], v[120:123], v[80:83], v[32:35]
    v_mfma_f32_16x16x32_bf16 v[36:39], v[124:127], v[76:79], v[36:39]
    v_mfma_f32_16x16x32_bf16 v[40:43], v[124:127], v[80:83], v[40:43]
    v_mfma_f32_16x16x32_bf16 v[44:47], v[128:131], v[76:79], v[44:47]
    v_mfma_f32_16x16x32_bf16 v[48:51], v[128:131], v[80:83], v[48:51]
    s_waitcnt vmcnt(20) lgkmcnt(0)
    s_barrier
    ds_read_b128 v[68:71], v19 offset:40960
    ds_read_b128 v[72:75], v19 offset:43008
    ds_read_b64_tr_b16 v[108:109], v147 offset:40960
    ds_read_b64_tr_b16 v[110:111], v147 offset:41728
    ds_read_b64_tr_b16 v[112:113], v148 offset:40960
    ds_read_b64_tr_b16 v[114:115], v148 offset:41728
    ds_read_b64_tr_b16 v[116:117], v149 offset:40960
    ds_read_b64_tr_b16 v[118:119], v149 offset:41728
    ds_read_b128 v[76:79], v20 offset:40960
    ds_read_b128 v[80:83], v20 offset:43008
    ds_read_b64_tr_b16 v[120:121], v147 offset:47104
    ds_read_b64_tr_b16 v[122:123], v147 offset:47872
    ds_read_b64_tr_b16 v[124:125], v148 offset:47104
    ds_read_b64_tr_b16 v[126:127], v148 offset:47872
    ds_read_b64_tr_b16 v[128:129], v149 offset:47104
    ds_read_b64_tr_b16 v[130:131], v149 offset:47872
    s_add_u32 m0, s47, 61440
    s_add_u32 s50, s44, 1280
    buffer_load_dwordx4 v12, s[24:27], s50 offen lds
    s_add_u32 m0, s47, 62464
    s_add_u32 s50, s44, 47360
    buffer_load_dwordx4 v13, s[24:27], s50 offen lds
    s_add_u32 s50, s46, 73728
    s_add_u32 m0, s49, 61440
    s_nop 0
    buffer_load_dwordx4 v14, s[52:55], s50 offen lds
    s_add_u32 m0, s49, 62464
    s_nop 0
    buffer_load_dwordx4 v15, s[52:55], s50 offen lds
    s_add_u32 m0, s49, 63488
    s_nop 0
    buffer_load_dwordx4 v16, s[52:55], s50 offen lds
    v_mfma_f32_16x16x32_bf16 v[28:31], v[84:87], v[52:55], v[28:31]
    v_mfma_f32_16x16x32_bf16 v[32:35], v[84:87], v[56:59], v[32:35]
    v_mfma_f32_16x16x32_bf16 v[36:39], v[88:91], v[52:55], v[36:39]
    v_mfma_f32_16x16x32_bf16 v[40:43], v[88:91], v[56:59], v[40:43]
    v_mfma_f32_16x16x32_bf16 v[44:47], v[92:95], v[52:55], v[44:47]
    v_mfma_f32_16x16x32_bf16 v[48:51], v[92:95], v[56:59], v[48:51]
    v_mfma_f32_16x16x32_bf16 v[28:31], v[96:99], v[60:63], v[28:31]
    v_mfma_f32_16x16x32_bf16 v[32:35], v[96:99], v[64:67], v[32:35]
    v_mfma_f32_16x16x32_bf16 v[36:39], v[100:103], v[60:63], v[36:39]
    v_mfma_f32_16x16x32_bf16 v[40:43], v[100:103], v[64:67], v[40:43]
    v_mfma_f32_16x16x32_bf16 v[44:47], v[104:107], v[60:63], v[44:47]
    v_mfma_f32_16x16x32_bf16 v[48:51], v[104:107], v[64:67], v[48:51]
    s_waitcnt vmcnt(20) lgkmcnt(0)
    s_barrier
    ds_read_b128 v[52:55], v21 offset:0
    ds_read_b128 v[56:59], v21 offset:2048
    ds_read_b64_tr_b16 v[84:85], v150 offset:0
    ds_read_b64_tr_b16 v[86:87], v150 offset:768
    ds_read_b64_tr_b16 v[88:89], v151 offset:0
    ds_read_b64_tr_b16 v[90:91], v151 offset:768
    ds_read_b64_tr_b16 v[92:93], v152 offset:0
    ds_read_b64_tr_b16 v[94:95], v152 offset:768
    ds_read_b128 v[60:63], v22 offset:0
    ds_read_b128 v[64:67], v22 offset:2048
    ds_read_b64_tr_b16 v[96:97], v150 offset:6144
    ds_read_b64_tr_b16 v[98:99], v150 offset:6912
    ds_read_b64_tr_b16 v[100:101], v151 offset:6144
    ds_read_b64_tr_b16 v[102:103], v151 offset:6912
    ds_read_b64_tr_b16 v[104:105], v152 offset:6144
    ds_read_b64_tr_b16 v[106:107], v152 offset:6912
    s_add_u32 m0, s47, 81920
    s_add_u32 s50, s44, 1408
    buffer_load_dwordx4 v12, s[24:27], s50 offen lds
    s_add_u32 m0, s47, 82944
    s_add_u32 s50, s44, 47488
    buffer_load_dwordx4 v13, s[24:27], s50 offen lds
    s_add_u32 s50, s46, 147456
    s_add_u32 m0, s49, 81920
    s_nop 0
    buffer_load_dwordx4 v14, s[52:55], s50 offen lds
    s_add_u32 m0, s49, 82944
    s_nop 0
    buffer_load_dwordx4 v15, s[52:55], s50 offen lds
    s_add_u32 m0, s49, 83968
    s_nop 0
    buffer_load_dwordx4 v16, s[52:55], s50 offen lds
    v_mfma_f32_16x16x32_bf16 v[28:31], v[108:111], v[68:71], v[28:31]
    v_mfma_f32_16x16x32_bf16 v[32:35], v[108:111], v[72:75], v[32:35]
    v_mfma_f32_16x16x32_bf16 v[36:39], v[112:115], v[68:71], v[36:39]
    v_mfma_f32_16x16x32_bf16 v[40:43], v[112:115], v[72:75], v[40:43]
    v_mfma_f32_16x16x32_bf16 v[44:47], v[116:119], v[68:71], v[44:47]
    v_mfma_f32_16x16x32_bf16 v[48:51], v[116:119], v[72:75], v[48:51]
    v_mfma_f32_16x16x32_bf16 v[28:31], v[120:123], v[76:79], v[28:31]
    v_mfma_f32_16x16x32_bf16 v[32:35], v[120:123], v[80:83], v[32:35]
    v_mfma_f32_16x16x32_bf16 v[36:39], v[124:127], v[76:79], v[36:39]
    v_mfma_f32_16x16x32_bf16 v[40:43], v[124:127], v[80:83], v[40:43]
    v_mfma_f32_16x16x32_bf16 v[44:47], v[128:131], v[76:79], v[44:47]
    v_mfma_f32_16x16x32_bf16 v[48:51], v[128:131], v[80:83], v[48:51]
    s_waitcnt vmcnt(20) lgkmcnt(0)
    s_barrier
    ds_read_b128 v[68:71], v17 offset:0
    ds_read_b128 v[72:75], v17 offset:2048
    ds_read_b64_tr_b16 v[108:109], v144 offset:0
    ds_read_b64_tr_b16 v[110:111], v144 offset:768
    ds_read_b64_tr_b16 v[112:113], v145 offset:0
    ds_read_b64_tr_b16 v[114:115], v145 offset:768
    ds_read_b64_tr_b16 v[116:117], v146 offset:0
    ds_read_b64_tr_b16 v[118:119], v146 offset:768
    ds_read_b128 v[76:79], v18 offset:0
    ds_read_b128 v[80:83], v18 offset:2048
    ds_read_b64_tr_b16 v[120:121], v144 offset:6144
    ds_read_b64_tr_b16 v[122:123], v144 offset:6912
    ds_read_b64_tr_b16 v[124:125], v145 offset:6144
    ds_read_b64_tr_b16 v[126:127], v145 offset:6912
    ds_read_b64_tr_b16 v[128:129], v146 offset:6144
    ds_read_b64_tr_b16 v[130:131], v146 offset:6912
    s_add_u32 m0, s47, 102400
    s_add_u32 s50, s44, 1536
    buffer_load_dwordx4 v12, s[24:27], s50 offen lds
    s_add_u32 m0, s47, 103424
    s_add_u32 s50, s44, 47616
    buffer_load_dwordx4 v13, s[24:27], s50 offen lds
    s_add_u32 s50, s46, 221184
    s_add_u32 m0, s49, 102400
    s_nop 0
    buffer_load_dwordx4 v14, s[52:55], s50 offen lds
    s_add_u32 m0, s49, 103424
    s_nop 0
    buffer_load_dwordx4 v15, s[52:55], s50 offen lds
    s_add_u32 m0, s49, 104448
    s_nop 0
    buffer_load_dwordx4 v16, s[52:55], s50 offen lds
    v_mfma_f32_16x16x32_bf16 v[28:31], v[84:87], v[52:55], v[28:31]
    v_mfma_f32_16x16x32_bf16 v[32:35], v[84:87], v[56:59], v[32:35]
    v_mfma_f32_16x16x32_bf16 v[36:39], v[88:91], v[52:55], v[36:39]
    v_mfma_f32_16x16x32_bf16 v[40:43], v[88:91], v[56:59], v[40:43]
    v_mfma_f32_16x16x32_bf16 v[44:47], v[92:95], v[52:55], v[44:47]
    v_mfma_f32_16x16x32_bf16 v[48:51], v[92:95], v[56:59], v[48:51]
    v_mfma_f32_16x16x32_bf16 v[28:31], v[96:99], v[60:63], v[28:31]
    v_mfma_f32_16x16x32_bf16 v[32:35], v[96:99], v[64:67], v[32:35]
    v_mfma_f32_16x16x32_bf16 v[36:39], v[100:103], v[60:63], v[36:39]
    v_mfma_f32_16x16x32_bf16 v[40:43], v[100:103], v[64:67], v[40:43]
    v_mfma_f32_16x16x32_bf16 v[44:47], v[104:107], v[60:63], v[44:47]
    v_mfma_f32_16x16x32_bf16 v[48:51], v[104:107], v[64:67], v[48:51]
    s_waitcnt vmcnt(20) lgkmcnt(0)
    s_barrier
    ds_read_b128 v[52:55], v17 offset:20480
    ds_read_b128 v[56:59], v17 offset:22528
    ds_read_b64_tr_b16 v[84:85], v144 offset:20480
    ds_read_b64_tr_b16 v[86:87], v144 offset:21248
    ds_read_b64_tr_b16 v[88:89], v145 offset:20480
    ds_read_b64_tr_b16 v[90:91], v145 offset:21248
    ds_read_b64_tr_b16 v[92:93], v146 offset:20480
    ds_read_b64_tr_b16 v[94:95], v146 offset:21248
    ds_read_b128 v[60:63], v18 offset:20480
    ds_read_b128 v[64:67], v18 offset:22528
    ds_read_b64_tr_b16 v[96:97], v144 offset:26624
    ds_read_b64_tr_b16 v[98:99], v144 offset:27392
    ds_read_b64_tr_b16 v[100:101], v145 offset:26624
    ds_read_b64_tr_b16 v[102:103], v145 offset:27392
    ds_read_b64_tr_b16 v[104:105], v146 offset:26624
    ds_read_b64_tr_b16 v[106:107], v146 offset:27392
    s_add_u32 m0, s47, 122880
    s_add_u32 s50, s44, 1664
    buffer_load_dwordx4 v12, s[24:27], s50 offen lds
    s_add_u32 m0, s47, 123904
    s_add_u32 s50, s44, 47744
    buffer_load_dwordx4 v13, s[24:27], s50 offen lds
    s_add_u32 s50, s46, 294912
    s_add_u32 m0, s49, 122880
    s_nop 0
    buffer_load_dwordx4 v14, s[52:55], s50 offen lds
    s_add_u32 m0, s49, 123904
    s_nop 0
    buffer_load_dwordx4 v15, s[52:55], s50 offen lds
    s_add_u32 m0, s49, 124928
    s_nop 0
    buffer_load_dwordx4 v16, s[52:55], s50 offen lds
    v_mfma_f32_16x16x32_bf16 v[28:31], v[108:111], v[68:71], v[28:31]
    v_mfma_f32_16x16x32_bf16 v[32:35], v[108:111], v[72:75], v[32:35]
    v_mfma_f32_16x16x32_bf16 v[36:39], v[112:115], v[68:71], v[36:39]
    v_mfma_f32_16x16x32_bf16 v[40:43], v[112:115], v[72:75], v[40:43]
    v_mfma_f32_16x16x32_bf16 v[44:47], v[116:119], v[68:71], v[44:47]
    v_mfma_f32_16x16x32_bf16 v[48:51], v[116:119], v[72:75], v[48:51]
    v_mfma_f32_16x16x32_bf16 v[28:31], v[120:123], v[76:79], v[28:31]
    v_mfma_f32_16x16x32_bf16 v[32:35], v[120:123], v[80:83], v[32:35]
    v_mfma_f32_16x16x32_bf16 v[36:39], v[124:127], v[76:79], v[36:39]
    v_mfma_f32_16x16x32_bf16 v[40:43], v[124:127], v[80:83], v[40:43]
    v_mfma_f32_16x16x32_bf16 v[44:47], v[128:131], v[76:79], v[44:47]
    v_mfma_f32_16x16x32_bf16 v[48:51], v[128:131], v[80:83], v[48:51]
    s_waitcnt vmcnt(20) lgkmcnt(0)
    s_barrier
    ds_read_b128 v[68:71], v17 offset:40960
    ds_read_b128 v[72:75], v17 offset:43008
    ds_read_b64_tr_b16 v[108:109], v144 offset:40960
    ds_read_b64_tr_b16 v[110:111], v144 offset:41728
    ds_read_b64_tr_b16 v[112:113], v145 offset:40960
    ds_read_b64_tr_b16 v[114:115], v145 offset:41728
    ds_read_b64_tr_b16 v[116:117], v146 offset:40960
    ds_read_b64_tr_b16 v[118:119], v146 offset:41728
    ds_read_b128 v[76:79], v18 offset:40960
    ds_read_b128 v[80:83], v18 offset:43008
    ds_read_b64_tr_b16 v[120:121], v144 offset:47104
    ds_read_b64_tr_b16 v[122:123], v144 offset:47872
    ds_read_b64_tr_b16 v[124:125], v145 offset:47104
    ds_read_b64_tr_b16 v[126:127], v145 offset:47872
    ds_read_b64_tr_b16 v[128:129], v146 offset:47104
    ds_read_b64_tr_b16 v[130:131], v146 offset:47872
    s_add_u32 m0, s47, 0
    s_add_u32 s50, s44, 1792
    buffer_load_dwordx4 v12, s[24:27], s50 offen lds
    s_add_u32 m0, s47, 1024
    s_add_u32 s50, s44, 47872
    buffer_load_dwordx4 v13, s[24:27], s50 offen lds
    s_add_u32 s50, s46, 368640
    s_add_u32 m0, s49, 0
    s_nop 0
    buffer_load_dwordx4 v14, s[52:55], s50 offen lds
    s_add_u32 m0, s49, 1024
    s_nop 0
    buffer_load_dwordx4 v15, s[52:55], s50 offen lds
    s_add_u32 m0, s49, 2048
    s_nop 0
    buffer_load_dwordx4 v16, s[52:55], s50 offen lds
    v_mfma_f32_16x16x32_bf16 v[28:31], v[84:87], v[52:55], v[28:31]
    v_mfma_f32_16x16x32_bf16 v[32:35], v[84:87], v[56:59], v[32:35]
    v_mfma_f32_16x16x32_bf16 v[36:39], v[88:91], v[52:55], v[36:39]
    v_mfma_f32_16x16x32_bf16 v[40:43], v[88:91], v[56:59], v[40:43]
    v_mfma_f32_16x16x32_bf16 v[44:47], v[92:95], v[52:55], v[44:47]
    v_mfma_f32_16x16x32_bf16 v[48:51], v[92:95], v[56:59], v[48:51]
    v_mfma_f32_16x16x32_bf16 v[28:31], v[96:99], v[60:63], v[28:31]
    v_mfma_f32_16x16x32_bf16 v[32:35], v[96:99], v[64:67], v[32:35]
    v_mfma_f32_16x16x32_bf16 v[36:39], v[100:103], v[60:63], v[36:39]
    v_mfma_f32_16x16x32_bf16 v[40:43], v[100:103], v[64:67], v[40:43]
    v_mfma_f32_16x16x32_bf16 v[44:47], v[104:107], v[60:63], v[44:47]
    v_mfma_f32_16x16x32_bf16 v[48:51], v[104:107], v[64:67], v[48:51]
    s_waitcnt vmcnt(20) lgkmcnt(0)
    s_barrier
    ds_read_b128 v[52:55], v19 offset:0
    ds_read_b128 v[56:59], v19 offset:2048
    ds_read_b64_tr_b16 v[84:85], v147 offset:0
    ds_read_b64_tr_b16 v[86:87], v147 offset:768
    ds_read_b64_tr_b16 v[88:89], v148 offset:0
    ds_read_b64_tr_b16 v[90:91], v148 offset:768
    ds_read_b64_tr_b16 v[92:93], v149 offset:0
    ds_read_b64_tr_b16 v[94:95], v149 offset:768
    ds_read_b128 v[60:63], v20 offset:0
    ds_read_b128 v[64:67], v20 offset:2048
    ds_read_b64_tr_b16 v[96:97], v147 offset:6144
    ds_read_b64_tr_b16 v[98:99], v147 offset:6912
    ds_read_b64_tr_b16 v[100:101], v148 offset:6144
    ds_read_b64_tr_b16 v[102:103], v148 offset:6912
    ds_read_b64_tr_b16 v[104:105], v149 offset:6144
    ds_read_b64_tr_b16 v[106:107], v149 offset:6912
    s_add_u32 m0, s47, 20480
    s_add_u32 s50, s44, 1920
    buffer_load_dwordx4 v12, s[24:27], s50 offen lds
    s_add_u32 m0, s47, 21504
    s_add_u32 s50, s44, 48000
    buffer_load_dwordx4 v13, s[24:27], s50 offen lds
    s_add_u32 s50, s46, 442368
    s_add_u32 m0, s49, 20480
    s_nop 0
    buffer_load_dwordx4 v14, s[52:55], s50 offen lds
    s_add_u32 m0, s49, 21504
    s_nop 0
    buffer_load_dwordx4 v15, s[52:55], s50 offen lds
    s_add_u32 m0, s49, 22528
    s_nop 0
    buffer_load_dwordx4 v16, s[52:55], s50 offen lds
    v_mfma_f32_16x16x32_bf16 v[28:31], v[108:111], v[68:71], v[28:31]
    v_mfma_f32_16x16x32_bf16 v[32:35], v[108:111], v[72:75], v[32:35]
    v_mfma_f32_16x16x32_bf16 v[36:39], v[112:115], v[68:71], v[36:39]
    v_mfma_f32_16x16x32_bf16 v[40:43], v[112:115], v[72:75], v[40:43]
    v_mfma_f32_16x16x32_bf16 v[44:47], v[116:119], v[68:71], v[44:47]
    v_mfma_f32_16x16x32_bf16 v[48:51], v[116:119], v[72:75], v[48:51]
    v_mfma_f32_16x16x32_bf16 v[28:31], v[120:123], v[76:79], v[28:31]
    v_mfma_f32_16x16x32_bf16 v[32:35], v[120:123], v[80:83], v[32:35]
    v_mfma_f32_16x16x32_bf16 v[36:39], v[124:127], v[76:79], v[36:39]
    v_mfma_f32_16x16x32_bf16 v[40:43], v[124:127], v[80:83], v[40:43]
    v_mfma_f32_16x16x32_bf16 v[44:47], v[128:131], v[76:79], v[44:47]
    v_mfma_f32_16x16x32_bf16 v[48:51], v[128:131], v[80:83], v[48:51]
    s_waitcnt vmcnt(20) lgkmcnt(0)
    s_barrier
    ds_read_b128 v[68:71], v19 offset:20480
    ds_read_b128 v[72:75], v19 offset:22528
    ds_read_b64_tr_b16 v[108:109], v147 offset:20480
    ds_read_b64_tr_b16 v[110:111], v147 offset:21248
    ds_read_b64_tr_b16 v[112:113], v148 offset:20480
    ds_read_b64_tr_b16 v[114:115], v148 offset:21248
    ds_read_b64_tr_b16 v[116:117], v149 offset:20480
    ds_read_b64_tr_b16 v[118:119], v149 offset:21248
    ds_read_b128 v[76:79], v20 offset:20480
    ds_read_b128 v[80:83], v20 offset:22528
    ds_read_b64_tr_b16 v[120:121], v147 offset:26624
    ds_read_b64_tr_b16 v[122:123], v147 offset:27392
    ds_read_b64_tr_b16 v[124:125], v148 offset:26624
    ds_read_b64_tr_b16 v[126:127], v148 offset:27392
    ds_read_b64_tr_b16 v[128:129], v149 offset:26624
    ds_read_b64_tr_b16 v[130:131], v149 offset:27392
    s_add_u32 m0, s47, 40960
    s_add_u32 s50, s44, 2048
    buffer_load_dwordx4 v12, s[24:27], s50 offen lds
    s_add_u32 m0, s47, 41984
    s_add_u32 s50, s44, 48128
    buffer_load_dwordx4 v13, s[24:27], s50 offen lds
    s_add_u32 s50, s46, 516096
    s_add_u32 m0, s49, 40960
    s_nop 0
    buffer_load_dwordx4 v14, s[52:55], s50 offen lds
    s_add_u32 m0, s49, 41984
    s_nop 0
    buffer_load_dwordx4 v15, s[52:55], s50 offen lds
    s_add_u32 m0, s49, 43008
    s_nop 0
    buffer_load_dwordx4 v16, s[52:55], s50 offen lds
    v_mfma_f32_16x16x32_bf16 v[28:31], v[84:87], v[52:55], v[28:31]
    v_mfma_f32_16x16x32_bf16 v[32:35], v[84:87], v[56:59], v[32:35]
    v_mfma_f32_16x16x32_bf16 v[36:39], v[88:91], v[52:55], v[36:39]
    v_mfma_f32_16x16x32_bf16 v[40:43], v[88:91], v[56:59], v[40:43]
    v_mfma_f32_16x16x32_bf16 v[44:47], v[92:95], v[52:55], v[44:47]
    v_mfma_f32_16x16x32_bf16 v[48:51], v[92:95], v[56:59], v[48:51]
    v_mfma_f32_16x16x32_bf16 v[28:31], v[96:99], v[60:63], v[28:31]
    v_mfma_f32_16x16x32_bf16 v[32:35], v[96:99], v[64:67], v[32:35]
    v_mfma_f32_16x16x32_bf16 v[36:39], v[100:103], v[60:63], v[36:39]
    v_mfma_f32_16x16x32_bf16 v[40:43], v[100:103], v[64:67], v[40:43]
    v_mfma_f32_16x16x32_bf16 v[44:47], v[104:107], v[60:63], v[44:47]
    v_mfma_f32_16x16x32_bf16 v[48:51], v[104:107], v[64:67], v[48:51]
    s_waitcnt vmcnt(20) lgkmcnt(0)
    s_barrier
    ds_read_b128 v[52:55], v19 offset:40960
    ds_read_b128 v[56:59], v19 offset:43008
    ds_read_b64_tr_b16 v[84:85], v147 offset:40960
    ds_read_b64_tr_b16 v[86:87], v147 offset:41728
    ds_read_b64_tr_b16 v[88:89], v148 offset:40960
    ds_read_b64_tr_b16 v[90:91], v148 offset:41728
    ds_read_b64_tr_b16 v[92:93], v149 offset:40960
    ds_read_b64_tr_b16 v[94:95], v149 offset:41728
    ds_read_b128 v[60:63], v20 offset:40960
    ds_read_b128 v[64:67], v20 offset:43008
    ds_read_b64_tr_b16 v[96:97], v147 offset:47104
    ds_read_b64_tr_b16 v[98:99], v147 offset:47872
    ds_read_b64_tr_b16 v[100:101], v148 offset:47104
    ds_read_b64_tr_b16 v[102:103], v148 offset:47872
    ds_read_b64_tr_b16 v[104:105], v149 offset:47104
    ds_read_b64_tr_b16 v[106:107], v149 offset:47872
    s_add_u32 m0, s47, 61440
    s_add_u32 s50, s44, 2176
    buffer_load_dwordx4 v12, s[24:27], s50 offen lds
    s_add_u32 m0, s47, 62464
    s_add_u32 s50, s44, 48256
    buffer_load_dwordx4 v13, s[24:27], s50 offen lds
    s_add_u32 s50, s46, 589824
    s_add_u32 m0, s49, 61440
    s_nop 0
    buffer_load_dwordx4 v14, s[52:55], s50 offen lds
    s_add_u32 m0, s49, 62464
    s_nop 0
    buffer_load_dwordx4 v15, s[52:55], s50 offen lds
    s_add_u32 m0, s49, 63488
    s_nop 0
    buffer_load_dwordx4 v16, s[52:55], s50 offen lds
    v_mfma_f32_16x16x32_bf16 v[28:31], v[108:111], v[68:71], v[28:31]
    v_mfma_f32_16x16x32_bf16 v[32:35], v[108:111], v[72:75], v[32:35]
    v_mfma_f32_16x16x32_bf16 v[36:39], v[112:115], v[68:71], v[36:39]
    v_mfma_f32_16x16x32_bf16 v[40:43], v[112:115], v[72:75], v[40:43]
    v_mfma_f32_16x16x32_bf16 v[44:47], v[116:119], v[68:71], v[44:47]
    v_mfma_f32_16x16x32_bf16 v[48:51], v[116:119], v[72:75], v[48:51]
    v_mfma_f32_16x16x32_bf16 v[28:31], v[120:123], v[76:79], v[28:31]
    v_mfma_f32_16x16x32_bf16 v[32:35], v[120:123], v[80:83], v[32:35]
    v_mfma_f32_16x16x32_bf16 v[36:39], v[124:127], v[76:79], v[36:39]
    v_mfma_f32_16x16x32_bf16 v[40:43], v[124:127], v[80:83], v[40:43]
    v_mfma_f32_16x16x32_bf16 v[44:47], v[128:131], v[76:79], v[44:47]
    v_mfma_f32_16x16x32_bf16 v[48:51], v[128:131], v[80:83], v[48:51]
    s_waitcnt vmcnt(20) lgkmcnt(0)
    s_barrier
    ds_read_b128 v[68:71], v21 offset:0
    ds_read_b128 v[72:75], v21 offset:2048
    ds_read_b64_tr_b16 v[108:109], v150 offset:0
    ds_read_b64_tr_b16 v[110:111], v150 offset:768
    ds_read_b64_tr_b16 v[112:113], v151 offset:0
    ds_read_b64_tr_b16 v[114:115], v151 offset:768
    ds_read_b64_tr_b16 v[116:117], v152 offset:0
    ds_read_b64_tr_b16 v[118:119], v152 offset:768
    ds_read_b128 v[76:79], v22 offset:0
    ds_read_b128 v[80:83], v22 offset:2048
    ds_read_b64_tr_b16 v[120:121], v150 offset:6144
    ds_read_b64_tr_b16 v[122:123], v150 offset:6912
    ds_read_b64_tr_b16 v[124:125], v151 offset:6144
    ds_read_b64_tr_b16 v[126:127], v151 offset:6912
    ds_read_b64_tr_b16 v[128:129], v152 offset:6144
    ds_read_b64_tr_b16 v[130:131], v152 offset:6912
    s_add_u32 m0, s47, 81920
    s_add_u32 s50, s44, 2304
    buffer_load_dwordx4 v12, s[24:27], s50 offen lds
    s_add_u32 m0, s47, 82944
    s_add_u32 s50, s44, 48384
    buffer_load_dwordx4 v13, s[24:27], s50 offen lds
    s_add_u32 s50, s46, 663552
    s_add_u32 m0, s49, 81920
    s_nop 0
    buffer_load_dwordx4 v14, s[52:55], s50 offen lds
    s_add_u32 m0, s49, 82944
    s_nop 0
    buffer_load_dwordx4 v15, s[52:55], s50 offen lds
    s_add_u32 m0, s49, 83968
    s_nop 0
    buffer_load_dwordx4 v16, s[52:55], s50 offen lds
    v_mfma_f32_16x16x32_bf16 v[28:31], v[84:87], v[52:55], v[28:31]
    v_mfma_f32_16x16x32_bf16 v[32:35], v[84:87], v[56:59], v[32:35]
    v_mfma_f32_16x16x32_bf16 v[36:39], v[88:91], v[52:55], v[36:39]
    v_mfma_f32_16x16x32_bf16 v[40:43], v[88:91], v[56:59], v[40:43]
    v_mfma_f32_16x16x32_bf16 v[44:47], v[92:95], v[52:55], v[44:47]
    v_mfma_f32_16x16x32_bf16 v[48:51], v[92:95], v[56:59], v[48:51]
    v_mfma_f32_16x16x32_bf16 v[28:31], v[96:99], v[60:63], v[28:31]
    v_mfma_f32_16x16x32_bf16 v[32:35], v[96:99], v[64:67], v[32:35]
    v_mfma_f32_16x16x32_bf16 v[36:39], v[100:103], v[60:63], v[36:39]
    v_mfma_f32_16x16x32_bf16 v[40:43], v[100:103], v[64:67], v[40:43]
    v_mfma_f32_16x16x32_bf16 v[44:47], v[104:107], v[60:63], v[44:47]
    v_mfma_f32_16x16x32_bf16 v[48:51], v[104:107], v[64:67], v[48:51]
    s_waitcnt vmcnt(20) lgkmcnt(0)
    s_barrier
    ds_read_b128 v[52:55], v17 offset:0
    ds_read_b128 v[56:59], v17 offset:2048
    ds_read_b64_tr_b16 v[84:85], v144 offset:0
    ds_read_b64_tr_b16 v[86:87], v144 offset:768
    ds_read_b64_tr_b16 v[88:89], v145 offset:0
    ds_read_b64_tr_b16 v[90:91], v145 offset:768
    ds_read_b64_tr_b16 v[92:93], v146 offset:0
    ds_read_b64_tr_b16 v[94:95], v146 offset:768
    ds_read_b128 v[60:63], v18 offset:0
    ds_read_b128 v[64:67], v18 offset:2048
    ds_read_b64_tr_b16 v[96:97], v144 offset:6144
    ds_read_b64_tr_b16 v[98:99], v144 offset:6912
    ds_read_b64_tr_b16 v[100:101], v145 offset:6144
    ds_read_b64_tr_b16 v[102:103], v145 offset:6912
    ds_read_b64_tr_b16 v[104:105], v146 offset:6144
    ds_read_b64_tr_b16 v[106:107], v146 offset:6912
    s_add_u32 m0, s47, 102400
    s_add_u32 s50, s44, 2432
    buffer_load_dwordx4 v12, s[24:27], s50 offen lds
    s_add_u32 m0, s47, 103424
    s_add_u32 s50, s44, 48512
    buffer_load_dwordx4 v13, s[24:27], s50 offen lds
    s_add_u32 s50, s46, 737280
    s_add_u32 m0, s49, 102400
    s_nop 0
    buffer_load_dwordx4 v14, s[52:55], s50 offen lds
    s_add_u32 m0, s49, 103424
    s_nop 0
    buffer_load_dwordx4 v15, s[52:55], s50 offen lds
    s_add_u32 m0, s49, 104448
    s_nop 0
    buffer_load_dwordx4 v16, s[52:55], s50 offen lds
    v_mfma_f32_16x16x32_bf16 v[28:31], v[108:111], v[68:71], v[28:31]
    v_mfma_f32_16x16x32_bf16 v[32:35], v[108:111], v[72:75], v[32:35]
    v_mfma_f32_16x16x32_bf16 v[36:39], v[112:115], v[68:71], v[36:39]
    v_mfma_f32_16x16x32_bf16 v[40:43], v[112:115], v[72:75], v[40:43]
    v_mfma_f32_16x16x32_bf16 v[44:47], v[116:119], v[68:71], v[44:47]
    v_mfma_f32_16x16x32_bf16 v[48:51], v[116:119], v[72:75], v[48:51]
    v_mfma_f32_16x16x32_bf16 v[28:31], v[120:123], v[76:79], v[28:31]
    v_mfma_f32_16x16x32_bf16 v[32:35], v[120:123], v[80:83], v[32:35]
    v_mfma_f32_16x16x32_bf16 v[36:39], v[124:127], v[76:79], v[36:39]
    v_mfma_f32_16x16x32_bf16 v[40:43], v[124:127], v[80:83], v[40:43]
    v_mfma_f32_16x16x32_bf16 v[44:47], v[128:131], v[76:79], v[44:47]
    v_mfma_f32_16x16x32_bf16 v[48:51], v[128:131], v[80:83], v[48:51]
    s_waitcnt vmcnt(20) lgkmcnt(0)
    s_barrier
    ds_read_b128 v[68:71], v17 offset:20480
    ds_read_b128 v[72:75], v17 offset:22528
    ds_read_b64_tr_b16 v[108:109], v144 offset:20480
    ds_read_b64_tr_b16 v[110:111], v144 offset:21248
    ds_read_b64_tr_b16 v[112:113], v145 offset:20480
    ds_read_b64_tr_b16 v[114:115], v145 offset:21248
    ds_read_b64_tr_b16 v[116:117], v146 offset:20480
    ds_read_b64_tr_b16 v[118:119], v146 offset:21248
    ds_read_b128 v[76:79], v18 offset:20480
    ds_read_b128 v[80:83], v18 offset:22528
    ds_read_b64_tr_b16 v[120:121], v144 offset:26624
    ds_read_b64_tr_b16 v[122:123], v144 offset:27392
    ds_read_b64_tr_b16 v[124:125], v145 offset:26624
    ds_read_b64_tr_b16 v[126:127], v145 offset:27392
    ds_read_b64_tr_b16 v[128:129], v146 offset:26624
    ds_read_b64_tr_b16 v[130:131], v146 offset:27392
    s_add_u32 m0, s47, 122880
    s_add_u32 s50, s44, 2560
    buffer_load_dwordx4 v12, s[24:27], s50 offen lds
    s_add_u32 m0, s47, 123904
    s_add_u32 s50, s44, 48640
    buffer_load_dwordx4 v13, s[24:27], s50 offen lds
    s_add_u32 s50, s46, 811008
    s_add_u32 m0, s49, 122880
    s_nop 0
    buffer_load_dwordx4 v14, s[52:55], s50 offen lds
    s_add_u32 m0, s49, 123904
    s_nop 0
    buffer_load_dwordx4 v15, s[52:55], s50 offen lds
    s_add_u32 m0, s49, 124928
    s_nop 0
    buffer_load_dwordx4 v16, s[52:55], s50 offen lds
    v_mfma_f32_16x16x32_bf16 v[28:31], v[84:87], v[52:55], v[28:31]
    v_mfma_f32_16x16x32_bf16 v[32:35], v[84:87], v[56:59], v[32:35]
    v_mfma_f32_16x16x32_bf16 v[36:39], v[88:91], v[52:55], v[36:39]
    v_mfma_f32_16x16x32_bf16 v[40:43], v[88:91], v[56:59], v[40:43]
    v_mfma_f32_16x16x32_bf16 v[44:47], v[92:95], v[52:55], v[44:47]
    v_mfma_f32_16x16x32_bf16 v[48:51], v[92:95], v[56:59], v[48:51]
    v_mfma_f32_16x16x32_bf16 v[28:31], v[96:99], v[60:63], v[28:31]
    v_mfma_f32_16x16x32_bf16 v[32:35], v[96:99], v[64:67], v[32:35]
    v_mfma_f32_16x16x32_bf16 v[36:39], v[100:103], v[60:63], v[36:39]
    v_mfma_f32_16x16x32_bf16 v[40:43], v[100:103], v[64:67], v[40:43]
    v_mfma_f32_16x16x32_bf16 v[44:47], v[104:107], v[60:63], v[44:47]
    v_mfma_f32_16x16x32_bf16 v[48:51], v[104:107], v[64:67], v[48:51]
    s_waitcnt vmcnt(20) lgkmcnt(0)
    s_barrier
    ds_read_b128 v[52:55], v17 offset:40960
    ds_read_b128 v[56:59], v17 offset:43008
    ds_read_b64_tr_b16 v[84:85], v144 offset:40960
    ds_read_b64_tr_b16 v[86:87], v144 offset:41728
    ds_read_b64_tr_b16 v[88:89], v145 offset:40960
    ds_read_b64_tr_b16 v[90:91], v145 offset:41728
    ds_read_b64_tr_b16 v[92:93], v146 offset:40960
    ds_read_b64_tr_b16 v[94:95], v146 offset:41728
    ds_read_b128 v[60:63], v18 offset:40960
    ds_read_b128 v[64:67], v18 offset:43008
    ds_read_b64_tr_b16 v[96:97], v144 offset:47104
    ds_read_b64_tr_b16 v[98:99], v144 offset:47872
    ds_read_b64_tr_b16 v[100:101], v145 offset:47104
    ds_read_b64_tr_b16 v[102:103], v145 offset:47872
    ds_read_b64_tr_b16 v[104:105], v146 offset:47104
    ds_read_b64_tr_b16 v[106:107], v146 offset:47872
    s_add_u32 m0, s47, 0
    s_add_u32 s50, s44, 2688
    buffer_load_dwordx4 v12, s[24:27], s50 offen lds
    s_add_u32 m0, s47, 1024
    s_add_u32 s50, s44, 48768
    buffer_load_dwordx4 v13, s[24:27], s50 offen lds
    s_add_u32 s50, s46, 884736
    s_add_u32 m0, s49, 0
    s_nop 0
    buffer_load_dwordx4 v14, s[52:55], s50 offen lds
    s_add_u32 m0, s49, 1024
    s_nop 0
    buffer_load_dwordx4 v15, s[52:55], s50 offen lds
    s_add_u32 m0, s49, 2048
    s_nop 0
    buffer_load_dwordx4 v16, s[52:55], s50 offen lds
    v_mfma_f32_16x16x32_bf16 v[28:31], v[108:111], v[68:71], v[28:31]
    v_mfma_f32_16x16x32_bf16 v[32:35], v[108:111], v[72:75], v[32:35]
    v_mfma_f32_16x16x32_bf16 v[36:39], v[112:115], v[68:71], v[36:39]
    v_mfma_f32_16x16x32_bf16 v[40:43], v[112:115], v[72:75], v[40:43]
    v_mfma_f32_16x16x32_bf16 v[44:47], v[116:119], v[68:71], v[44:47]
    v_mfma_f32_16x16x32_bf16 v[48:51], v[116:119], v[72:75], v[48:51]
    v_mfma_f32_16x16x32_bf16 v[28:31], v[120:123], v[76:79], v[28:31]
    v_mfma_f32_16x16x32_bf16 v[32:35], v[120:123], v[80:83], v[32:35]
    v_mfma_f32_16x16x32_bf16 v[36:39], v[124:127], v[76:79], v[36:39]
    v_mfma_f32_16x16x32_bf16 v[40:43], v[124:127], v[80:83], v[40:43]
    v_mfma_f32_16x16x32_bf16 v[44:47], v[128:131], v[76:79], v[44:47]
    v_mfma_f32_16x16x32_bf16 v[48:51], v[128:131], v[80:83], v[48:51]
    s_waitcnt vmcnt(20) lgkmcnt(0)
    s_barrier
    ds_read_b128 v[68:71], v19 offset:0
    ds_read_b128 v[72:75], v19 offset:2048
    ds_read_b64_tr_b16 v[108:109], v147 offset:0
    ds_read_b64_tr_b16 v[110:111], v147 offset:768
    ds_read_b64_tr_b16 v[112:113], v148 offset:0
    ds_read_b64_tr_b16 v[114:115], v148 offset:768
    ds_read_b64_tr_b16 v[116:117], v149 offset:0
    ds_read_b64_tr_b16 v[118:119], v149 offset:768
    ds_read_b128 v[76:79], v20 offset:0
    ds_read_b128 v[80:83], v20 offset:2048
    ds_read_b64_tr_b16 v[120:121], v147 offset:6144
    ds_read_b64_tr_b16 v[122:123], v147 offset:6912
    ds_read_b64_tr_b16 v[124:125], v148 offset:6144
    ds_read_b64_tr_b16 v[126:127], v148 offset:6912
    ds_read_b64_tr_b16 v[128:129], v149 offset:6144
    ds_read_b64_tr_b16 v[130:131], v149 offset:6912
    s_add_u32 m0, s47, 20480
    s_add_u32 s50, s44, 2816
    buffer_load_dwordx4 v12, s[24:27], s50 offen lds
    s_add_u32 m0, s47, 21504
    s_add_u32 s50, s44, 48896
    buffer_load_dwordx4 v13, s[24:27], s50 offen lds
    s_add_u32 s50, s46, 958464
    s_add_u32 m0, s49, 20480
    s_nop 0
    buffer_load_dwordx4 v14, s[52:55], s50 offen lds
    s_add_u32 m0, s49, 21504
    s_nop 0
    buffer_load_dwordx4 v15, s[52:55], s50 offen lds
    s_add_u32 m0, s49, 22528
    s_nop 0
    buffer_load_dwordx4 v16, s[52:55], s50 offen lds
    v_mfma_f32_16x16x32_bf16 v[28:31], v[84:87], v[52:55], v[28:31]
    v_mfma_f32_16x16x32_bf16 v[32:35], v[84:87], v[56:59], v[32:35]
    v_mfma_f32_16x16x32_bf16 v[36:39], v[88:91], v[52:55], v[36:39]
    v_mfma_f32_16x16x32_bf16 v[40:43], v[88:91], v[56:59], v[40:43]
    v_mfma_f32_16x16x32_bf16 v[44:47], v[92:95], v[52:55], v[44:47]
    v_mfma_f32_16x16x32_bf16 v[48:51], v[92:95], v[56:59], v[48:51]
    v_mfma_f32_16x16x32_bf16 v[28:31], v[96:99], v[60:63], v[28:31]
    v_mfma_f32_16x16x32_bf16 v[32:35], v[96:99], v[64:67], v[32:35]
    v_mfma_f32_16x16x32_bf16 v[36:39], v[100:103], v[60:63], v[36:39]
    v_mfma_f32_16x16x32_bf16 v[40:43], v[100:103], v[64:67], v[40:43]
    v_mfma_f32_16x16x32_bf16 v[44:47], v[104:107], v[60:63], v[44:47]
    v_mfma_f32_16x16x32_bf16 v[48:51], v[104:107], v[64:67], v[48:51]
    s_waitcnt vmcnt(20) lgkmcnt(0)
    s_barrier
    ds_read_b128 v[52:55], v19 offset:20480
    ds_read_b128 v[56:59], v19 offset:22528
    ds_read_b64_tr_b16 v[84:85], v147 offset:20480
    ds_read_b64_tr_b16 v[86:87], v147 offset:21248
    ds_read_b64_tr_b16 v[88:89], v148 offset:20480
    ds_read_b64_tr_b16 v[90:91], v148 offset:21248
    ds_read_b64_tr_b16 v[92:93], v149 offset:20480
    ds_read_b64_tr_b16 v[94:95], v149 offset:21248
    ds_read_b128 v[60:63], v20 offset:20480
    ds_read_b128 v[64:67], v20 offset:22528
    ds_read_b64_tr_b16 v[96:97], v147 offset:26624
    ds_read_b64_tr_b16 v[98:99], v147 offset:27392
    ds_read_b64_tr_b16 v[100:101], v148 offset:26624
    ds_read_b64_tr_b16 v[102:103], v148 offset:27392
    ds_read_b64_tr_b16 v[104:105], v149 offset:26624
    ds_read_b64_tr_b16 v[106:107], v149 offset:27392
    s_add_u32 m0, s47, 40960
    s_add_u32 s50, s44, 2944
    buffer_load_dwordx4 v12, s[24:27], s50 offen lds
    s_add_u32 m0, s47, 41984
    s_add_u32 s50, s44, 49024
    buffer_load_dwordx4 v13, s[24:27], s50 offen lds
    s_add_u32 s50, s46, 1032192
    s_add_u32 m0, s49, 40960
    s_nop 0
    buffer_load_dwordx4 v14, s[52:55], s50 offen lds
    s_add_u32 m0, s49, 41984
    s_nop 0
    buffer_load_dwordx4 v15, s[52:55], s50 offen lds
    s_add_u32 m0, s49, 43008
    s_nop 0
    buffer_load_dwordx4 v16, s[52:55], s50 offen lds
    v_mfma_f32_16x16x32_bf16 v[28:31], v[108:111], v[68:71], v[28:31]
    v_mfma_f32_16x16x32_bf16 v[32:35], v[108:111], v[72:75], v[32:35]
    v_mfma_f32_16x16x32_bf16 v[36:39], v[112:115], v[68:71], v[36:39]
    v_mfma_f32_16x16x32_bf16 v[40:43], v[112:115], v[72:75], v[40:43]
    v_mfma_f32_16x16x32_bf16 v[44:47], v[116:119], v[68:71], v[44:47]
    v_mfma_f32_16x16x32_bf16 v[48:51], v[116:119], v[72:75], v[48:51]
    v_mfma_f32_16x16x32_bf16 v[28:31], v[120:123], v[76:79], v[28:31]
    v_mfma_f32_16x16x32_bf16 v[32:35], v[120:123], v[80:83], v[32:35]
    v_mfma_f32_16x16x32_bf16 v[36:39], v[124:127], v[76:79], v[36:39]
    v_mfma_f32_16x16x32_bf16 v[40:43], v[124:127], v[80:83], v[40:43]
    v_mfma_f32_16x16x32_bf16 v[44:47], v[128:131], v[76:79], v[44:47]
    v_mfma_f32_16x16x32_bf16 v[48:51], v[128:131], v[80:83], v[48:51]
    s_waitcnt vmcnt(20) lgkmcnt(0)
    s_barrier
    ds_read_b128 v[68:71], v19 offset:40960
    ds_read_b128 v[72:75], v19 offset:43008
    ds_read_b64_tr_b16 v[108:109], v147 offset:40960
    ds_read_b64_tr_b16 v[110:111], v147 offset:41728
    ds_read_b64_tr_b16 v[112:113], v148 offset:40960
    ds_read_b64_tr_b16 v[114:115], v148 offset:41728
    ds_read_b64_tr_b16 v[116:117], v149 offset:40960
    ds_read_b64_tr_b16 v[118:119], v149 offset:41728
    ds_read_b128 v[76:79], v20 offset:40960
    ds_read_b128 v[80:83], v20 offset:43008
    ds_read_b64_tr_b16 v[120:121], v147 offset:47104
    ds_read_b64_tr_b16 v[122:123], v147 offset:47872
    ds_read_b64_tr_b16 v[124:125], v148 offset:47104
    ds_read_b64_tr_b16 v[126:127], v148 offset:47872
    ds_read_b64_tr_b16 v[128:129], v149 offset:47104
    ds_read_b64_tr_b16 v[130:131], v149 offset:47872
    s_add_u32 m0, s47, 61440
    s_add_u32 s50, s44, 3072
    buffer_load_dwordx4 v12, s[24:27], s50 offen lds
    s_add_u32 m0, s47, 62464
    s_add_u32 s50, s44, 49152
    buffer_load_dwordx4 v13, s[24:27], s50 offen lds
    s_add_u32 s50, s46, 1105920
    s_add_u32 m0, s49, 61440
    s_nop 0
    buffer_load_dwordx4 v14, s[52:55], s50 offen lds
    s_add_u32 m0, s49, 62464
    s_nop 0
    buffer_load_dwordx4 v15, s[52:55], s50 offen lds
    s_add_u32 m0, s49, 63488
    s_nop 0
    buffer_load_dwordx4 v16, s[52:55], s50 offen lds
    v_mfma_f32_16x16x32_bf16 v[28:31], v[84:87], v[52:55], v[28:31]
    v_mfma_f32_16x16x32_bf16 v[32:35], v[84:87], v[56:59], v[32:35]
    v_mfma_f32_16x16x32_bf16 v[36:39], v[88:91], v[52:55], v[36:39]
    v_mfma_f32_16x16x32_bf16 v[40:43], v[88:91], v[56:59], v[40:43]
    v_mfma_f32_16x16x32_bf16 v[44:47], v[92:95], v[52:55], v[44:47]
    v_mfma_f32_16x16x32_bf16 v[48:51], v[92:95], v[56:59], v[48:51]
    v_mfma_f32_16x16x32_bf16 v[28:31], v[96:99], v[60:63], v[28:31]
    v_mfma_f32_16x16x32_bf16 v[32:35], v[96:99], v[64:67], v[32:35]
    v_mfma_f32_16x16x32_bf16 v[36:39], v[100:103], v[60:63], v[36:39]
    v_mfma_f32_16x16x32_bf16 v[40:43], v[100:103], v[64:67], v[40:43]
    v_mfma_f32_16x16x32_bf16 v[44:47], v[104:107], v[60:63], v[44:47]
    v_mfma_f32_16x16x32_bf16 v[48:51], v[104:107], v[64:67], v[48:51]
    s_waitcnt vmcnt(20) lgkmcnt(0)
    s_barrier
    ds_read_b128 v[52:55], v21 offset:0
    ds_read_b128 v[56:59], v21 offset:2048
    ds_read_b64_tr_b16 v[84:85], v150 offset:0
    ds_read_b64_tr_b16 v[86:87], v150 offset:768
    ds_read_b64_tr_b16 v[88:89], v151 offset:0
    ds_read_b64_tr_b16 v[90:91], v151 offset:768
    ds_read_b64_tr_b16 v[92:93], v152 offset:0
    ds_read_b64_tr_b16 v[94:95], v152 offset:768
    ds_read_b128 v[60:63], v22 offset:0
    ds_read_b128 v[64:67], v22 offset:2048
    ds_read_b64_tr_b16 v[96:97], v150 offset:6144
    ds_read_b64_tr_b16 v[98:99], v150 offset:6912
    ds_read_b64_tr_b16 v[100:101], v151 offset:6144
    ds_read_b64_tr_b16 v[102:103], v151 offset:6912
    ds_read_b64_tr_b16 v[104:105], v152 offset:6144
    ds_read_b64_tr_b16 v[106:107], v152 offset:6912
    s_add_u32 m0, s47, 81920
    s_add_u32 s50, s44, 3200
    buffer_load_dwordx4 v12, s[24:27], s50 offen lds
    s_add_u32 m0, s47, 82944
    s_add_u32 s50, s44, 49280
    buffer_load_dwordx4 v13, s[24:27], s50 offen lds
    s_add_u32 s50, s46, 1179648
    s_add_u32 m0, s49, 81920
    s_nop 0
    buffer_load_dwordx4 v14, s[52:55], s50 offen lds
    s_add_u32 m0, s49, 82944
    s_nop 0
    buffer_load_dwordx4 v15, s[52:55], s50 offen lds
    s_add_u32 m0, s49, 83968
    s_nop 0
    buffer_load_dwordx4 v16, s[52:55], s50 offen lds
    v_mfma_f32_16x16x32_bf16 v[28:31], v[108:111], v[68:71], v[28:31]
    v_mfma_f32_16x16x32_bf16 v[32:35], v[108:111], v[72:75], v[32:35]
    v_mfma_f32_16x16x32_bf16 v[36:39], v[112:115], v[68:71], v[36:39]
    v_mfma_f32_16x16x32_bf16 v[40:43], v[112:115], v[72:75], v[40:43]
    v_mfma_f32_16x16x32_bf16 v[44:47], v[116:119], v[68:71], v[44:47]
    v_mfma_f32_16x16x32_bf16 v[48:51], v[116:119], v[72:75], v[48:51]
    v_mfma_f32_16x16x32_bf16 v[28:31], v[120:123], v[76:79], v[28:31]
    v_mfma_f32_16x16x32_bf16 v[32:35], v[120:123], v[80:83], v[32:35]
    v_mfma_f32_16x16x32_bf16 v[36:39], v[124:127], v[76:79], v[36:39]
    v_mfma_f32_16x16x32_bf16 v[40:43], v[124:127], v[80:83], v[40:43]
    v_mfma_f32_16x16x32_bf16 v[44:47], v[128:131], v[76:79], v[44:47]
    v_mfma_f32_16x16x32_bf16 v[48:51], v[128:131], v[80:83], v[48:51]
    s_waitcnt vmcnt(20) lgkmcnt(0)
    s_barrier
    ds_read_b128 v[68:71], v17 offset:0
    ds_read_b128 v[72:75], v17 offset:2048
    ds_read_b64_tr_b16 v[108:109], v144 offset:0
    ds_read_b64_tr_b16 v[110:111], v144 offset:768
    ds_read_b64_tr_b16 v[112:113], v145 offset:0
    ds_read_b64_tr_b16 v[114:115], v145 offset:768
    ds_read_b64_tr_b16 v[116:117], v146 offset:0
    ds_read_b64_tr_b16 v[118:119], v146 offset:768
    ds_read_b128 v[76:79], v18 offset:0
    ds_read_b128 v[80:83], v18 offset:2048
    ds_read_b64_tr_b16 v[120:121], v144 offset:6144
    ds_read_b64_tr_b16 v[122:123], v144 offset:6912
    ds_read_b64_tr_b16 v[124:125], v145 offset:6144
    ds_read_b64_tr_b16 v[126:127], v145 offset:6912
    ds_read_b64_tr_b16 v[128:129], v146 offset:6144
    ds_read_b64_tr_b16 v[130:131], v146 offset:6912
    s_add_u32 m0, s47, 102400
    s_add_u32 s50, s44, 3328
    buffer_load_dwordx4 v12, s[24:27], s50 offen lds
    s_add_u32 m0, s47, 103424
    s_add_u32 s50, s44, 49408
    buffer_load_dwordx4 v13, s[24:27], s50 offen lds
    s_add_u32 s50, s46, 1253376
    s_add_u32 m0, s49, 102400
    s_nop 0
    buffer_load_dwordx4 v14, s[52:55], s50 offen lds
    s_add_u32 m0, s49, 103424
    s_nop 0
    buffer_load_dwordx4 v15, s[52:55], s50 offen lds
    s_add_u32 m0, s49, 104448
    s_nop 0
    buffer_load_dwordx4 v16, s[52:55], s50 offen lds
    v_mfma_f32_16x16x32_bf16 v[28:31], v[84:87], v[52:55], v[28:31]
    v_mfma_f32_16x16x32_bf16 v[32:35], v[84:87], v[56:59], v[32:35]
    v_mfma_f32_16x16x32_bf16 v[36:39], v[88:91], v[52:55], v[36:39]
    v_mfma_f32_16x16x32_bf16 v[40:43], v[88:91], v[56:59], v[40:43]
    v_mfma_f32_16x16x32_bf16 v[44:47], v[92:95], v[52:55], v[44:47]
    v_mfma_f32_16x16x32_bf16 v[48:51], v[92:95], v[56:59], v[48:51]
    v_mfma_f32_16x16x32_bf16 v[28:31], v[96:99], v[60:63], v[28:31]
    v_mfma_f32_16x16x32_bf16 v[32:35], v[96:99], v[64:67], v[32:35]
    v_mfma_f32_16x16x32_bf16 v[36:39], v[100:103], v[60:63], v[36:39]
    v_mfma_f32_16x16x32_bf16 v[40:43], v[100:103], v[64:67], v[40:43]
    v_mfma_f32_16x16x32_bf16 v[44:47], v[104:107], v[60:63], v[44:47]
    v_mfma_f32_16x16x32_bf16 v[48:51], v[104:107], v[64:67], v[48:51]
    s_waitcnt vmcnt(20) lgkmcnt(0)
    s_barrier
    ds_read_b128 v[52:55], v17 offset:20480
    ds_read_b128 v[56:59], v17 offset:22528
    ds_read_b64_tr_b16 v[84:85], v144 offset:20480
    ds_read_b64_tr_b16 v[86:87], v144 offset:21248
    ds_read_b64_tr_b16 v[88:89], v145 offset:20480
    ds_read_b64_tr_b16 v[90:91], v145 offset:21248
    ds_read_b64_tr_b16 v[92:93], v146 offset:20480
    ds_read_b64_tr_b16 v[94:95], v146 offset:21248
    ds_read_b128 v[60:63], v18 offset:20480
    ds_read_b128 v[64:67], v18 offset:22528
    ds_read_b64_tr_b16 v[96:97], v144 offset:26624
    ds_read_b64_tr_b16 v[98:99], v144 offset:27392
    ds_read_b64_tr_b16 v[100:101], v145 offset:26624
    ds_read_b64_tr_b16 v[102:103], v145 offset:27392
    ds_read_b64_tr_b16 v[104:105], v146 offset:26624
    ds_read_b64_tr_b16 v[106:107], v146 offset:27392
    s_add_u32 m0, s47, 122880
    s_add_u32 s50, s44, 3456
    buffer_load_dwordx4 v12, s[24:27], s50 offen lds
    s_add_u32 m0, s47, 123904
    s_add_u32 s50, s44, 49536
    buffer_load_dwordx4 v13, s[24:27], s50 offen lds
    s_add_u32 s50, s46, 1327104
    s_add_u32 m0, s49, 122880
    s_nop 0
    buffer_load_dwordx4 v14, s[52:55], s50 offen lds
    s_add_u32 m0, s49, 123904
    s_nop 0
    buffer_load_dwordx4 v15, s[52:55], s50 offen lds
    s_add_u32 m0, s49, 124928
    s_nop 0
    buffer_load_dwordx4 v16, s[52:55], s50 offen lds
    v_mfma_f32_16x16x32_bf16 v[28:31], v[108:111], v[68:71], v[28:31]
    v_mfma_f32_16x16x32_bf16 v[32:35], v[108:111], v[72:75], v[32:35]
    v_mfma_f32_16x16x32_bf16 v[36:39], v[112:115], v[68:71], v[36:39]
    v_mfma_f32_16x16x32_bf16 v[40:43], v[112:115], v[72:75], v[40:43]
    v_mfma_f32_16x16x32_bf16 v[44:47], v[116:119], v[68:71], v[44:47]
    v_mfma_f32_16x16x32_bf16 v[48:51], v[116:119], v[72:75], v[48:51]
    v_mfma_f32_16x16x32_bf16 v[28:31], v[120:123], v[76:79], v[28:31]
    v_mfma_f32_16x16x32_bf16 v[32:35], v[120:123], v[80:83], v[32:35]
    v_mfma_f32_16x16x32_bf16 v[36:39], v[124:127], v[76:79], v[36:39]
    v_mfma_f32_16x16x32_bf16 v[40:43], v[124:127], v[80:83], v[40:43]
    v_mfma_f32_16x16x32_bf16 v[44:47], v[128:131], v[76:79], v[44:47]
    v_mfma_f32_16x16x32_bf16 v[48:51], v[128:131], v[80:83], v[48:51]
    s_waitcnt vmcnt(20) lgkmcnt(0)
    s_barrier
    ds_read_b128 v[68:71], v17 offset:40960
    ds_read_b128 v[72:75], v17 offset:43008
    ds_read_b64_tr_b16 v[108:109], v144 offset:40960
    ds_read_b64_tr_b16 v[110:111], v144 offset:41728
    ds_read_b64_tr_b16 v[112:113], v145 offset:40960
    ds_read_b64_tr_b16 v[114:115], v145 offset:41728
    ds_read_b64_tr_b16 v[116:117], v146 offset:40960
    ds_read_b64_tr_b16 v[118:119], v146 offset:41728
    ds_read_b128 v[76:79], v18 offset:40960
    ds_read_b128 v[80:83], v18 offset:43008
    ds_read_b64_tr_b16 v[120:121], v144 offset:47104
    ds_read_b64_tr_b16 v[122:123], v144 offset:47872
    ds_read_b64_tr_b16 v[124:125], v145 offset:47104
    ds_read_b64_tr_b16 v[126:127], v145 offset:47872
    ds_read_b64_tr_b16 v[128:129], v146 offset:47104
    ds_read_b64_tr_b16 v[130:131], v146 offset:47872
    s_add_u32 m0, s47, 0
    s_add_u32 s50, s44, 3584
    buffer_load_dwordx4 v12, s[24:27], s50 offen lds
    s_add_u32 m0, s47, 1024
    s_add_u32 s50, s44, 49664
    buffer_load_dwordx4 v13, s[24:27], s50 offen lds
    s_add_u32 s50, s46, 1400832
    s_add_u32 m0, s49, 0
    s_nop 0
    buffer_load_dwordx4 v14, s[52:55], s50 offen lds
    s_add_u32 m0, s49, 1024
    s_nop 0
    buffer_load_dwordx4 v15, s[52:55], s50 offen lds
    s_add_u32 m0, s49, 2048
    s_nop 0
    buffer_load_dwordx4 v16, s[52:55], s50 offen lds
    v_mfma_f32_16x16x32_bf16 v[28:31], v[84:87], v[52:55], v[28:31]
    v_mfma_f32_16x16x32_bf16 v[32:35], v[84:87], v[56:59], v[32:35]
    v_mfma_f32_16x16x32_bf16 v[36:39], v[88:91], v[52:55], v[36:39]
    v_mfma_f32_16x16x32_bf16 v[40:43], v[88:91], v[56:59], v[40:43]
    v_mfma_f32_16x16x32_bf16 v[44:47], v[92:95], v[52:55], v[44:47]
    v_mfma_f32_16x16x32_bf16 v[48:51], v[92:95], v[56:59], v[48:51]
    v_mfma_f32_16x16x32_bf16 v[28:31], v[96:99], v[60:63], v[28:31]
    v_mfma_f32_16x16x32_bf16 v[32:35], v[96:99], v[64:67], v[32:35]
    v_mfma_f32_16x16x32_bf16 v[36:39], v[100:103], v[60:63], v[36:39]
    v_mfma_f32_16x16x32_bf16 v[40:43], v[100:103], v[64:67], v[40:43]
    v_mfma_f32_16x16x32_bf16 v[44:47], v[104:107], v[60:63], v[44:47]
    v_mfma_f32_16x16x32_bf16 v[48:51], v[104:107], v[64:67], v[48:51]
    s_waitcnt vmcnt(20) lgkmcnt(0)
    s_barrier
    ds_read_b128 v[52:55], v19 offset:0
    ds_read_b128 v[56:59], v19 offset:2048
    ds_read_b64_tr_b16 v[84:85], v147 offset:0
    ds_read_b64_tr_b16 v[86:87], v147 offset:768
    ds_read_b64_tr_b16 v[88:89], v148 offset:0
    ds_read_b64_tr_b16 v[90:91], v148 offset:768
    ds_read_b64_tr_b16 v[92:93], v149 offset:0
    ds_read_b64_tr_b16 v[94:95], v149 offset:768
    ds_read_b128 v[60:63], v20 offset:0
    ds_read_b128 v[64:67], v20 offset:2048
    ds_read_b64_tr_b16 v[96:97], v147 offset:6144
    ds_read_b64_tr_b16 v[98:99], v147 offset:6912
    ds_read_b64_tr_b16 v[100:101], v148 offset:6144
    ds_read_b64_tr_b16 v[102:103], v148 offset:6912
    ds_read_b64_tr_b16 v[104:105], v149 offset:6144
    ds_read_b64_tr_b16 v[106:107], v149 offset:6912
    s_add_u32 m0, s47, 20480
    s_add_u32 s50, s44, 3712
    buffer_load_dwordx4 v12, s[24:27], s50 offen lds
    s_add_u32 m0, s47, 21504
    s_add_u32 s50, s44, 49792
    buffer_load_dwordx4 v13, s[24:27], s50 offen lds
    s_add_u32 s50, s46, 1474560
    s_add_u32 m0, s49, 20480
    s_nop 0
    buffer_load_dwordx4 v14, s[52:55], s50 offen lds
    s_add_u32 m0, s49, 21504
    s_nop 0
    buffer_load_dwordx4 v15, s[52:55], s50 offen lds
    s_add_u32 m0, s49, 22528
    s_nop 0
    buffer_load_dwordx4 v16, s[52:55], s50 offen lds
    v_mfma_f32_16x16x32_bf16 v[28:31], v[108:111], v[68:71], v[28:31]
    v_mfma_f32_16x16x32_bf16 v[32:35], v[108:111], v[72:75], v[32:35]
    v_mfma_f32_16x16x32_bf16 v[36:39], v[112:115], v[68:71], v[36:39]
    v_mfma_f32_16x16x32_bf16 v[40:43], v[112:115], v[72:75], v[40:43]
    v_mfma_f32_16x16x32_bf16 v[44:47], v[116:119], v[68:71], v[44:47]
    v_mfma_f32_16x16x32_bf16 v[48:51], v[116:119], v[72:75], v[48:51]
    v_mfma_f32_16x16x32_bf16 v[28:31], v[120:123], v[76:79], v[28:31]
    v_mfma_f32_16x16x32_bf16 v[32:35], v[120:123], v[80:83], v[32:35]
    v_mfma_f32_16x16x32_bf16 v[36:39], v[124:127], v[76:79], v[36:39]
    v_mfma_f32_16x16x32_bf16 v[40:43], v[124:127], v[80:83], v[40:43]
    v_mfma_f32_16x16x32_bf16 v[44:47], v[128:131], v[76:79], v[44:47]
    v_mfma_f32_16x16x32_bf16 v[48:51], v[128:131], v[80:83], v[48:51]
    s_waitcnt vmcnt(20) lgkmcnt(0)
    s_barrier
    ds_read_b128 v[68:71], v19 offset:20480
    ds_read_b128 v[72:75], v19 offset:22528
    ds_read_b64_tr_b16 v[108:109], v147 offset:20480
    ds_read_b64_tr_b16 v[110:111], v147 offset:21248
    ds_read_b64_tr_b16 v[112:113], v148 offset:20480
    ds_read_b64_tr_b16 v[114:115], v148 offset:21248
    ds_read_b64_tr_b16 v[116:117], v149 offset:20480
    ds_read_b64_tr_b16 v[118:119], v149 offset:21248
    ds_read_b128 v[76:79], v20 offset:20480
    ds_read_b128 v[80:83], v20 offset:22528
    ds_read_b64_tr_b16 v[120:121], v147 offset:26624
    ds_read_b64_tr_b16 v[122:123], v147 offset:27392
    ds_read_b64_tr_b16 v[124:125], v148 offset:26624
    ds_read_b64_tr_b16 v[126:127], v148 offset:27392
    ds_read_b64_tr_b16 v[128:129], v149 offset:26624
    ds_read_b64_tr_b16 v[130:131], v149 offset:27392
    s_add_u32 m0, s47, 40960
    s_add_u32 s50, s44, 3840
    buffer_load_dwordx4 v12, s[24:27], s50 offen lds
    s_add_u32 m0, s47, 41984
    s_add_u32 s50, s44, 49920
    buffer_load_dwordx4 v13, s[24:27], s50 offen lds
    s_add_u32 s50, s46, 1548288
    s_add_u32 m0, s49, 40960
    s_nop 0
    buffer_load_dwordx4 v14, s[52:55], s50 offen lds
    s_add_u32 m0, s49, 41984
    s_nop 0
    buffer_load_dwordx4 v15, s[52:55], s50 offen lds
    s_add_u32 m0, s49, 43008
    s_nop 0
    buffer_load_dwordx4 v16, s[52:55], s50 offen lds
    v_mfma_f32_16x16x32_bf16 v[28:31], v[84:87], v[52:55], v[28:31]
    v_mfma_f32_16x16x32_bf16 v[32:35], v[84:87], v[56:59], v[32:35]
    v_mfma_f32_16x16x32_bf16 v[36:39], v[88:91], v[52:55], v[36:39]
    v_mfma_f32_16x16x32_bf16 v[40:43], v[88:91], v[56:59], v[40:43]
    v_mfma_f32_16x16x32_bf16 v[44:47], v[92:95], v[52:55], v[44:47]
    v_mfma_f32_16x16x32_bf16 v[48:51], v[92:95], v[56:59], v[48:51]
    v_mfma_f32_16x16x32_bf16 v[28:31], v[96:99], v[60:63], v[28:31]
    v_mfma_f32_16x16x32_bf16 v[32:35], v[96:99], v[64:67], v[32:35]
    v_mfma_f32_16x16x32_bf16 v[36:39], v[100:103], v[60:63], v[36:39]
    v_mfma_f32_16x16x32_bf16 v[40:43], v[100:103], v[64:67], v[40:43]
    v_mfma_f32_16x16x32_bf16 v[44:47], v[104:107], v[60:63], v[44:47]
    v_mfma_f32_16x16x32_bf16 v[48:51], v[104:107], v[64:67], v[48:51]
    s_waitcnt vmcnt(20) lgkmcnt(0)
    s_barrier
    ds_read_b128 v[52:55], v19 offset:40960
    ds_read_b128 v[56:59], v19 offset:43008
    ds_read_b64_tr_b16 v[84:85], v147 offset:40960
    ds_read_b64_tr_b16 v[86:87], v147 offset:41728
    ds_read_b64_tr_b16 v[88:89], v148 offset:40960
    ds_read_b64_tr_b16 v[90:91], v148 offset:41728
    ds_read_b64_tr_b16 v[92:93], v149 offset:40960
    ds_read_b64_tr_b16 v[94:95], v149 offset:41728
    ds_read_b128 v[60:63], v20 offset:40960
    ds_read_b128 v[64:67], v20 offset:43008
    ds_read_b64_tr_b16 v[96:97], v147 offset:47104
    ds_read_b64_tr_b16 v[98:99], v147 offset:47872
    ds_read_b64_tr_b16 v[100:101], v148 offset:47104
    ds_read_b64_tr_b16 v[102:103], v148 offset:47872
    ds_read_b64_tr_b16 v[104:105], v149 offset:47104
    ds_read_b64_tr_b16 v[106:107], v149 offset:47872
    s_add_u32 m0, s47, 61440
    s_add_u32 s50, s44, 3968
    buffer_load_dwordx4 v12, s[24:27], s50 offen lds
    s_add_u32 m0, s47, 62464
    s_add_u32 s50, s44, 50048
    buffer_load_dwordx4 v13, s[24:27], s50 offen lds
    s_add_u32 s50, s46, 1622016
    s_add_u32 m0, s49, 61440
    s_nop 0
    buffer_load_dwordx4 v14, s[52:55], s50 offen lds
    s_add_u32 m0, s49, 62464
    s_nop 0
    buffer_load_dwordx4 v15, s[52:55], s50 offen lds
    s_add_u32 m0, s49, 63488
    s_nop 0
    buffer_load_dwordx4 v16, s[52:55], s50 offen lds
    v_mfma_f32_16x16x32_bf16 v[28:31], v[108:111], v[68:71], v[28:31]
    v_mfma_f32_16x16x32_bf16 v[32:35], v[108:111], v[72:75], v[32:35]
    v_mfma_f32_16x16x32_bf16 v[36:39], v[112:115], v[68:71], v[36:39]
    v_mfma_f32_16x16x32_bf16 v[40:43], v[112:115], v[72:75], v[40:43]
    v_mfma_f32_16x16x32_bf16 v[44:47], v[116:119], v[68:71], v[44:47]
    v_mfma_f32_16x16x32_bf16 v[48:51], v[116:119], v[72:75], v[48:51]
    v_mfma_f32_16x16x32_bf16 v[28:31], v[120:123], v[76:79], v[28:31]
    v_mfma_f32_16x16x32_bf16 v[32:35], v[120:123], v[80:83], v[32:35]
    v_mfma_f32_16x16x32_bf16 v[36:39], v[124:127], v[76:79], v[36:39]
    v_mfma_f32_16x16x32_bf16 v[40:43], v[124:127], v[80:83], v[40:43]
    v_mfma_f32_16x16x32_bf16 v[44:47], v[128:131], v[76:79], v[44:47]
    v_mfma_f32_16x16x32_bf16 v[48:51], v[128:131], v[80:83], v[48:51]
    s_waitcnt vmcnt(20) lgkmcnt(0)
    s_barrier
    ds_read_b128 v[68:71], v21 offset:0
    ds_read_b128 v[72:75], v21 offset:2048
    ds_read_b64_tr_b16 v[108:109], v150 offset:0
    ds_read_b64_tr_b16 v[110:111], v150 offset:768
    ds_read_b64_tr_b16 v[112:113], v151 offset:0
    ds_read_b64_tr_b16 v[114:115], v151 offset:768
    ds_read_b64_tr_b16 v[116:117], v152 offset:0
    ds_read_b64_tr_b16 v[118:119], v152 offset:768
    ds_read_b128 v[76:79], v22 offset:0
    ds_read_b128 v[80:83], v22 offset:2048
    ds_read_b64_tr_b16 v[120:121], v150 offset:6144
    ds_read_b64_tr_b16 v[122:123], v150 offset:6912
    ds_read_b64_tr_b16 v[124:125], v151 offset:6144
    ds_read_b64_tr_b16 v[126:127], v151 offset:6912
    ds_read_b64_tr_b16 v[128:129], v152 offset:6144
    ds_read_b64_tr_b16 v[130:131], v152 offset:6912
    s_add_u32 m0, s47, 81920
    s_add_u32 s50, s44, 4096
    buffer_load_dwordx4 v12, s[24:27], s50 offen lds
    s_add_u32 m0, s47, 82944
    s_add_u32 s50, s44, 50176
    buffer_load_dwordx4 v13, s[24:27], s50 offen lds
    s_add_u32 s50, s46, 1695744
    s_add_u32 m0, s49, 81920
    s_nop 0
    buffer_load_dwordx4 v14, s[52:55], s50 offen lds
    s_add_u32 m0, s49, 82944
    s_nop 0
    buffer_load_dwordx4 v15, s[52:55], s50 offen lds
    s_add_u32 m0, s49, 83968
    s_nop 0
    buffer_load_dwordx4 v16, s[52:55], s50 offen lds
    v_mfma_f32_16x16x32_bf16 v[28:31], v[84:87], v[52:55], v[28:31]
    v_mfma_f32_16x16x32_bf16 v[32:35], v[84:87], v[56:59], v[32:35]
    v_mfma_f32_16x16x32_bf16 v[36:39], v[88:91], v[52:55], v[36:39]
    v_mfma_f32_16x16x32_bf16 v[40:43], v[88:91], v[56:59], v[40:43]
    v_mfma_f32_16x16x32_bf16 v[44:47], v[92:95], v[52:55], v[44:47]
    v_mfma_f32_16x16x32_bf16 v[48:51], v[92:95], v[56:59], v[48:51]
    v_mfma_f32_16x16x32_bf16 v[28:31], v[96:99], v[60:63], v[28:31]
    v_mfma_f32_16x16x32_bf16 v[32:35], v[96:99], v[64:67], v[32:35]
    v_mfma_f32_16x16x32_bf16 v[36:39], v[100:103], v[60:63], v[36:39]
    v_mfma_f32_16x16x32_bf16 v[40:43], v[100:103], v[64:67], v[40:43]
    v_mfma_f32_16x16x32_bf16 v[44:47], v[104:107], v[60:63], v[44:47]
    v_mfma_f32_16x16x32_bf16 v[48:51], v[104:107], v[64:67], v[48:51]
    s_waitcnt vmcnt(20) lgkmcnt(0)
    s_barrier
    ds_read_b128 v[52:55], v17 offset:0
    ds_read_b128 v[56:59], v17 offset:2048
    ds_read_b64_tr_b16 v[84:85], v144 offset:0
    ds_read_b64_tr_b16 v[86:87], v144 offset:768
    ds_read_b64_tr_b16 v[88:89], v145 offset:0
    ds_read_b64_tr_b16 v[90:91], v145 offset:768
    ds_read_b64_tr_b16 v[92:93], v146 offset:0
    ds_read_b64_tr_b16 v[94:95], v146 offset:768
    ds_read_b128 v[60:63], v18 offset:0
    ds_read_b128 v[64:67], v18 offset:2048
    ds_read_b64_tr_b16 v[96:97], v144 offset:6144
    ds_read_b64_tr_b16 v[98:99], v144 offset:6912
    ds_read_b64_tr_b16 v[100:101], v145 offset:6144
    ds_read_b64_tr_b16 v[102:103], v145 offset:6912
    ds_read_b64_tr_b16 v[104:105], v146 offset:6144
    ds_read_b64_tr_b16 v[106:107], v146 offset:6912
    s_add_u32 m0, s47, 102400
    s_add_u32 s50, s44, 4224
    buffer_load_dwordx4 v12, s[24:27], s50 offen lds
    s_add_u32 m0, s47, 103424
    s_add_u32 s50, s44, 50304
    buffer_load_dwordx4 v13, s[24:27], s50 offen lds
    s_add_u32 s50, s46, 1769472
    s_add_u32 m0, s49, 102400
    s_nop 0
    buffer_load_dwordx4 v14, s[52:55], s50 offen lds
    s_add_u32 m0, s49, 103424
    s_nop 0
    buffer_load_dwordx4 v15, s[52:55], s50 offen lds
    s_add_u32 m0, s49, 104448
    s_nop 0
    buffer_load_dwordx4 v16, s[52:55], s50 offen lds
    v_mfma_f32_16x16x32_bf16 v[28:31], v[108:111], v[68:71], v[28:31]
    v_mfma_f32_16x16x32_bf16 v[32:35], v[108:111], v[72:75], v[32:35]
    v_mfma_f32_16x16x32_bf16 v[36:39], v[112:115], v[68:71], v[36:39]
    v_mfma_f32_16x16x32_bf16 v[40:43], v[112:115], v[72:75], v[40:43]
    v_mfma_f32_16x16x32_bf16 v[44:47], v[116:119], v[68:71], v[44:47]
    v_mfma_f32_16x16x32_bf16 v[48:51], v[116:119], v[72:75], v[48:51]
    v_mfma_f32_16x16x32_bf16 v[28:31], v[120:123], v[76:79], v[28:31]
    v_mfma_f32_16x16x32_bf16 v[32:35], v[120:123], v[80:83], v[32:35]
    v_mfma_f32_16x16x32_bf16 v[36:39], v[124:127], v[76:79], v[36:39]
    v_mfma_f32_16x16x32_bf16 v[40:43], v[124:127], v[80:83], v[40:43]
    v_mfma_f32_16x16x32_bf16 v[44:47], v[128:131], v[76:79], v[44:47]
    v_mfma_f32_16x16x32_bf16 v[48:51], v[128:131], v[80:83], v[48:51]
    s_waitcnt vmcnt(20) lgkmcnt(0)
    s_barrier
    ds_read_b128 v[68:71], v17 offset:20480
    ds_read_b128 v[72:75], v17 offset:22528
    ds_read_b64_tr_b16 v[108:109], v144 offset:20480
    ds_read_b64_tr_b16 v[110:111], v144 offset:21248
    ds_read_b64_tr_b16 v[112:113], v145 offset:20480
    ds_read_b64_tr_b16 v[114:115], v145 offset:21248
    ds_read_b64_tr_b16 v[116:117], v146 offset:20480
    ds_read_b64_tr_b16 v[118:119], v146 offset:21248
    ds_read_b128 v[76:79], v18 offset:20480
    ds_read_b128 v[80:83], v18 offset:22528
    ds_read_b64_tr_b16 v[120:121], v144 offset:26624
    ds_read_b64_tr_b16 v[122:123], v144 offset:27392
    ds_read_b64_tr_b16 v[124:125], v145 offset:26624
    ds_read_b64_tr_b16 v[126:127], v145 offset:27392
    ds_read_b64_tr_b16 v[128:129], v146 offset:26624
    ds_read_b64_tr_b16 v[130:131], v146 offset:27392
    s_add_u32 m0, s47, 122880
    s_add_u32 s50, s44, 4352
    buffer_load_dwordx4 v12, s[24:27], s50 offen lds
    s_add_u32 m0, s47, 123904
    s_add_u32 s50, s44, 50432
    buffer_load_dwordx4 v13, s[24:27], s50 offen lds
    s_add_u32 s50, s46, 1843200
    s_add_u32 m0, s49, 122880
    s_nop 0
    buffer_load_dwordx4 v14, s[52:55], s50 offen lds
    s_add_u32 m0, s49, 123904
    s_nop 0
    buffer_load_dwordx4 v15, s[52:55], s50 offen lds
    s_add_u32 m0, s49, 124928
    s_nop 0
    buffer_load_dwordx4 v16, s[52:55], s50 offen lds
    v_mfma_f32_16x16x32_bf16 v[28:31], v[84:87], v[52:55], v[28:31]
    v_mfma_f32_16x16x32_bf16 v[32:35], v[84:87], v[56:59], v[32:35]
    v_mfma_f32_16x16x32_bf16 v[36:39], v[88:91], v[52:55], v[36:39]
    v_mfma_f32_16x16x32_bf16 v[40:43], v[88:91], v[56:59], v[40:43]
    v_mfma_f32_16x16x32_bf16 v[44:47], v[92:95], v[52:55], v[44:47]
    v_mfma_f32_16x16x32_bf16 v[48:51], v[92:95], v[56:59], v[48:51]
    v_mfma_f32_16x16x32_bf16 v[28:31], v[96:99], v[60:63], v[28:31]
    v_mfma_f32_16x16x32_bf16 v[32:35], v[96:99], v[64:67], v[32:35]
    v_mfma_f32_16x16x32_bf16 v[36:39], v[100:103], v[60:63], v[36:39]
    v_mfma_f32_16x16x32_bf16 v[40:43], v[100:103], v[64:67], v[40:43]
    v_mfma_f32_16x16x32_bf16 v[44:47], v[104:107], v[60:63], v[44:47]
    v_mfma_f32_16x16x32_bf16 v[48:51], v[104:107], v[64:67], v[48:51]
    s_waitcnt vmcnt(20) lgkmcnt(0)
    s_barrier
    ds_read_b128 v[52:55], v17 offset:40960
    ds_read_b128 v[56:59], v17 offset:43008
    ds_read_b64_tr_b16 v[84:85], v144 offset:40960
    ds_read_b64_tr_b16 v[86:87], v144 offset:41728
    ds_read_b64_tr_b16 v[88:89], v145 offset:40960
    ds_read_b64_tr_b16 v[90:91], v145 offset:41728
    ds_read_b64_tr_b16 v[92:93], v146 offset:40960
    ds_read_b64_tr_b16 v[94:95], v146 offset:41728
    ds_read_b128 v[60:63], v18 offset:40960
    ds_read_b128 v[64:67], v18 offset:43008
    ds_read_b64_tr_b16 v[96:97], v144 offset:47104
    ds_read_b64_tr_b16 v[98:99], v144 offset:47872
    ds_read_b64_tr_b16 v[100:101], v145 offset:47104
    ds_read_b64_tr_b16 v[102:103], v145 offset:47872
    ds_read_b64_tr_b16 v[104:105], v146 offset:47104
    ds_read_b64_tr_b16 v[106:107], v146 offset:47872
    s_add_u32 m0, s47, 0
    s_add_u32 s50, s44, 4480
    buffer_load_dwordx4 v12, s[24:27], s50 offen lds
    s_add_u32 m0, s47, 1024
    s_add_u32 s50, s44, 50560
    buffer_load_dwordx4 v13, s[24:27], s50 offen lds
    s_add_u32 s50, s46, 1916928
    s_add_u32 m0, s49, 0
    s_nop 0
    buffer_load_dwordx4 v14, s[52:55], s50 offen lds
    s_add_u32 m0, s49, 1024
    s_nop 0
    buffer_load_dwordx4 v15, s[52:55], s50 offen lds
    s_add_u32 m0, s49, 2048
    s_nop 0
    buffer_load_dwordx4 v16, s[52:55], s50 offen lds
    v_mfma_f32_16x16x32_bf16 v[28:31], v[108:111], v[68:71], v[28:31]
    v_mfma_f32_16x16x32_bf16 v[32:35], v[108:111], v[72:75], v[32:35]
    v_mfma_f32_16x16x32_bf16 v[36:39], v[112:115], v[68:71], v[36:39]
    v_mfma_f32_16x16x32_bf16 v[40:43], v[112:115], v[72:75], v[40:43]
    v_mfma_f32_16x16x32_bf16 v[44:47], v[116:119], v[68:71], v[44:47]
    v_mfma_f32_16x16x32_bf16 v[48:51], v[116:119], v[72:75], v[48:51]
    v_mfma_f32_16x16x32_bf16 v[28:31], v[120:123], v[76:79], v[28:31]
    v_mfma_f32_16x16x32_bf16 v[32:35], v[120:123], v[80:83], v[32:35]
    v_mfma_f32_16x16x32_bf16 v[36:39], v[124:127], v[76:79], v[36:39]
    v_mfma_f32_16x16x32_bf16 v[40:43], v[124:127], v[80:83], v[40:43]
    v_mfma_f32_16x16x32_bf16 v[44:47], v[128:131], v[76:79], v[44:47]
    v_mfma_f32_16x16x32_bf16 v[48:51], v[128:131], v[80:83], v[48:51]
    s_waitcnt vmcnt(20) lgkmcnt(0)
    s_barrier
    ds_read_b128 v[68:71], v19 offset:0
    ds_read_b128 v[72:75], v19 offset:2048
    ds_read_b64_tr_b16 v[108:109], v147 offset:0
    ds_read_b64_tr_b16 v[110:111], v147 offset:768
    ds_read_b64_tr_b16 v[112:113], v148 offset:0
    ds_read_b64_tr_b16 v[114:115], v148 offset:768
    ds_read_b64_tr_b16 v[116:117], v149 offset:0
    ds_read_b64_tr_b16 v[118:119], v149 offset:768
    ds_read_b128 v[76:79], v20 offset:0
    ds_read_b128 v[80:83], v20 offset:2048
    ds_read_b64_tr_b16 v[120:121], v147 offset:6144
    ds_read_b64_tr_b16 v[122:123], v147 offset:6912
    ds_read_b64_tr_b16 v[124:125], v148 offset:6144
    ds_read_b64_tr_b16 v[126:127], v148 offset:6912
    ds_read_b64_tr_b16 v[128:129], v149 offset:6144
    ds_read_b64_tr_b16 v[130:131], v149 offset:6912
    s_add_u32 m0, s47, 20480
    s_add_u32 s50, s44, 4608
    buffer_load_dwordx4 v12, s[24:27], s50 offen lds
    s_add_u32 m0, s47, 21504
    s_add_u32 s50, s44, 50688
    buffer_load_dwordx4 v13, s[24:27], s50 offen lds
    s_add_u32 s50, s46, 1990656
    s_add_u32 m0, s49, 20480
    s_nop 0
    buffer_load_dwordx4 v14, s[52:55], s50 offen lds
    s_add_u32 m0, s49, 21504
    s_nop 0
    buffer_load_dwordx4 v15, s[52:55], s50 offen lds
    s_add_u32 m0, s49, 22528
    s_nop 0
    buffer_load_dwordx4 v16, s[52:55], s50 offen lds
    v_mfma_f32_16x16x32_bf16 v[28:31], v[84:87], v[52:55], v[28:31]
    v_mfma_f32_16x16x32_bf16 v[32:35], v[84:87], v[56:59], v[32:35]
    v_mfma_f32_16x16x32_bf16 v[36:39], v[88:91], v[52:55], v[36:39]
    v_mfma_f32_16x16x32_bf16 v[40:43], v[88:91], v[56:59], v[40:43]
    v_mfma_f32_16x16x32_bf16 v[44:47], v[92:95], v[52:55], v[44:47]
    v_mfma_f32_16x16x32_bf16 v[48:51], v[92:95], v[56:59], v[48:51]
    v_mfma_f32_16x16x32_bf16 v[28:31], v[96:99], v[60:63], v[28:31]
    v_mfma_f32_16x16x32_bf16 v[32:35], v[96:99], v[64:67], v[32:35]
    v_mfma_f32_16x16x32_bf16 v[36:39], v[100:103], v[60:63], v[36:39]
    v_mfma_f32_16x16x32_bf16 v[40:43], v[100:103], v[64:67], v[40:43]
    v_mfma_f32_16x16x32_bf16 v[44:47], v[104:107], v[60:63], v[44:47]
    v_mfma_f32_16x16x32_bf16 v[48:51], v[104:107], v[64:67], v[48:51]
    s_waitcnt vmcnt(20) lgkmcnt(0)
    s_barrier
    ds_read_b128 v[52:55], v19 offset:20480
    ds_read_b128 v[56:59], v19 offset:22528
    ds_read_b64_tr_b16 v[84:85], v147 offset:20480
    ds_read_b64_tr_b16 v[86:87], v147 offset:21248
    ds_read_b64_tr_b16 v[88:89], v148 offset:20480
    ds_read_b64_tr_b16 v[90:91], v148 offset:21248
    ds_read_b64_tr_b16 v[92:93], v149 offset:20480
    ds_read_b64_tr_b16 v[94:95], v149 offset:21248
    ds_read_b128 v[60:63], v20 offset:20480
    ds_read_b128 v[64:67], v20 offset:22528
    ds_read_b64_tr_b16 v[96:97], v147 offset:26624
    ds_read_b64_tr_b16 v[98:99], v147 offset:27392
    ds_read_b64_tr_b16 v[100:101], v148 offset:26624
    ds_read_b64_tr_b16 v[102:103], v148 offset:27392
    ds_read_b64_tr_b16 v[104:105], v149 offset:26624
    ds_read_b64_tr_b16 v[106:107], v149 offset:27392
    s_add_u32 m0, s47, 40960
    s_add_u32 s50, s44, 4736
    buffer_load_dwordx4 v12, s[24:27], s50 offen lds
    s_add_u32 m0, s47, 41984
    s_add_u32 s50, s44, 50816
    buffer_load_dwordx4 v13, s[24:27], s50 offen lds
    s_add_u32 s50, s46, 2064384
    s_add_u32 m0, s49, 40960
    s_nop 0
    buffer_load_dwordx4 v14, s[52:55], s50 offen lds
    s_add_u32 m0, s49, 41984
    s_nop 0
    buffer_load_dwordx4 v15, s[52:55], s50 offen lds
    s_add_u32 m0, s49, 43008
    s_nop 0
    buffer_load_dwordx4 v16, s[52:55], s50 offen lds
    v_mfma_f32_16x16x32_bf16 v[28:31], v[108:111], v[68:71], v[28:31]
    v_mfma_f32_16x16x32_bf16 v[32:35], v[108:111], v[72:75], v[32:35]
    v_mfma_f32_16x16x32_bf16 v[36:39], v[112:115], v[68:71], v[36:39]
    v_mfma_f32_16x16x32_bf16 v[40:43], v[112:115], v[72:75], v[40:43]
    v_mfma_f32_16x16x32_bf16 v[44:47], v[116:119], v[68:71], v[44:47]
    v_mfma_f32_16x16x32_bf16 v[48:51], v[116:119], v[72:75], v[48:51]
    v_mfma_f32_16x16x32_bf16 v[28:31], v[120:123], v[76:79], v[28:31]
    v_mfma_f32_16x16x32_bf16 v[32:35], v[120:123], v[80:83], v[32:35]
    v_mfma_f32_16x16x32_bf16 v[36:39], v[124:127], v[76:79], v[36:39]
    v_mfma_f32_16x16x32_bf16 v[40:43], v[124:127], v[80:83], v[40:43]
    v_mfma_f32_16x16x32_bf16 v[44:47], v[128:131], v[76:79], v[44:47]
    v_mfma_f32_16x16x32_bf16 v[48:51], v[128:131], v[80:83], v[48:51]
    s_waitcnt vmcnt(20) lgkmcnt(0)
    s_barrier
    ds_read_b128 v[68:71], v19 offset:40960
    ds_read_b128 v[72:75], v19 offset:43008
    ds_read_b64_tr_b16 v[108:109], v147 offset:40960
    ds_read_b64_tr_b16 v[110:111], v147 offset:41728
    ds_read_b64_tr_b16 v[112:113], v148 offset:40960
    ds_read_b64_tr_b16 v[114:115], v148 offset:41728
    ds_read_b64_tr_b16 v[116:117], v149 offset:40960
    ds_read_b64_tr_b16 v[118:119], v149 offset:41728
    ds_read_b128 v[76:79], v20 offset:40960
    ds_read_b128 v[80:83], v20 offset:43008
    ds_read_b64_tr_b16 v[120:121], v147 offset:47104
    ds_read_b64_tr_b16 v[122:123], v147 offset:47872
    ds_read_b64_tr_b16 v[124:125], v148 offset:47104
    ds_read_b64_tr_b16 v[126:127], v148 offset:47872
    ds_read_b64_tr_b16 v[128:129], v149 offset:47104
    ds_read_b64_tr_b16 v[130:131], v149 offset:47872
    s_add_u32 m0, s47, 61440
    s_add_u32 s50, s44, 4864
    buffer_load_dwordx4 v12, s[24:27], s50 offen lds
    s_add_u32 m0, s47, 62464
    s_add_u32 s50, s44, 50944
    buffer_load_dwordx4 v13, s[24:27], s50 offen lds
    s_add_u32 s50, s46, 2138112
    s_add_u32 m0, s49, 61440
    s_nop 0
    buffer_load_dwordx4 v14, s[52:55], s50 offen lds
    s_add_u32 m0, s49, 62464
    s_nop 0
    buffer_load_dwordx4 v15, s[52:55], s50 offen lds
    s_add_u32 m0, s49, 63488
    s_nop 0
    buffer_load_dwordx4 v16, s[52:55], s50 offen lds
    v_mfma_f32_16x16x32_bf16 v[28:31], v[84:87], v[52:55], v[28:31]
    v_mfma_f32_16x16x32_bf16 v[32:35], v[84:87], v[56:59], v[32:35]
    v_mfma_f32_16x16x32_bf16 v[36:39], v[88:91], v[52:55], v[36:39]
    v_mfma_f32_16x16x32_bf16 v[40:43], v[88:91], v[56:59], v[40:43]
    v_mfma_f32_16x16x32_bf16 v[44:47], v[92:95], v[52:55], v[44:47]
    v_mfma_f32_16x16x32_bf16 v[48:51], v[92:95], v[56:59], v[48:51]
    v_mfma_f32_16x16x32_bf16 v[28:31], v[96:99], v[60:63], v[28:31]
    v_mfma_f32_16x16x32_bf16 v[32:35], v[96:99], v[64:67], v[32:35]
    v_mfma_f32_16x16x32_bf16 v[36:39], v[100:103], v[60:63], v[36:39]
    v_mfma_f32_16x16x32_bf16 v[40:43], v[100:103], v[64:67], v[40:43]
    v_mfma_f32_16x16x32_bf16 v[44:47], v[104:107], v[60:63], v[44:47]
    v_mfma_f32_16x16x32_bf16 v[48:51], v[104:107], v[64:67], v[48:51]
    s_waitcnt vmcnt(20) lgkmcnt(0)
    s_barrier
    ds_read_b128 v[52:55], v21 offset:0
    ds_read_b128 v[56:59], v21 offset:2048
    ds_read_b64_tr_b16 v[84:85], v150 offset:0
    ds_read_b64_tr_b16 v[86:87], v150 offset:768
    ds_read_b64_tr_b16 v[88:89], v151 offset:0
    ds_read_b64_tr_b16 v[90:91], v151 offset:768
    ds_read_b64_tr_b16 v[92:93], v152 offset:0
    ds_read_b64_tr_b16 v[94:95], v152 offset:768
    ds_read_b128 v[60:63], v22 offset:0
    ds_read_b128 v[64:67], v22 offset:2048
    ds_read_b64_tr_b16 v[96:97], v150 offset:6144
    ds_read_b64_tr_b16 v[98:99], v150 offset:6912
    ds_read_b64_tr_b16 v[100:101], v151 offset:6144
    ds_read_b64_tr_b16 v[102:103], v151 offset:6912
    ds_read_b64_tr_b16 v[104:105], v152 offset:6144
    ds_read_b64_tr_b16 v[106:107], v152 offset:6912
    s_add_u32 m0, s47, 81920
    s_add_u32 s50, s44, 4992
    buffer_load_dwordx4 v12, s[24:27], s50 offen lds
    s_add_u32 m0, s47, 82944
    s_add_u32 s50, s44, 51072
    buffer_load_dwordx4 v13, s[24:27], s50 offen lds
    s_add_u32 s50, s46, 2211840
    s_add_u32 m0, s49, 81920
    s_nop 0
    buffer_load_dwordx4 v14, s[52:55], s50 offen lds
    s_add_u32 m0, s49, 82944
    s_nop 0
    buffer_load_dwordx4 v15, s[52:55], s50 offen lds
    s_add_u32 m0, s49, 83968
    s_nop 0
    buffer_load_dwordx4 v16, s[52:55], s50 offen lds
    v_mfma_f32_16x16x32_bf16 v[28:31], v[108:111], v[68:71], v[28:31]
    v_mfma_f32_16x16x32_bf16 v[32:35], v[108:111], v[72:75], v[32:35]
    v_mfma_f32_16x16x32_bf16 v[36:39], v[112:115], v[68:71], v[36:39]
    v_mfma_f32_16x16x32_bf16 v[40:43], v[112:115], v[72:75], v[40:43]
    v_mfma_f32_16x16x32_bf16 v[44:47], v[116:119], v[68:71], v[44:47]
    v_mfma_f32_16x16x32_bf16 v[48:51], v[116:119], v[72:75], v[48:51]
    v_mfma_f32_16x16x32_bf16 v[28:31], v[120:123], v[76:79], v[28:31]
    v_mfma_f32_16x16x32_bf16 v[32:35], v[120:123], v[80:83], v[32:35]
    v_mfma_f32_16x16x32_bf16 v[36:39], v[124:127], v[76:79], v[36:39]
    v_mfma_f32_16x16x32_bf16 v[40:43], v[124:127], v[80:83], v[40:43]
    v_mfma_f32_16x16x32_bf16 v[44:47], v[128:131], v[76:79], v[44:47]
    v_mfma_f32_16x16x32_bf16 v[48:51], v[128:131], v[80:83], v[48:51]
    s_waitcnt vmcnt(20) lgkmcnt(0)
    s_barrier
    ds_read_b128 v[68:71], v17 offset:0
    ds_read_b128 v[72:75], v17 offset:2048
    ds_read_b64_tr_b16 v[108:109], v144 offset:0
    ds_read_b64_tr_b16 v[110:111], v144 offset:768
    ds_read_b64_tr_b16 v[112:113], v145 offset:0
    ds_read_b64_tr_b16 v[114:115], v145 offset:768
    ds_read_b64_tr_b16 v[116:117], v146 offset:0
    ds_read_b64_tr_b16 v[118:119], v146 offset:768
    ds_read_b128 v[76:79], v18 offset:0
    ds_read_b128 v[80:83], v18 offset:2048
    ds_read_b64_tr_b16 v[120:121], v144 offset:6144
    ds_read_b64_tr_b16 v[122:123], v144 offset:6912
    ds_read_b64_tr_b16 v[124:125], v145 offset:6144
    ds_read_b64_tr_b16 v[126:127], v145 offset:6912
    ds_read_b64_tr_b16 v[128:129], v146 offset:6144
    ds_read_b64_tr_b16 v[130:131], v146 offset:6912
    s_add_u32 m0, s47, 102400
    s_add_u32 s50, s44, 5120
    buffer_load_dwordx4 v12, s[24:27], s50 offen lds
    s_add_u32 m0, s47, 103424
    s_add_u32 s50, s44, 51200
    buffer_load_dwordx4 v13, s[24:27], s50 offen lds
    s_add_u32 s50, s46, 2285568
    s_add_u32 m0, s49, 102400
    s_nop 0
    buffer_load_dwordx4 v14, s[52:55], s50 offen lds
    s_add_u32 m0, s49, 103424
    s_nop 0
    buffer_load_dwordx4 v15, s[52:55], s50 offen lds
    s_add_u32 m0, s49, 104448
    s_nop 0
    buffer_load_dwordx4 v16, s[52:55], s50 offen lds
    v_mfma_f32_16x16x32_bf16 v[28:31], v[84:87], v[52:55], v[28:31]
    v_mfma_f32_16x16x32_bf16 v[32:35], v[84:87], v[56:59], v[32:35]
    v_mfma_f32_16x16x32_bf16 v[36:39], v[88:91], v[52:55], v[36:39]
    v_mfma_f32_16x16x32_bf16 v[40:43], v[88:91], v[56:59], v[40:43]
    v_mfma_f32_16x16x32_bf16 v[44:47], v[92:95], v[52:55], v[44:47]
    v_mfma_f32_16x16x32_bf16 v[48:51], v[92:95], v[56:59], v[48:51]
    v_mfma_f32_16x16x32_bf16 v[28:31], v[96:99], v[60:63], v[28:31]
    v_mfma_f32_16x16x32_bf16 v[32:35], v[96:99], v[64:67], v[32:35]
    v_mfma_f32_16x16x32_bf16 v[36:39], v[100:103], v[60:63], v[36:39]
    v_mfma_f32_16x16x32_bf16 v[40:43], v[100:103], v[64:67], v[40:43]
    v_mfma_f32_16x16x32_bf16 v[44:47], v[104:107], v[60:63], v[44:47]
    v_mfma_f32_16x16x32_bf16 v[48:51], v[104:107], v[64:67], v[48:51]
    s_waitcnt vmcnt(20) lgkmcnt(0)
    s_barrier
    ds_read_b128 v[52:55], v17 offset:20480
    ds_read_b128 v[56:59], v17 offset:22528
    ds_read_b64_tr_b16 v[84:85], v144 offset:20480
    ds_read_b64_tr_b16 v[86:87], v144 offset:21248
    ds_read_b64_tr_b16 v[88:89], v145 offset:20480
    ds_read_b64_tr_b16 v[90:91], v145 offset:21248
    ds_read_b64_tr_b16 v[92:93], v146 offset:20480
    ds_read_b64_tr_b16 v[94:95], v146 offset:21248
    ds_read_b128 v[60:63], v18 offset:20480
    ds_read_b128 v[64:67], v18 offset:22528
    ds_read_b64_tr_b16 v[96:97], v144 offset:26624
    ds_read_b64_tr_b16 v[98:99], v144 offset:27392
    ds_read_b64_tr_b16 v[100:101], v145 offset:26624
    ds_read_b64_tr_b16 v[102:103], v145 offset:27392
    ds_read_b64_tr_b16 v[104:105], v146 offset:26624
    ds_read_b64_tr_b16 v[106:107], v146 offset:27392
    s_add_u32 m0, s47, 122880
    s_add_u32 s50, s44, 5248
    buffer_load_dwordx4 v12, s[24:27], s50 offen lds
    s_add_u32 m0, s47, 123904
    s_add_u32 s50, s44, 51328
    buffer_load_dwordx4 v13, s[24:27], s50 offen lds
    s_add_u32 s50, s46, 2359296
    s_add_u32 m0, s49, 122880
    s_nop 0
    buffer_load_dwordx4 v14, s[52:55], s50 offen lds
    s_add_u32 m0, s49, 123904
    s_nop 0
    buffer_load_dwordx4 v15, s[52:55], s50 offen lds
    s_add_u32 m0, s49, 124928
    s_nop 0
    buffer_load_dwordx4 v16, s[52:55], s50 offen lds
    v_mfma_f32_16x16x32_bf16 v[28:31], v[108:111], v[68:71], v[28:31]
    v_mfma_f32_16x16x32_bf16 v[32:35], v[108:111], v[72:75], v[32:35]
    v_mfma_f32_16x16x32_bf16 v[36:39], v[112:115], v[68:71], v[36:39]
    v_mfma_f32_16x16x32_bf16 v[40:43], v[112:115], v[72:75], v[40:43]
    v_mfma_f32_16x16x32_bf16 v[44:47], v[116:119], v[68:71], v[44:47]
    v_mfma_f32_16x16x32_bf16 v[48:51], v[116:119], v[72:75], v[48:51]
    v_mfma_f32_16x16x32_bf16 v[28:31], v[120:123], v[76:79], v[28:31]
    v_mfma_f32_16x16x32_bf16 v[32:35], v[120:123], v[80:83], v[32:35]
    v_mfma_f32_16x16x32_bf16 v[36:39], v[124:127], v[76:79], v[36:39]
    v_mfma_f32_16x16x32_bf16 v[40:43], v[124:127], v[80:83], v[40:43]
    v_mfma_f32_16x16x32_bf16 v[44:47], v[128:131], v[76:79], v[44:47]
    v_mfma_f32_16x16x32_bf16 v[48:51], v[128:131], v[80:83], v[48:51]
    s_waitcnt vmcnt(20) lgkmcnt(0)
    s_barrier
    ds_read_b128 v[68:71], v17 offset:40960
    ds_read_b128 v[72:75], v17 offset:43008
    ds_read_b64_tr_b16 v[108:109], v144 offset:40960
    ds_read_b64_tr_b16 v[110:111], v144 offset:41728
    ds_read_b64_tr_b16 v[112:113], v145 offset:40960
    ds_read_b64_tr_b16 v[114:115], v145 offset:41728
    ds_read_b64_tr_b16 v[116:117], v146 offset:40960
    ds_read_b64_tr_b16 v[118:119], v146 offset:41728
    ds_read_b128 v[76:79], v18 offset:40960
    ds_read_b128 v[80:83], v18 offset:43008
    ds_read_b64_tr_b16 v[120:121], v144 offset:47104
    ds_read_b64_tr_b16 v[122:123], v144 offset:47872
    ds_read_b64_tr_b16 v[124:125], v145 offset:47104
    ds_read_b64_tr_b16 v[126:127], v145 offset:47872
    ds_read_b64_tr_b16 v[128:129], v146 offset:47104
    ds_read_b64_tr_b16 v[130:131], v146 offset:47872
    s_add_u32 m0, s47, 0
    s_add_u32 s50, s44, 5376
    buffer_load_dwordx4 v12, s[24:27], s50 offen lds
    s_add_u32 m0, s47, 1024
    s_add_u32 s50, s44, 51456
    buffer_load_dwordx4 v13, s[24:27], s50 offen lds
    s_add_u32 s50, s46, 2433024
    s_add_u32 m0, s49, 0
    s_nop 0
    buffer_load_dwordx4 v14, s[52:55], s50 offen lds
    s_add_u32 m0, s49, 1024
    s_nop 0
    buffer_load_dwordx4 v15, s[52:55], s50 offen lds
    s_add_u32 m0, s49, 2048
    s_nop 0
    buffer_load_dwordx4 v16, s[52:55], s50 offen lds
    v_mfma_f32_16x16x32_bf16 v[28:31], v[84:87], v[52:55], v[28:31]
    v_mfma_f32_16x16x32_bf16 v[32:35], v[84:87], v[56:59], v[32:35]
    v_mfma_f32_16x16x32_bf16 v[36:39], v[88:91], v[52:55], v[36:39]
    v_mfma_f32_16x16x32_bf16 v[40:43], v[88:91], v[56:59], v[40:43]
    v_mfma_f32_16x16x32_bf16 v[44:47], v[92:95], v[52:55], v[44:47]
    v_mfma_f32_16x16x32_bf16 v[48:51], v[92:95], v[56:59], v[48:51]
    v_mfma_f32_16x16x32_bf16 v[28:31], v[96:99], v[60:63], v[28:31]
    v_mfma_f32_16x16x32_bf16 v[32:35], v[96:99], v[64:67], v[32:35]
    v_mfma_f32_16x16x32_bf16 v[36:39], v[100:103], v[60:63], v[36:39]
    v_mfma_f32_16x16x32_bf16 v[40:43], v[100:103], v[64:67], v[40:43]
    v_mfma_f32_16x16x32_bf16 v[44:47], v[104:107], v[60:63], v[44:47]
    v_mfma_f32_16x16x32_bf16 v[48:51], v[104:107], v[64:67], v[48:51]
    s_waitcnt vmcnt(20) lgkmcnt(0)
    s_barrier
    ds_read_b128 v[52:55], v19 offset:0
    ds_read_b128 v[56:59], v19 offset:2048
    ds_read_b64_tr_b16 v[84:85], v147 offset:0
    ds_read_b64_tr_b16 v[86:87], v147 offset:768
    ds_read_b64_tr_b16 v[88:89], v148 offset:0
    ds_read_b64_tr_b16 v[90:91], v148 offset:768
    ds_read_b64_tr_b16 v[92:93], v149 offset:0
    ds_read_b64_tr_b16 v[94:95], v149 offset:768
    ds_read_b128 v[60:63], v20 offset:0
    ds_read_b128 v[64:67], v20 offset:2048
    ds_read_b64_tr_b16 v[96:97], v147 offset:6144
    ds_read_b64_tr_b16 v[98:99], v147 offset:6912
    ds_read_b64_tr_b16 v[100:101], v148 offset:6144
    ds_read_b64_tr_b16 v[102:103], v148 offset:6912
    ds_read_b64_tr_b16 v[104:105], v149 offset:6144
    ds_read_b64_tr_b16 v[106:107], v149 offset:6912
    s_add_u32 m0, s47, 20480
    s_add_u32 s50, s44, 5504
    buffer_load_dwordx4 v12, s[24:27], s50 offen lds
    s_add_u32 m0, s47, 21504
    s_add_u32 s50, s44, 51584
    buffer_load_dwordx4 v13, s[24:27], s50 offen lds
    s_add_u32 s50, s46, 2506752
    s_add_u32 m0, s49, 20480
    s_nop 0
    buffer_load_dwordx4 v14, s[52:55], s50 offen lds
    s_add_u32 m0, s49, 21504
    s_nop 0
    buffer_load_dwordx4 v15, s[52:55], s50 offen lds
    s_add_u32 m0, s49, 22528
    s_nop 0
    buffer_load_dwordx4 v16, s[52:55], s50 offen lds
    v_mfma_f32_16x16x32_bf16 v[28:31], v[108:111], v[68:71], v[28:31]
    v_mfma_f32_16x16x32_bf16 v[32:35], v[108:111], v[72:75], v[32:35]
    v_mfma_f32_16x16x32_bf16 v[36:39], v[112:115], v[68:71], v[36:39]
    v_mfma_f32_16x16x32_bf16 v[40:43], v[112:115], v[72:75], v[40:43]
    v_mfma_f32_16x16x32_bf16 v[44:47], v[116:119], v[68:71], v[44:47]
    v_mfma_f32_16x16x32_bf16 v[48:51], v[116:119], v[72:75], v[48:51]
    v_mfma_f32_16x16x32_bf16 v[28:31], v[120:123], v[76:79], v[28:31]
    v_mfma_f32_16x16x32_bf16 v[32:35], v[120:123], v[80:83], v[32:35]
    v_mfma_f32_16x16x32_bf16 v[36:39], v[124:127], v[76:79], v[36:39]
    v_mfma_f32_16x16x32_bf16 v[40:43], v[124:127], v[80:83], v[40:43]
    v_mfma_f32_16x16x32_bf16 v[44:47], v[128:131], v[76:79], v[44:47]
    v_mfma_f32_16x16x32_bf16 v[48:51], v[128:131], v[80:83], v[48:51]
    s_waitcnt vmcnt(20) lgkmcnt(0)
    s_barrier
    ds_read_b128 v[68:71], v19 offset:20480
    ds_read_b128 v[72:75], v19 offset:22528
    ds_read_b64_tr_b16 v[108:109], v147 offset:20480
    ds_read_b64_tr_b16 v[110:111], v147 offset:21248
    ds_read_b64_tr_b16 v[112:113], v148 offset:20480
    ds_read_b64_tr_b16 v[114:115], v148 offset:21248
    ds_read_b64_tr_b16 v[116:117], v149 offset:20480
    ds_read_b64_tr_b16 v[118:119], v149 offset:21248
    ds_read_b128 v[76:79], v20 offset:20480
    ds_read_b128 v[80:83], v20 offset:22528
    ds_read_b64_tr_b16 v[120:121], v147 offset:26624
    ds_read_b64_tr_b16 v[122:123], v147 offset:27392
    ds_read_b64_tr_b16 v[124:125], v148 offset:26624
    ds_read_b64_tr_b16 v[126:127], v148 offset:27392
    ds_read_b64_tr_b16 v[128:129], v149 offset:26624
    ds_read_b64_tr_b16 v[130:131], v149 offset:27392
    s_add_u32 m0, s47, 40960
    s_add_u32 s50, s44, 5632
    buffer_load_dwordx4 v12, s[24:27], s50 offen lds
    s_add_u32 m0, s47, 41984
    s_add_u32 s50, s44, 51712
    buffer_load_dwordx4 v13, s[24:27], s50 offen lds
    s_add_u32 s50, s46, 2580480
    s_add_u32 m0, s49, 40960
    s_nop 0
    buffer_load_dwordx4 v14, s[52:55], s50 offen lds
    s_add_u32 m0, s49, 41984
    s_nop 0
    buffer_load_dwordx4 v15, s[52:55], s50 offen lds
    s_add_u32 m0, s49, 43008
    s_nop 0
    buffer_load_dwordx4 v16, s[52:55], s50 offen lds
    v_mfma_f32_16x16x32_bf16 v[28:31], v[84:87], v[52:55], v[28:31]
    v_mfma_f32_16x16x32_bf16 v[32:35], v[84:87], v[56:59], v[32:35]
    v_mfma_f32_16x16x32_bf16 v[36:39], v[88:91], v[52:55], v[36:39]
    v_mfma_f32_16x16x32_bf16 v[40:43], v[88:91], v[56:59], v[40:43]
    v_mfma_f32_16x16x32_bf16 v[44:47], v[92:95], v[52:55], v[44:47]
    v_mfma_f32_16x16x32_bf16 v[48:51], v[92:95], v[56:59], v[48:51]
    v_mfma_f32_16x16x32_bf16 v[28:31], v[96:99], v[60:63], v[28:31]
    v_mfma_f32_16x16x32_bf16 v[32:35], v[96:99], v[64:67], v[32:35]
    v_mfma_f32_16x16x32_bf16 v[36:39], v[100:103], v[60:63], v[36:39]
    v_mfma_f32_16x16x32_bf16 v[40:43], v[100:103], v[64:67], v[40:43]
    v_mfma_f32_16x16x32_bf16 v[44:47], v[104:107], v[60:63], v[44:47]
    v_mfma_f32_16x16x32_bf16 v[48:51], v[104:107], v[64:67], v[48:51]
    s_waitcnt vmcnt(20) lgkmcnt(0)
    s_barrier
    ds_read_b128 v[52:55], v19 offset:40960
    ds_read_b128 v[56:59], v19 offset:43008
    ds_read_b64_tr_b16 v[84:85], v147 offset:40960
    ds_read_b64_tr_b16 v[86:87], v147 offset:41728
    ds_read_b64_tr_b16 v[88:89], v148 offset:40960
    ds_read_b64_tr_b16 v[90:91], v148 offset:41728
    ds_read_b64_tr_b16 v[92:93], v149 offset:40960
    ds_read_b64_tr_b16 v[94:95], v149 offset:41728
    ds_read_b128 v[60:63], v20 offset:40960
    ds_read_b128 v[64:67], v20 offset:43008
    ds_read_b64_tr_b16 v[96:97], v147 offset:47104
    ds_read_b64_tr_b16 v[98:99], v147 offset:47872
    ds_read_b64_tr_b16 v[100:101], v148 offset:47104
    ds_read_b64_tr_b16 v[102:103], v148 offset:47872
    ds_read_b64_tr_b16 v[104:105], v149 offset:47104
    ds_read_b64_tr_b16 v[106:107], v149 offset:47872
    v_mfma_f32_16x16x32_bf16 v[28:31], v[108:111], v[68:71], v[28:31]
    v_mfma_f32_16x16x32_bf16 v[32:35], v[108:111], v[72:75], v[32:35]
    v_mfma_f32_16x16x32_bf16 v[36:39], v[112:115], v[68:71], v[36:39]
    v_mfma_f32_16x16x32_bf16 v[40:43], v[112:115], v[72:75], v[40:43]
    v_mfma_f32_16x16x32_bf16 v[44:47], v[116:119], v[68:71], v[44:47]
    v_mfma_f32_16x16x32_bf16 v[48:51], v[116:119], v[72:75], v[48:51]
    v_mfma_f32_16x16x32_bf16 v[28:31], v[120:123], v[76:79], v[28:31]
    v_mfma_f32_16x16x32_bf16 v[32:35], v[120:123], v[80:83], v[32:35]
    v_mfma_f32_16x16x32_bf16 v[36:39], v[124:127], v[76:79], v[36:39]
    v_mfma_f32_16x16x32_bf16 v[40:43], v[124:127], v[80:83], v[40:43]
    v_mfma_f32_16x16x32_bf16 v[44:47], v[128:131], v[76:79], v[44:47]
    v_mfma_f32_16x16x32_bf16 v[48:51], v[128:131], v[80:83], v[48:51]
    s_waitcnt vmcnt(15) lgkmcnt(0)
    s_barrier
    ds_read_b128 v[68:71], v21 offset:0
    ds_read_b128 v[72:75], v21 offset:2048
    ds_read_b64_tr_b16 v[108:109], v150 offset:0
    ds_read_b64_tr_b16 v[110:111], v150 offset:768
    ds_read_b64_tr_b16 v[112:113], v151 offset:0
    ds_read_b64_tr_b16 v[114:115], v151 offset:768
    ds_read_b64_tr_b16 v[116:117], v152 offset:0
    ds_read_b64_tr_b16 v[118:119], v152 offset:768
    ds_read_b128 v[76:79], v22 offset:0
    ds_read_b128 v[80:83], v22 offset:2048
    ds_read_b64_tr_b16 v[120:121], v150 offset:6144
    ds_read_b64_tr_b16 v[122:123], v150 offset:6912
    ds_read_b64_tr_b16 v[124:125], v151 offset:6144
    ds_read_b64_tr_b16 v[126:127], v151 offset:6912
    ds_read_b64_tr_b16 v[128:129], v152 offset:6144
    ds_read_b64_tr_b16 v[130:131], v152 offset:6912
    v_mfma_f32_16x16x32_bf16 v[28:31], v[84:87], v[52:55], v[28:31]
    v_mfma_f32_16x16x32_bf16 v[32:35], v[84:87], v[56:59], v[32:35]
    v_mfma_f32_16x16x32_bf16 v[36:39], v[88:91], v[52:55], v[36:39]
    v_mfma_f32_16x16x32_bf16 v[40:43], v[88:91], v[56:59], v[40:43]
    v_mfma_f32_16x16x32_bf16 v[44:47], v[92:95], v[52:55], v[44:47]
    v_mfma_f32_16x16x32_bf16 v[48:51], v[92:95], v[56:59], v[48:51]
    v_mfma_f32_16x16x32_bf16 v[28:31], v[96:99], v[60:63], v[28:31]
    v_mfma_f32_16x16x32_bf16 v[32:35], v[96:99], v[64:67], v[32:35]
    v_mfma_f32_16x16x32_bf16 v[36:39], v[100:103], v[60:63], v[36:39]
    v_mfma_f32_16x16x32_bf16 v[40:43], v[100:103], v[64:67], v[40:43]
    v_mfma_f32_16x16x32_bf16 v[44:47], v[104:107], v[60:63], v[44:47]
    v_mfma_f32_16x16x32_bf16 v[48:51], v[104:107], v[64:67], v[48:51]
    s_waitcnt vmcnt(10) lgkmcnt(0)
    s_barrier
    ds_read_b128 v[52:55], v17 offset:0
    ds_read_b128 v[56:59], v17 offset:2048
    ds_read_b64_tr_b16 v[84:85], v144 offset:0
    ds_read_b64_tr_b16 v[86:87], v144 offset:768
    ds_read_b64_tr_b16 v[88:89], v145 offset:0
    ds_read_b64_tr_b16 v[90:91], v145 offset:768
    ds_read_b64_tr_b16 v[92:93], v146 offset:0
    ds_read_b64_tr_b16 v[94:95], v146 offset:768
    ds_read_b128 v[60:63], v18 offset:0
    ds_read_b128 v[64:67], v18 offset:2048
    ds_read_b64_tr_b16 v[96:97], v144 offset:6144
    ds_read_b64_tr_b16 v[98:99], v144 offset:6912
    ds_read_b64_tr_b16 v[100:101], v145 offset:6144
    ds_read_b64_tr_b16 v[102:103], v145 offset:6912
    ds_read_b64_tr_b16 v[104:105], v146 offset:6144
    ds_read_b64_tr_b16 v[106:107], v146 offset:6912
    v_mfma_f32_16x16x32_bf16 v[28:31], v[108:111], v[68:71], v[28:31]
    v_mfma_f32_16x16x32_bf16 v[32:35], v[108:111], v[72:75], v[32:35]
    v_mfma_f32_16x16x32_bf16 v[36:39], v[112:115], v[68:71], v[36:39]
    v_mfma_f32_16x16x32_bf16 v[40:43], v[112:115], v[72:75], v[40:43]
    v_mfma_f32_16x16x32_bf16 v[44:47], v[116:119], v[68:71], v[44:47]
    v_mfma_f32_16x16x32_bf16 v[48:51], v[116:119], v[72:75], v[48:51]
    v_mfma_f32_16x16x32_bf16 v[28:31], v[120:123], v[76:79], v[28:31]
    v_mfma_f32_16x16x32_bf16 v[32:35], v[120:123], v[80:83], v[32:35]
    v_mfma_f32_16x16x32_bf16 v[36:39], v[124:127], v[76:79], v[36:39]
    v_mfma_f32_16x16x32_bf16 v[40:43], v[124:127], v[80:83], v[40:43]
    v_mfma_f32_16x16x32_bf16 v[44:47], v[128:131], v[76:79], v[44:47]
    v_mfma_f32_16x16x32_bf16 v[48:51], v[128:131], v[80:83], v[48:51]
    s_waitcnt vmcnt(5) lgkmcnt(0)
    s_barrier
    ds_read_b128 v[68:71], v17 offset:20480
    ds_read_b128 v[72:75], v17 offset:22528
    ds_read_b64_tr_b16 v[108:109], v144 offset:20480
    ds_read_b64_tr_b16 v[110:111], v144 offset:21248
    ds_read_b64_tr_b16 v[112:113], v145 offset:20480
    ds_read_b64_tr_b16 v[114:115], v145 offset:21248
    ds_read_b64_tr_b16 v[116:117], v146 offset:20480
    ds_read_b64_tr_b16 v[118:119], v146 offset:21248
    ds_read_b128 v[76:79], v18 offset:20480
    ds_read_b128 v[80:83], v18 offset:22528
    ds_read_b64_tr_b16 v[120:121], v144 offset:26624
    ds_read_b64_tr_b16 v[122:123], v144 offset:27392
    ds_read_b64_tr_b16 v[124:125], v145 offset:26624
    ds_read_b64_tr_b16 v[126:127], v145 offset:27392
    ds_read_b64_tr_b16 v[128:129], v146 offset:26624
    ds_read_b64_tr_b16 v[130:131], v146 offset:27392
    v_mfma_f32_16x16x32_bf16 v[28:31], v[84:87], v[52:55], v[28:31]
    v_mfma_f32_16x16x32_bf16 v[32:35], v[84:87], v[56:59], v[32:35]
    v_mfma_f32_16x16x32_bf16 v[36:39], v[88:91], v[52:55], v[36:39]
    v_mfma_f32_16x16x32_bf16 v[40:43], v[88:91], v[56:59], v[40:43]
    v_mfma_f32_16x16x32_bf16 v[44:47], v[92:95], v[52:55], v[44:47]
    v_mfma_f32_16x16x32_bf16 v[48:51], v[92:95], v[56:59], v[48:51]
    v_mfma_f32_16x16x32_bf16 v[28:31], v[96:99], v[60:63], v[28:31]
    v_mfma_f32_16x16x32_bf16 v[32:35], v[96:99], v[64:67], v[32:35]
    v_mfma_f32_16x16x32_bf16 v[36:39], v[100:103], v[60:63], v[36:39]
    v_mfma_f32_16x16x32_bf16 v[40:43], v[100:103], v[64:67], v[40:43]
    v_mfma_f32_16x16x32_bf16 v[44:47], v[104:107], v[60:63], v[44:47]
    v_mfma_f32_16x16x32_bf16 v[48:51], v[104:107], v[64:67], v[48:51]
    s_waitcnt vmcnt(0) lgkmcnt(0)
    s_barrier
    ds_read_b128 v[52:55], v17 offset:40960
    ds_read_b128 v[56:59], v17 offset:43008
    ds_read_b64_tr_b16 v[84:85], v144 offset:40960
    ds_read_b64_tr_b16 v[86:87], v144 offset:41728
    ds_read_b64_tr_b16 v[88:89], v145 offset:40960
    ds_read_b64_tr_b16 v[90:91], v145 offset:41728
    ds_read_b64_tr_b16 v[92:93], v146 offset:40960
    ds_read_b64_tr_b16 v[94:95], v146 offset:41728
    ds_read_b128 v[60:63], v18 offset:40960
    ds_read_b128 v[64:67], v18 offset:43008
    ds_read_b64_tr_b16 v[96:97], v144 offset:47104
    ds_read_b64_tr_b16 v[98:99], v144 offset:47872
    ds_read_b64_tr_b16 v[100:101], v145 offset:47104
    ds_read_b64_tr_b16 v[102:103], v145 offset:47872
    ds_read_b64_tr_b16 v[104:105], v146 offset:47104
    ds_read_b64_tr_b16 v[106:107], v146 offset:47872
    v_mfma_f32_16x16x32_bf16 v[28:31], v[108:111], v[68:71], v[28:31]
    v_mfma_f32_16x16x32_bf16 v[32:35], v[108:111], v[72:75], v[32:35]
    v_mfma_f32_16x16x32_bf16 v[36:39], v[112:115], v[68:71], v[36:39]
    v_mfma_f32_16x16x32_bf16 v[40:43], v[112:115], v[72:75], v[40:43]
    v_mfma_f32_16x16x32_bf16 v[44:47], v[116:119], v[68:71], v[44:47]
    v_mfma_f32_16x16x32_bf16 v[48:51], v[116:119], v[72:75], v[48:51]
    v_mfma_f32_16x16x32_bf16 v[28:31], v[120:123], v[76:79], v[28:31]
    v_mfma_f32_16x16x32_bf16 v[32:35], v[120:123], v[80:83], v[32:35]
    v_mfma_f32_16x16x32_bf16 v[36:39], v[124:127], v[76:79], v[36:39]
    v_mfma_f32_16x16x32_bf16 v[40:43], v[124:127], v[80:83], v[40:43]
    v_mfma_f32_16x16x32_bf16 v[44:47], v[128:131], v[76:79], v[44:47]
    v_mfma_f32_16x16x32_bf16 v[48:51], v[128:131], v[80:83], v[48:51]
    s_waitcnt lgkmcnt(0)
    v_mfma_f32_16x16x32_bf16 v[28:31], v[84:87], v[52:55], v[28:31]
    v_mfma_f32_16x16x32_bf16 v[32:35], v[84:87], v[56:59], v[32:35]
    v_mfma_f32_16x16x32_bf16 v[36:39], v[88:91], v[52:55], v[36:39]
    v_mfma_f32_16x16x32_bf16 v[40:43], v[88:91], v[56:59], v[40:43]
    v_mfma_f32_16x16x32_bf16 v[44:47], v[92:95], v[52:55], v[44:47]
    v_mfma_f32_16x16x32_bf16 v[48:51], v[92:95], v[56:59], v[48:51]
    v_mfma_f32_16x16x32_bf16 v[28:31], v[96:99], v[60:63], v[28:31]
    v_mfma_f32_16x16x32_bf16 v[32:35], v[96:99], v[64:67], v[32:35]
    v_mfma_f32_16x16x32_bf16 v[36:39], v[100:103], v[60:63], v[36:39]
    v_mfma_f32_16x16x32_bf16 v[40:43], v[100:103], v[64:67], v[40:43]
    v_mfma_f32_16x16x32_bf16 v[44:47], v[104:107], v[60:63], v[44:47]
    v_mfma_f32_16x16x32_bf16 v[48:51], v[104:107], v[64:67], v[48:51]
    s_lshl_b32 s39, s29, 5
    s_add_u32 s39, s39, s33
    v_add_u32 v4, s39, v2
    v_lshlrev_b32 v5, 3, v3
    s_movk_i32 s40, 1152
    v_mad_u32_u24 v25, v4, s40, v5
    v_add_u32 v6, 18432, v25
    s_mul_i32 s41, s30, 96
    s_lshl_b32 s42, s34, 1
    s_add_u32 s42, s42, s41
    buffer_load_dwordx2 v[132:133], v25, s[16:19], s42 offen offset:0
    buffer_load_dwordx2 v[134:135], v6, s[16:19], s42 offen offset:0
    buffer_load_dwordx2 v[136:137], v25, s[16:19], s42 offen offset:32
    buffer_load_dwordx2 v[138:139], v6, s[16:19], s42 offen offset:32
    buffer_load_dwordx2 v[140:141], v25, s[16:19], s42 offen offset:64
    buffer_load_dwordx2 v[142:143], v6, s[16:19], s42 offen offset:64
    s_waitcnt vmcnt(0)
    s_nop 4
    v_lshlrev_b32 v8, 16, v132
    v_and_b32 v9, 0xffff0000, v132
    v_lshlrev_b32 v10, 16, v133
    v_and_b32 v11, 0xffff0000, v133
    v_add_f32 v28, v28, v8
    v_add_f32 v29, v29, v9
    v_add_f32 v30, v30, v10
    v_add_f32 v31, v31, v11
    v_cvt_pk_bf16_f32 v28, v28, v29
    v_cvt_pk_bf16_f32 v29, v30, v31
    buffer_store_dwordx2 v[28:29], v25, s[56:59], s42 offen offset:0
    v_lshlrev_b32 v8, 16, v134
    v_and_b32 v9, 0xffff0000, v134
    v_lshlrev_b32 v10, 16, v135
    v_and_b32 v11, 0xffff0000, v135
    v_add_f32 v32, v32, v8
    v_add_f32 v33, v33, v9
    v_add_f32 v34, v34, v10
    v_add_f32 v35, v35, v11
    v_cvt_pk_bf16_f32 v32, v32, v33
    v_cvt_pk_bf16_f32 v33, v34, v35
    buffer_store_dwordx2 v[32:33], v6, s[56:59], s42 offen offset:0
    v_lshlrev_b32 v8, 16, v136
    v_and_b32 v9, 0xffff0000, v136
    v_lshlrev_b32 v10, 16, v137
    v_and_b32 v11, 0xffff0000, v137
    v_add_f32 v36, v36, v8
    v_add_f32 v37, v37, v9
    v_add_f32 v38, v38, v10
    v_add_f32 v39, v39, v11
    v_cvt_pk_bf16_f32 v36, v36, v37
    v_cvt_pk_bf16_f32 v37, v38, v39
    buffer_store_dwordx2 v[36:37], v25, s[56:59], s42 offen offset:32
    v_lshlrev_b32 v8, 16, v138
    v_and_b32 v9, 0xffff0000, v138
    v_lshlrev_b32 v10, 16, v139
    v_and_b32 v11, 0xffff0000, v139
    v_add_f32 v40, v40, v8
    v_add_f32 v41, v41, v9
    v_add_f32 v42, v42, v10
    v_add_f32 v43, v43, v11
    v_cvt_pk_bf16_f32 v40, v40, v41
    v_cvt_pk_bf16_f32 v41, v42, v43
    buffer_store_dwordx2 v[40:41], v6, s[56:59], s42 offen offset:32
    v_lshlrev_b32 v8, 16, v140
    v_and_b32 v9, 0xffff0000, v140
    v_lshlrev_b32 v10, 16, v141
    v_and_b32 v11, 0xffff0000, v141
    v_add_f32 v44, v44, v8
    v_add_f32 v45, v45, v9
    v_add_f32 v46, v46, v10
    v_add_f32 v47, v47, v11
    v_cvt_pk_bf16_f32 v44, v44, v45
    v_cvt_pk_bf16_f32 v45, v46, v47
    buffer_store_dwordx2 v[44:45], v25, s[56:59], s42 offen offset:64
    v_lshlrev_b32 v8, 16, v142
    v_and_b32 v9, 0xffff0000, v142
    v_lshlrev_b32 v10, 16, v143
    v_and_b32 v11, 0xffff0000, v143
    v_add_f32 v48, v48, v8
    v_add_f32 v49, v49, v9
    v_add_f32 v50, v50, v10
    v_add_f32 v51, v51, v11
    v_cvt_pk_bf16_f32 v48, v48, v49
    v_cvt_pk_bf16_f32 v49, v50, v51
    buffer_store_dwordx2 v[48:49], v6, s[56:59], s42 offen offset:64
k4_end:
    s_endpgm
.section .rodata,"a"
.p2align 6
.amdhsa_kernel k1_kernel
  .amdhsa_next_free_vgpr 248
  .amdhsa_next_free_sgpr 102
  .amdhsa_accum_offset 248
  .amdhsa_group_segment_fixed_size 0
  .amdhsa_kernarg_size 104
  .amdhsa_user_sgpr_count 2
  .amdhsa_user_sgpr_kernarg_segment_ptr 1
  .amdhsa_system_sgpr_workgroup_id_x 1
.end_amdhsa_kernel
.section .rodata,"a"
.p2align 6
.amdhsa_kernel kn_kernel
  .amdhsa_next_free_vgpr 72
  .amdhsa_next_free_sgpr 80
  .amdhsa_accum_offset 72
  .amdhsa_group_segment_fixed_size 0
  .amdhsa_kernarg_size 104
  .amdhsa_user_sgpr_count 2
  .amdhsa_user_sgpr_kernarg_segment_ptr 1
  .amdhsa_system_sgpr_workgroup_id_x 1
.end_amdhsa_kernel
.section .rodata,"a"
.p2align 6
.amdhsa_kernel kf_kernel
  .amdhsa_next_free_vgpr 168
  .amdhsa_next_free_sgpr 102
  .amdhsa_accum_offset 168
  .amdhsa_group_segment_fixed_size 0
  .amdhsa_kernarg_size 104
  .amdhsa_user_sgpr_count 2
  .amdhsa_user_sgpr_kernarg_segment_ptr 1
  .amdhsa_system_sgpr_workgroup_id_x 1
.end_amdhsa_kernel
.section .rodata,"a"
.p2align 6
.amdhsa_kernel k4_kernel
  .amdhsa_next_free_vgpr 160
  .amdhsa_next_free_sgpr 102
  .amdhsa_accum_offset 160
  .amdhsa_group_segment_fixed_size 0
  .amdhsa_kernarg_size 104
  .amdhsa_user_sgpr_count 2
  .amdhsa_user_sgpr_kernarg_segment_ptr 1
  .amdhsa_system_sgpr_workgroup_id_x 1
.end_amdhsa_kernel
```
